```python
import torch

def _softmax(x, axis=-1):
    return torch.softmax(x, dim=axis)
def _gelu(x):
    return torch.nn.functional.gelu(x, approximate="tanh")
def _silu(x):
    return torch.nn.functional.silu(x)
def _sigmoid(x):
    return torch.sigmoid(x)
def _layernorm(x, axis=-1, eps=1e-5):
    m = x.mean(dim=axis, keepdim=True)
    v = x.var(dim=axis, keepdim=True, unbiased=False)
    return (x - m) / torch.sqrt(v + eps)
def _scatter_add(tgt, idx, src, axis=0):
    return tgt.clone().index_add_(axis, idx, src)
def _segment_sum(src, seg, n):
    out = torch.zeros((n,) + src.shape[1:], dtype=src.dtype)
    return out.index_add_(0, seg, src)
def _pad(x, pw):
    flat = tuple(v for pair in reversed(pw) for v in pair)
    return torch.nn.functional.pad(x, flat)

kernel_name = 'interleave_layers__linear_attn_block__dense_activation_silu__prompt'

def setup_inputs():

    _w = (lambda a: (lambda t: t.to(torch.bfloat16) if t.is_floating_point() else t)(torch.as_tensor(a)))
    def _A_setup():
        B, S, D = 1, 2048, 512
        return {
            "x": _w((lambda *s: torch.randn(*s, dtype=torch.bfloat16) * 0.05)(B, S, D)),
            "wqkv": _w((lambda *s: torch.randn(*s, dtype=torch.bfloat16) * 0.05)(D, 3 * D)),
            "wo": _w((lambda *s: torch.randn(*s, dtype=torch.bfloat16) * 0.05)(D, D)),
        }
    _A_in = _A_setup()

    def _B_setup():
        B, S, D, F = 1, 2048, 512, 1376
        return {
            "x": _w((lambda *s: torch.randn(*s, dtype=torch.bfloat16) * 0.05)(B, S, D)),
            "w1": _w((lambda *s: torch.randn(*s, dtype=torch.bfloat16) * 0.8)(D, F) * (D ** -0.5)),
            "w2": _w((lambda *s: torch.randn(*s, dtype=torch.bfloat16) * 0.8)(F, D) * (F ** -0.5)),
        }
    _B_in = _B_setup()

    return {
        "A_x": _A_in["x"],
        "A_wqkv": _A_in["wqkv"],
        "A_wo": _A_in["wo"],
        "B_x": _B_in["x"],
        "B_w1": _B_in["w1"],
        "B_w2": _B_in["w2"],
    }

def reference(A_x, A_wqkv, A_wo, B_x, B_w1, B_w2):
    def _A_ref(x, wqkv, wo):
        B, S, D = x.shape
        H = 32; Dh = D // H
        qkv = (lambda x, *d: x.permute(*d))((x @ wqkv).reshape(B, S, 3, H, Dh), 2, 0, 3, 1, 4)
        q, k, v = qkv[0], qkv[1], qkv[2]
        phi = lambda t: torch.where(t > 0, t + 1, torch.exp(t)) + 1e-6
        pq, pk = phi(q), phi(k)
        kv = torch.einsum("bhsd,bhse->bhde", pk, v)
        z = torch.einsum("bhsd->bhd", pk)
        num = torch.einsum("bhqd,bhde->bhqe", pq, kv)
        den = torch.einsum("bhqd,bhd->bhq", pq, z)[..., None] + 1e-6
        o = num / den
        return (lambda x, *d: x.permute(*d))(o, 0, 2, 1, 3).reshape(B, S, D) @ wo

    def _B_ref(x, w1, w2):
        h = torch.einsum("bsd,df->bsf", x, w1)
        h = _silu(h)
        out = torch.einsum("bsf,fd->bsd", h, w2)
        return out

    x = A_x
    x = x + _A_ref(_layernorm(x, axis=-1), A_wqkv, A_wo)
    x = x + _B_ref(_layernorm(x, axis=-1), B_w1, B_w2)
    x = x + _A_ref(_layernorm(x, axis=-1), A_wqkv, A_wo)
    x = x + _B_ref(_layernorm(x, axis=-1), B_w1, B_w2)
    return x
```

```asm
; @launch grid=(256,1,1) block=(512,1,1) lds=163840
.amdgcn_target "amdgcn-amd-amdhsa--gfx950"
.text
.globl interleave_layers__linear_attn_block__dense_activation_silu__prompt_kernel
.p2align 8
.type interleave_layers__linear_attn_block__dense_activation_silu__prompt_kernel,@function
interleave_layers__linear_attn_block__dense_activation_silu__prompt_kernel:
    s_load_dwordx4 s[36:39], s[0:1], 0
    s_getpc_b64 s[90:91]
L_pc:
    s_cmp_ge_u32 s2, 256
    s_cbranch_scc1 L_end
    v_lshrrev_b32 v2, 6, v0
    s_load_dwordx8 s[40:47], s[0:1], 16
    s_load_dwordx4 s[48:51], s[0:1], 48
    s_load_dwordx2 s[52:53], s[0:1], 64
    v_readfirstlane_b32 s94, v2
    s_lshr_b32 s96, s2, 3
    s_and_b32 s95, s2, 7
    s_and_b32 s97, s96, 15
    s_lshr_b32 s98, s96, 4
    s_lshl_b32 s99, s95, 1
    s_add_u32 s99, s99, s98
    s_lshl_b32 s99, s99, 2
    s_and_b32 s93, s94, 3
    s_add_u32 s99, s99, s93
    s_add_u32 s64, s97, s95
    s_and_b32 s64, s64, 3
    v_lshlrev_b32 v19, 3, v0
    v_and_b32 v0, 63, v0
    s_cmp_ge_u32 s94, 4
    s_cbranch_scc0 L_compute
    v_lshlrev_b32 v1, 4, v0
    v_lshrrev_b32 v28, 4, v0
    v_lshrrev_b32 v29, 3, v0
    v_and_b32 v30, 7, v0
    v_xor_b32 v2, v30, v28
    v_lshlrev_b32 v2, 4, v2
    v_lshl_add_u32 v2, v29, 10, v2
    v_xor_b32 v3, 64, v2
    v_add_u32 v3, 8192, v3
    v_lshrrev_b32 v29, 2, v0
    v_mul_u32_u24 v29, 3072, v29
    v_and_b32 v30, 3, v0
    v_lshl_add_u32 v4, v30, 4, v29
    s_mul_i32 s100, s93, 49152
    s_lshl_b32 s101, s97, 6
    s_add_u32 s100, s100, s101
    v_add_u32 v4, s100, v4
    s_lshl_b32 s100, s99, 15
    s_lshl_b32 s101, s93, 14
    s_add_u32 s101, s101, 98304
    s_lshl_b32 s3, s93, 10
    s_add_u32 s85, s97, 0
    s_and_b32 s85, s85, 15
    s_sub_u32 s85, s85, s97
    s_lshl_b32 s85, s85, 6
    v_add_u32 v22, s85, v4
    s_waitcnt lgkmcnt(0)
    s_mov_b32 s8, s38
    s_and_b32 s9, s39, 0xffff
    s_mov_b32 s10, 1572864
    s_mov_b32 s11, 0x20000
    s_mov_b32 s4, s36
    s_and_b32 s5, s37, 0xffff
    s_mov_b32 s6, 2097152
    s_mov_b32 s7, 0x20000
    s_mov_b32 s36, s93
    s_add_u32 s71, s64, 0
    s_and_b32 s71, s71, 7
    s_lshl_b32 s42, s71, 7
    s_add_u32 s42, s42, s100
    s_mul_i32 s43, s71, 196608
    s_add_u32 m0, s101, 0
    s_add_u32 s39, s42, 0
    buffer_load_dwordx4 v2, s[4:7], s39 offen lds
    s_add_u32 m0, s101, 1024
    s_add_u32 s39, s42, 0
    buffer_load_dwordx4 v3, s[4:7], s39 offen lds
    s_add_u32 s39, s42, 15360
    buffer_load_dwordx4 v2, s[4:7], s39 offen offset:1024 lds
    s_add_u32 s39, s42, 14336
    buffer_load_dwordx4 v3, s[4:7], s39 offen offset:2048 lds
    s_add_u32 m0, s3, 0
    s_add_u32 s39, s43, 1024
    buffer_load_dwordx4 v4, s[8:11], s39 offen lds
    s_add_u32 m0, s3, 32768
    s_add_u32 s39, s43, 2048
    buffer_load_dwordx4 v4, s[8:11], s39 offen lds
    s_add_u32 m0, s3, 65536
    s_add_u32 s39, s43, 0
    buffer_load_dwordx4 v22, s[8:11], s39 offen lds
    s_lshl_b32 s92, s96, 11
    v_add_u32 v19, s92, v19
    v_subrev_u32 v19, 2048, v19
    v_min_u32 v19, (L_codeend - L_pc - 8), v19
    global_load_dwordx2 v[250:251], v19, s[90:91]
    s_setprio 2
    s_mov_b32 s28, s52
    s_and_b32 s29, s53, 0xffff
    s_mov_b32 s30, 11534336
    s_mov_b32 s31, 0x20000
    s_cmp_eq_u32 s36, 3
    s_cbranch_scc0 Lnoclr_1
    v_mov_b32 v36, -1
    v_mov_b32 v37, -1
    v_mov_b32 v38, -1
    v_mov_b32 v39, -1
    s_lshl_b32 s57, s96, 3
    s_add_u32 s57, s57, s95
    s_lshl_b32 s58, s57, 10
    s_add_u32 s58, s58, 10354688
    buffer_store_dwordx4 v[36:39], v1, s[28:31], s58 offen sc1
    s_add_u32 s58, s58, 278528
    buffer_store_dwordx4 v[36:39], v1, s[28:31], s58 offen sc1
    s_lshl_b32 s58, s57, 6
    s_add_u32 s58, s58, 10616832
    s_add_u32 s59, s58, 278464
    s_mul_i32 s57, s57, 80
    s_add_u32 s57, s57, 10911616
    v_mov_b32 v11, s57
    v_mov_b32 v12, s59
    v_cmp_gt_u32 vcc, 8, v0
    s_nop 1
    v_cndmask_b32 v11, v11, v12, vcc
    v_mov_b32 v12, s58
    v_cmp_gt_u32 vcc, 4, v0
    s_nop 1
    v_cndmask_b32 v11, v11, v12, vcc
    v_add_u32 v11, v11, v1
    s_mov_b64 exec, 0x1fff
    buffer_store_dwordx4 v[36:39], v11, s[28:31], 0 offen sc1
    s_mov_b64 exec, -1
Lnoclr_1:
    s_mov_b32 s24, s48
    s_and_b32 s25, s49, 0xffff
    s_mov_b32 s26, 2097152
    s_mov_b32 s27, 0x20000
    s_mov_b32 s32, s50
    s_and_b32 s33, s51, 0xffff
    s_mov_b32 s34, 256
    s_mov_b32 s35, 0x20000
    s_mov_b32 s12, s40
    s_and_b32 s13, s41, 0xffff
    s_mov_b32 s14, 524288
    s_mov_b32 s15, 0x20000
    s_mov_b32 s16, s44
    s_and_b32 s17, s45, 0xffff
    s_mov_b32 s18, 1409024
    s_mov_b32 s19, 0x20000
    s_mov_b32 s20, s46
    s_and_b32 s21, s47, 0xffff
    s_mov_b32 s22, 1409024
    s_mov_b32 s23, 0x20000
    s_mov_b32 s37, s95
    s_mov_b32 s38, s96
    v_lshlrev_b32 v14, 7, v0
    s_getreg_b32 s41, hwreg(HW_REG_XCC_ID, 0, 4)
    s_and_b32 s41, s41, 7
    v_and_b32 v31, 15, v0
    v_lshrrev_b32 v32, 5, v0
    v_and_b32 v33, 31, v0
    v_lshrrev_b32 v29, 2, v31
    v_and_b32 v30, 1, v28
    v_lshlrev_b32 v30, 5, v30
    v_and_b32 v11, 3, v31
    v_lshl_add_u32 v30, v11, 3, v30
    v_lshl_add_u32 v11, v32, 2, v29
    v_lshl_add_u32 v16, v11, 6, v30
    s_min_u32 s58, s36, 2
    s_lshl_b32 s58, s58, 15
    v_add_u32 v16, s58, v16
    s_add_u32 s71, s64, 1
    s_and_b32 s71, s71, 7
    s_lshl_b32 s42, s71, 7
    s_add_u32 s42, s42, s100
    s_mul_i32 s43, s71, 196608
    s_add_u32 m0, s101, 4096
    s_add_u32 s39, s42, 0
    buffer_load_dwordx4 v2, s[4:7], s39 offen lds
    s_min_u32 s57, s36, 2
    v_mul_u32_u24 v18, 192, v11
    v_add_u32 v18, v18, v30
    s_lshl_b32 s58, s57, 6
    v_add_u32 v18, s58, v18
    v_lshrrev_b32 v29, 1, v33
    v_and_b32 v29, 7, v29
    v_xor_b32 v29, v29, v32
    v_lshlrev_b32 v30, 7, v33
    v_add_u32 v30, s101, v30
    v_xor_b32 v20, 0, v29
    v_lshl_add_u32 v20, v20, 4, v30
    v_xor_b32 v21, 2, v29
    s_add_u32 m0, s101, 5120
    s_add_u32 s39, s42, 0
    buffer_load_dwordx4 v3, s[4:7], s39 offen lds
    v_lshl_add_u32 v21, v21, 4, v30
    s_mov_b32 s86, 0x3f803f80
    v_mov_b32 v24, s86
    v_mov_b32 v25, s86
    v_mov_b32 v26, s86
    v_mov_b32 v27, s86
    s_lshr_b32 s63, s36, 1
    s_mul_i32 s82, s97, 3
    s_lshl_b32 s83, s97, 1
    s_add_u32 s83, s83, 11
    s_min_u32 s82, s82, s83
    s_lshl_b32 s82, s82, 6
    s_add_u32 s83, s97, 5
    s_add_u32 s39, s42, 15360
    buffer_load_dwordx4 v2, s[4:7], s39 offen offset:1024 lds
    s_lshr_b32 s83, s83, 4
    s_mul_i32 s83, s83, -8
    s_add_u32 s83, s83, 15
    v_mov_b32 v13, 0x40000000
    v_add_u32 v11, 0, v0
    v_mul_u32_u24 v12, 43691, v11
    v_lshrrev_b32 v12, 19, v12
    v_mul_u32_u24 v5, 12, v12
    v_sub_u32 v11, v11, v5
    v_mul_u32_u24 v12, 2752, v12
    v_lshl_add_u32 v5, v11, 4, v12
    v_add_u32 v5, s82, v5
    v_cmp_lt_u32 vcc, s83, v11
    s_add_u32 s39, s42, 14336
    buffer_load_dwordx4 v3, s[4:7], s39 offen offset:2048 lds
    v_cndmask_b32 v5, v5, v13, vcc
    v_add_u32 v11, 64, v0
    v_mul_u32_u24 v12, 43691, v11
    v_lshrrev_b32 v12, 19, v12
    v_mul_u32_u24 v6, 12, v12
    v_sub_u32 v11, v11, v6
    v_mul_u32_u24 v12, 2752, v12
    v_lshl_add_u32 v6, v11, 4, v12
    v_add_u32 v6, s82, v6
    v_cmp_lt_u32 vcc, s83, v11
    s_nop 1
    v_cndmask_b32 v6, v6, v13, vcc
    v_add_u32 v11, 128, v0
    v_mul_u32_u24 v12, 43691, v11
    s_add_u32 m0, s3, 4096
    s_add_u32 s39, s43, 1024
    buffer_load_dwordx4 v4, s[8:11], s39 offen lds
    v_lshrrev_b32 v12, 19, v12
    v_mul_u32_u24 v7, 12, v12
    v_sub_u32 v11, v11, v7
    v_mul_u32_u24 v12, 2752, v12
    v_lshl_add_u32 v7, v11, 4, v12
    v_add_u32 v7, s82, v7
    v_cmp_lt_u32 vcc, s83, v11
    s_nop 1
    v_cndmask_b32 v7, v7, v13, vcc
    v_and_b32 v11, 1, v28
    v_lshlrev_b32 v11, 2, v11
    v_and_b32 v12, 7, v0
    v_xor_b32 v11, v11, v12
    v_lshlrev_b32 v11, 4, v11
    s_add_u32 m0, s3, 36864
    s_add_u32 s39, s43, 2048
    buffer_load_dwordx4 v4, s[8:11], s39 offen lds
    v_lshrrev_b32 v12, 3, v0
    v_lshl_add_u32 v8, v12, 10, v11
    s_and_b32 s82, s38, 7
    s_lshl_b32 s82, s82, 7
    v_add_u32 v8, s82, v8
    s_and_b32 s83, s36, 1
    s_mul_i32 s45, s83, 44032
    s_mul_i32 s46, s83, 3072
    s_lshl_b32 s47, s83, 18
    s_lshl_b32 s48, s83, 15
    s_add_u32 s48, s48, 98304
    s_mul_i32 s82, s63, 704512
    s_lshl_b32 s49, s83, 13
    s_add_u32 m0, s3, 69632
    s_add_u32 s39, s43, 0
    buffer_load_dwordx4 v22, s[8:11], s39 offen lds
    s_lshl_b32 s68, s83, 10
    s_lshl_b32 s82, s63, 15
    s_add_u32 s68, s68, s82
    s_add_u32 s68, s68, 98304
    s_lshl_b32 s51, s36, 14
    s_add_u32 s51, s51, 98304
    s_mul_i32 s52, s63, 49152
    s_lshl_b32 s80, s83, 10
    s_add_u32 s52, s52, s80
    s_lshl_b32 s80, s97, 1
    s_add_u32 s80, s80, s83
    s_lshl_b32 s81, s37, 1
    s_add_u32 s81, s81, s98
    s_add_u32 s71, s64, 2
    s_and_b32 s71, s71, 7
    s_lshl_b32 s42, s71, 7
    s_add_u32 s42, s42, s100
    s_mul_i32 s43, s71, 196608
    s_add_u32 m0, s101, 8192
    s_add_u32 s39, s42, 0
    buffer_load_dwordx4 v2, s[4:7], s39 offen lds
    s_lshl_b32 s82, s80, 13
    s_lshl_b32 s69, s81, 8
    s_add_u32 s82, s82, s69
    v_lshlrev_b32 v11, 12, v32
    v_lshl_add_u32 v11, v31, 4, v11
    v_add_u32 v11, s82, v11
    s_lshl_b32 s82, s80, 9
    s_lshl_b32 s69, s81, 4
    s_add_u32 s82, s82, s69
    s_add_u32 s82, s82, 262144
    v_lshlrev_b32 v12, 8, v32
    v_add_u32 v12, s82, v12
    v_and_b32 v10, 1, v28
    s_add_u32 m0, s101, 9216
    s_add_u32 s39, s42, 0
    buffer_load_dwordx4 v3, s[4:7], s39 offen lds
    v_cmp_eq_u32 vcc, s83, v10
    s_nop 1
    v_cndmask_b32 v10, v12, v11, vcc
    s_mul_i32 s78, s83, 4294770690
    s_add_u32 s78, s78, 0x0001ffff
    s_mov_b32 s79, s78
    v_lshlrev_b32 v9, 4, v31
    v_lshl_add_u32 v9, v28, 2, v9
    s_add_u32 s80, s97, 0
    s_and_b32 s80, s80, 15
    s_lshl_b32 s80, s80, 1
    s_add_u32 s80, s80, s83
    s_lshl_b32 s54, s80, 13
    s_add_u32 s54, s54, 10354688
    s_add_u32 s39, s42, 15360
    buffer_load_dwordx4 v2, s[4:7], s39 offen offset:1024 lds
    s_lshl_b32 s55, s80, 9
    s_add_u32 s55, s55, 10616832
    s_mul_i32 s56, s83, 2304
    s_add_u32 s56, s56, 49152
    s_xor_b32 s65, s56, 256
    s_mov_b32 s74, -1
    s_mov_b32 s75, 0
    s_mov_b32 s87, 0x3f80
    s_mov_b32 s88, 0x3f800000
    s_mov_b32 s89, 0xfffffffe
    v_and_b32 v11, 7, v0
    v_and_b32 v19, 1, v11
    v_lshlrev_b32 v19, 7, v19
    s_add_u32 s39, s42, 14336
    buffer_load_dwordx4 v3, s[4:7], s39 offen offset:2048 lds
    v_lshrrev_b32 v11, 1, v11
    v_lshl_add_u32 v19, v11, 3, v19
    s_lshl_b32 s53, s38, 2
    s_add_u32 s53, s53, s36
    s_lshr_b32 s80, s53, 4
    s_and_b32 s81, s53, 15
    s_lshl_b32 s69, s37, 3
    s_add_u32 s80, s80, s69
    s_mul_i32 s73, s80, 88064
    s_add_u32 s73, s73, 4194304
    s_lshl_b32 s82, s81, 11
    s_add_u32 s80, s73, s82
    s_mul_i32 s82, s81, 3456
    s_add_u32 m0, s3, 8192
    s_add_u32 s39, s43, 1024
    buffer_load_dwordx4 v4, s[8:11], s39 offen lds
    s_add_u32 s73, s73, s82
    s_add_u32 s73, s73, 32768
    s_lshl_b32 s77, s37, 7
    s_add_u32 s77, s77, s53
    v_mov_b32 v15, s80
    s_lshl_b32 s81, s37, 15
    s_lshl_b32 s82, s53, 8
    s_add_u32 s81, s81, s82
    s_add_u32 s82, s81, 9828352
    v_mov_b32 v11, s82
    v_cmp_lt_u32 vcc, 15, v0
    s_nop 1
    v_cndmask_b32 v15, v15, v11, vcc
    v_add_u32 v15, v15, v14
    s_add_u32 m0, s3, 40960
    s_add_u32 s39, s43, 2048
    buffer_load_dwordx4 v4, s[8:11], s39 offen lds
    s_add_u32 m0, s3, 73728
    s_add_u32 s39, s43, 0
    buffer_load_dwordx4 v22, s[8:11], s39 offen lds
    s_cmp_eq_u32 s36, 3
    s_cbranch_scc0 Lnoreg_2
    s_lshl_b32 s57, s41, 3
    s_lshl_b64 s[90:91], 1, s57
    v_mov_b32 v36, s90
    v_mov_b32 v37, s91
    s_and_b32 s57, s37, 1
    s_lshl_b32 s57, s57, 7
    s_lshr_b32 s58, s37, 1
    s_lshl_b32 s58, s58, 3
    s_add_u32 s57, s57, s58
    s_waitcnt vmcnt(14)
    s_mov_b64 exec, 1
    buffer_atomic_add_x2 v[36:37], off, s[32:35], s57 sc1
    s_mov_b64 exec, -1
Lnoreg_2:
    s_lshl_b32 s57, s36, 10
    v_add_u32 v42, s57, v1
    v_add_u32 v43, 65536, v42
    v_mov_b32 v36, 0
    v_mov_b32 v37, 0
    v_mov_b32 v44, 0
    v_mov_b32 v45, 0
    v_lshlrev_b32 v13, 3, v0
    v_add_u32 v13, s101, v13
    s_waitcnt vmcnt(15)
    s_barrier
    v_lshlrev_b32 v11, 10, v0
    s_mul_i32 s57, s53, 12288
    s_add_u32 s57, s57, 384
    s_bfm_b64 exec, 12, 0
    buffer_load_dword v250, v11, s[8:11], s57 offen
    s_mov_b64 exec, -1
    ds_read_b128 v[144:147], v20 offset:0
    ds_read_b128 v[148:151], v21 offset:0
    ds_read_b64_tr_b16 v[160:161], v16 offset:0
    ds_read_b64_tr_b16 v[162:163], v16 offset:512
    ds_read_b64_tr_b16 v[164:165], v16 offset:1024
    ds_read_b64_tr_b16 v[166:167], v16 offset:1536
    ds_read_b64_tr_b16 v[168:169], v16 offset:2048
    ds_read_b64_tr_b16 v[170:171], v16 offset:2560
    ds_read_b64_tr_b16 v[172:173], v16 offset:3072
    ds_read_b64_tr_b16 v[174:175], v16 offset:3584
    ds_read_b128 v[48:51], v42 offset:0
    ds_read_b128 v[52:55], v42 offset:32768
    ds_read_b128 v[112:115], v43 offset:0
    s_add_u32 s71, s64, 3
    s_and_b32 s71, s71, 7
    s_lshl_b32 s42, s71, 7
    s_add_u32 s42, s42, s100
    s_mul_i32 s43, s71, 196608
    s_add_u32 m0, s101, 12288
    s_add_u32 s39, s42, 0
    buffer_load_dwordx4 v2, s[4:7], s39 offen lds
    s_waitcnt lgkmcnt(12)
    v_lshlrev_b32 v46, 16, v144
    v_and_b32 v47, 0xffff0000, v144
    v_fmac_f32 v36, v46, v46
    v_fmac_f32 v44, v47, v47
    v_add_f32 v37, v37, v46
    v_add_f32 v45, v45, v47
    v_lshlrev_b32 v46, 16, v145
    v_and_b32 v47, 0xffff0000, v145
    v_fmac_f32 v36, v46, v46
    v_fmac_f32 v44, v47, v47
    v_add_f32 v37, v37, v46
    v_add_f32 v45, v45, v47
    s_waitcnt lgkmcnt(9)
    v_mfma_f32_32x32x16_bf16 v[176:191], v[24:27], v[160:163], 0
    s_add_u32 m0, s101, 13312
    s_add_u32 s39, s42, 0
    buffer_load_dwordx4 v3, s[4:7], s39 offen lds
    v_lshlrev_b32 v46, 16, v146
    v_and_b32 v47, 0xffff0000, v146
    v_fmac_f32 v36, v46, v46
    v_fmac_f32 v44, v47, v47
    v_add_f32 v37, v37, v46
    v_add_f32 v45, v45, v47
    v_lshlrev_b32 v46, 16, v147
    v_and_b32 v47, 0xffff0000, v147
    v_fmac_f32 v36, v46, v46
    v_fmac_f32 v44, v47, v47
    v_add_f32 v37, v37, v46
    v_add_f32 v45, v45, v47
    s_add_u32 s39, s42, 15360
    buffer_load_dwordx4 v2, s[4:7], s39 offen offset:1024 lds
    s_waitcnt lgkmcnt(7)
    v_mfma_f32_32x32x16_bf16 v[176:191], v[24:27], v[164:167], v[176:191]
    s_add_u32 s39, s42, 14336
    buffer_load_dwordx4 v3, s[4:7], s39 offen offset:2048 lds
    v_lshlrev_b32 v46, 16, v148
    v_and_b32 v47, 0xffff0000, v148
    v_fmac_f32 v36, v46, v46
    v_fmac_f32 v44, v47, v47
    v_add_f32 v37, v37, v46
    v_add_f32 v45, v45, v47
    v_lshlrev_b32 v46, 16, v149
    v_and_b32 v47, 0xffff0000, v149
    v_fmac_f32 v36, v46, v46
    v_fmac_f32 v44, v47, v47
    v_add_f32 v37, v37, v46
    v_add_f32 v45, v45, v47
    s_waitcnt lgkmcnt(5)
    v_mfma_f32_32x32x16_bf16 v[176:191], v[24:27], v[168:171], v[176:191]
    s_add_u32 m0, s3, 12288
    s_add_u32 s39, s43, 1024
    buffer_load_dwordx4 v4, s[8:11], s39 offen lds
    v_lshlrev_b32 v46, 16, v150
    v_and_b32 v47, 0xffff0000, v150
    v_fmac_f32 v36, v46, v46
    v_fmac_f32 v44, v47, v47
    v_add_f32 v37, v37, v46
    v_add_f32 v45, v45, v47
    v_lshlrev_b32 v46, 16, v151
    v_and_b32 v47, 0xffff0000, v151
    v_fmac_f32 v36, v46, v46
    v_fmac_f32 v44, v47, v47
    v_add_f32 v37, v37, v46
    v_add_f32 v45, v45, v47
    s_add_u32 m0, s3, 45056
    s_add_u32 s39, s43, 2048
    buffer_load_dwordx4 v4, s[8:11], s39 offen lds
    s_waitcnt lgkmcnt(3)
    v_mfma_f32_32x32x16_bf16 v[176:191], v[24:27], v[172:175], v[176:191]
    s_add_u32 m0, s3, 77824
    s_add_u32 s39, s43, 0
    buffer_load_dwordx4 v22, s[8:11], s39 offen lds
    s_waitcnt vmcnt(15)
    s_barrier
    s_add_u32 s71, s64, 4
    s_and_b32 s71, s71, 7
    s_lshl_b32 s42, s71, 7
    s_add_u32 s42, s42, s100
    s_mul_i32 s43, s71, 196608
    s_add_u32 m0, s101, 0
    s_add_u32 s39, s42, 0
    buffer_load_dwordx4 v2, s[4:7], s39 offen lds
    ds_read_b128 v[144:147], v20 offset:4096
    ds_read_b128 v[148:151], v21 offset:4096
    ds_read_b64_tr_b16 v[160:161], v16 offset:4096
    ds_read_b64_tr_b16 v[162:163], v16 offset:4608
    ds_read_b64_tr_b16 v[164:165], v16 offset:5120
    ds_read_b64_tr_b16 v[166:167], v16 offset:5632
    ds_read_b64_tr_b16 v[168:169], v16 offset:6144
    ds_read_b64_tr_b16 v[170:171], v16 offset:6656
    ds_read_b64_tr_b16 v[172:173], v16 offset:7168
    ds_read_b64_tr_b16 v[174:175], v16 offset:7680
    ds_read_b128 v[56:59], v42 offset:4096
    ds_read_b128 v[60:63], v42 offset:36864
    ds_read_b128 v[116:119], v43 offset:4096
    s_add_u32 m0, s101, 1024
    s_add_u32 s39, s42, 0
    buffer_load_dwordx4 v3, s[4:7], s39 offen lds
    s_waitcnt lgkmcnt(12)
    v_lshlrev_b32 v46, 16, v144
    v_and_b32 v47, 0xffff0000, v144
    v_fmac_f32 v36, v46, v46
    v_fmac_f32 v44, v47, v47
    v_add_f32 v37, v37, v46
    v_add_f32 v45, v45, v47
    v_lshlrev_b32 v46, 16, v145
    v_and_b32 v47, 0xffff0000, v145
    v_fmac_f32 v36, v46, v46
    v_fmac_f32 v44, v47, v47
    v_add_f32 v37, v37, v46
    v_add_f32 v45, v45, v47
    s_waitcnt lgkmcnt(9)
    v_mfma_f32_32x32x16_bf16 v[176:191], v[24:27], v[160:163], v[176:191]
    s_add_u32 s39, s42, 15360
    buffer_load_dwordx4 v2, s[4:7], s39 offen offset:1024 lds
    v_lshlrev_b32 v46, 16, v146
    v_and_b32 v47, 0xffff0000, v146
    v_fmac_f32 v36, v46, v46
    v_fmac_f32 v44, v47, v47
    v_add_f32 v37, v37, v46
    v_add_f32 v45, v45, v47
    v_lshlrev_b32 v46, 16, v147
    v_and_b32 v47, 0xffff0000, v147
    v_fmac_f32 v36, v46, v46
    v_fmac_f32 v44, v47, v47
    v_add_f32 v37, v37, v46
    v_add_f32 v45, v45, v47
    s_add_u32 s39, s42, 14336
    buffer_load_dwordx4 v3, s[4:7], s39 offen offset:2048 lds
    s_waitcnt lgkmcnt(7)
    v_mfma_f32_32x32x16_bf16 v[176:191], v[24:27], v[164:167], v[176:191]
    s_add_u32 m0, s3, 16384
    s_add_u32 s39, s43, 1024
    buffer_load_dwordx4 v4, s[8:11], s39 offen lds
    v_lshlrev_b32 v46, 16, v148
    v_and_b32 v47, 0xffff0000, v148
    v_fmac_f32 v36, v46, v46
    v_fmac_f32 v44, v47, v47
    v_add_f32 v37, v37, v46
    v_add_f32 v45, v45, v47
    v_lshlrev_b32 v46, 16, v149
    v_and_b32 v47, 0xffff0000, v149
    v_fmac_f32 v36, v46, v46
    v_fmac_f32 v44, v47, v47
    v_add_f32 v37, v37, v46
    v_add_f32 v45, v45, v47
    s_waitcnt lgkmcnt(5)
    v_mfma_f32_32x32x16_bf16 v[176:191], v[24:27], v[168:171], v[176:191]
    s_add_u32 m0, s3, 49152
    s_add_u32 s39, s43, 2048
    buffer_load_dwordx4 v4, s[8:11], s39 offen lds
    v_lshlrev_b32 v46, 16, v150
    v_and_b32 v47, 0xffff0000, v150
    v_fmac_f32 v36, v46, v46
    v_fmac_f32 v44, v47, v47
    v_add_f32 v37, v37, v46
    v_add_f32 v45, v45, v47
    v_lshlrev_b32 v46, 16, v151
    v_and_b32 v47, 0xffff0000, v151
    v_fmac_f32 v36, v46, v46
    v_fmac_f32 v44, v47, v47
    v_add_f32 v37, v37, v46
    v_add_f32 v45, v45, v47
    s_add_u32 m0, s3, 81920
    s_add_u32 s39, s43, 0
    buffer_load_dwordx4 v22, s[8:11], s39 offen lds
    s_waitcnt lgkmcnt(3)
    v_mfma_f32_32x32x16_bf16 v[176:191], v[24:27], v[172:175], v[176:191]
    s_waitcnt vmcnt(15)
    s_barrier
    s_add_u32 s71, s64, 5
    s_and_b32 s71, s71, 7
    s_lshl_b32 s42, s71, 7
    s_add_u32 s42, s42, s100
    s_mul_i32 s43, s71, 196608
    s_add_u32 m0, s101, 4096
    s_add_u32 s39, s42, 0
    buffer_load_dwordx4 v2, s[4:7], s39 offen lds
    ds_read_b128 v[144:147], v20 offset:8192
    ds_read_b128 v[148:151], v21 offset:8192
    ds_read_b64_tr_b16 v[160:161], v16 offset:8192
    ds_read_b64_tr_b16 v[162:163], v16 offset:8704
    ds_read_b64_tr_b16 v[164:165], v16 offset:9216
    ds_read_b64_tr_b16 v[166:167], v16 offset:9728
    ds_read_b64_tr_b16 v[168:169], v16 offset:10240
    ds_read_b64_tr_b16 v[170:171], v16 offset:10752
    ds_read_b64_tr_b16 v[172:173], v16 offset:11264
    ds_read_b64_tr_b16 v[174:175], v16 offset:11776
    ds_read_b128 v[64:67], v42 offset:8192
    ds_read_b128 v[68:71], v42 offset:40960
    ds_read_b128 v[120:123], v43 offset:8192
    s_add_u32 m0, s101, 5120
    s_add_u32 s39, s42, 0
    buffer_load_dwordx4 v3, s[4:7], s39 offen lds
    s_waitcnt lgkmcnt(12)
    v_lshlrev_b32 v46, 16, v144
    v_and_b32 v47, 0xffff0000, v144
    v_fmac_f32 v36, v46, v46
    v_fmac_f32 v44, v47, v47
    v_add_f32 v37, v37, v46
    v_add_f32 v45, v45, v47
    v_lshlrev_b32 v46, 16, v145
    v_and_b32 v47, 0xffff0000, v145
    v_fmac_f32 v36, v46, v46
    v_fmac_f32 v44, v47, v47
    v_add_f32 v37, v37, v46
    v_add_f32 v45, v45, v47
    s_waitcnt lgkmcnt(9)
    v_mfma_f32_32x32x16_bf16 v[176:191], v[24:27], v[160:163], v[176:191]
    s_add_u32 s39, s42, 15360
    buffer_load_dwordx4 v2, s[4:7], s39 offen offset:1024 lds
    v_lshlrev_b32 v46, 16, v146
    v_and_b32 v47, 0xffff0000, v146
    v_fmac_f32 v36, v46, v46
    v_fmac_f32 v44, v47, v47
    v_add_f32 v37, v37, v46
    v_add_f32 v45, v45, v47
    v_lshlrev_b32 v46, 16, v147
    v_and_b32 v47, 0xffff0000, v147
    v_fmac_f32 v36, v46, v46
    v_fmac_f32 v44, v47, v47
    v_add_f32 v37, v37, v46
    v_add_f32 v45, v45, v47
    s_add_u32 s39, s42, 14336
    buffer_load_dwordx4 v3, s[4:7], s39 offen offset:2048 lds
    s_waitcnt lgkmcnt(7)
    v_mfma_f32_32x32x16_bf16 v[176:191], v[24:27], v[164:167], v[176:191]
    s_add_u32 m0, s3, 20480
    s_add_u32 s39, s43, 1024
    buffer_load_dwordx4 v4, s[8:11], s39 offen lds
    v_lshlrev_b32 v46, 16, v148
    v_and_b32 v47, 0xffff0000, v148
    v_fmac_f32 v36, v46, v46
    v_fmac_f32 v44, v47, v47
    v_add_f32 v37, v37, v46
    v_add_f32 v45, v45, v47
    v_lshlrev_b32 v46, 16, v149
    v_and_b32 v47, 0xffff0000, v149
    v_fmac_f32 v36, v46, v46
    v_fmac_f32 v44, v47, v47
    v_add_f32 v37, v37, v46
    v_add_f32 v45, v45, v47
    s_waitcnt lgkmcnt(5)
    v_mfma_f32_32x32x16_bf16 v[176:191], v[24:27], v[168:171], v[176:191]
    s_add_u32 m0, s3, 53248
    s_add_u32 s39, s43, 2048
    buffer_load_dwordx4 v4, s[8:11], s39 offen lds
    v_lshlrev_b32 v46, 16, v150
    v_and_b32 v47, 0xffff0000, v150
    v_fmac_f32 v36, v46, v46
    v_fmac_f32 v44, v47, v47
    v_add_f32 v37, v37, v46
    v_add_f32 v45, v45, v47
    v_lshlrev_b32 v46, 16, v151
    v_and_b32 v47, 0xffff0000, v151
    v_fmac_f32 v36, v46, v46
    v_fmac_f32 v44, v47, v47
    v_add_f32 v37, v37, v46
    v_add_f32 v45, v45, v47
    s_add_u32 m0, s3, 86016
    s_add_u32 s39, s43, 0
    buffer_load_dwordx4 v22, s[8:11], s39 offen lds
    s_waitcnt lgkmcnt(3)
    v_mfma_f32_32x32x16_bf16 v[176:191], v[24:27], v[172:175], v[176:191]
    s_waitcnt vmcnt(14)
    s_barrier
    s_add_u32 s71, s64, 6
    s_and_b32 s71, s71, 7
    s_lshl_b32 s42, s71, 7
    s_add_u32 s42, s42, s100
    s_mul_i32 s43, s71, 196608
    s_add_u32 m0, s101, 8192
    s_add_u32 s39, s42, 0
    buffer_load_dwordx4 v2, s[4:7], s39 offen lds
    ds_read_b128 v[144:147], v20 offset:12288
    ds_read_b128 v[148:151], v21 offset:12288
    ds_read_b64_tr_b16 v[160:161], v16 offset:12288
    ds_read_b64_tr_b16 v[162:163], v16 offset:12800
    ds_read_b64_tr_b16 v[164:165], v16 offset:13312
    ds_read_b64_tr_b16 v[166:167], v16 offset:13824
    ds_read_b64_tr_b16 v[168:169], v16 offset:14336
    ds_read_b64_tr_b16 v[170:171], v16 offset:14848
    ds_read_b64_tr_b16 v[172:173], v16 offset:15360
    ds_read_b64_tr_b16 v[174:175], v16 offset:15872
    ds_read_b128 v[72:75], v42 offset:12288
    ds_read_b128 v[76:79], v42 offset:45056
    ds_read_b128 v[124:127], v43 offset:12288
    s_add_u32 m0, s101, 9216
    s_add_u32 s39, s42, 0
    buffer_load_dwordx4 v3, s[4:7], s39 offen lds
    s_waitcnt lgkmcnt(12)
    v_lshlrev_b32 v46, 16, v144
    v_and_b32 v47, 0xffff0000, v144
    v_fmac_f32 v36, v46, v46
    v_fmac_f32 v44, v47, v47
    v_add_f32 v37, v37, v46
    v_add_f32 v45, v45, v47
    v_lshlrev_b32 v46, 16, v145
    v_and_b32 v47, 0xffff0000, v145
    v_fmac_f32 v36, v46, v46
    v_fmac_f32 v44, v47, v47
    v_add_f32 v37, v37, v46
    v_add_f32 v45, v45, v47
    s_waitcnt lgkmcnt(9)
    v_mfma_f32_32x32x16_bf16 v[176:191], v[24:27], v[160:163], v[176:191]
    s_add_u32 s39, s42, 15360
    buffer_load_dwordx4 v2, s[4:7], s39 offen offset:1024 lds
    v_lshlrev_b32 v46, 16, v146
    v_and_b32 v47, 0xffff0000, v146
    v_fmac_f32 v36, v46, v46
    v_fmac_f32 v44, v47, v47
    v_add_f32 v37, v37, v46
    v_add_f32 v45, v45, v47
    v_lshlrev_b32 v46, 16, v147
    v_and_b32 v47, 0xffff0000, v147
    v_fmac_f32 v36, v46, v46
    v_fmac_f32 v44, v47, v47
    v_add_f32 v37, v37, v46
    v_add_f32 v45, v45, v47
    s_add_u32 s39, s42, 14336
    buffer_load_dwordx4 v3, s[4:7], s39 offen offset:2048 lds
    s_waitcnt lgkmcnt(7)
    v_mfma_f32_32x32x16_bf16 v[176:191], v[24:27], v[164:167], v[176:191]
    s_add_u32 m0, s3, 24576
    s_add_u32 s39, s43, 1024
    buffer_load_dwordx4 v4, s[8:11], s39 offen lds
    v_lshlrev_b32 v46, 16, v148
    v_and_b32 v47, 0xffff0000, v148
    v_fmac_f32 v36, v46, v46
    v_fmac_f32 v44, v47, v47
    v_add_f32 v37, v37, v46
    v_add_f32 v45, v45, v47
    v_lshlrev_b32 v46, 16, v149
    v_and_b32 v47, 0xffff0000, v149
    v_fmac_f32 v36, v46, v46
    v_fmac_f32 v44, v47, v47
    v_add_f32 v37, v37, v46
    v_add_f32 v45, v45, v47
    s_waitcnt lgkmcnt(5)
    v_mfma_f32_32x32x16_bf16 v[176:191], v[24:27], v[168:171], v[176:191]
    s_add_u32 m0, s3, 57344
    s_add_u32 s39, s43, 2048
    buffer_load_dwordx4 v4, s[8:11], s39 offen lds
    v_lshlrev_b32 v46, 16, v150
    v_and_b32 v47, 0xffff0000, v150
    v_fmac_f32 v36, v46, v46
    v_fmac_f32 v44, v47, v47
    v_add_f32 v37, v37, v46
    v_add_f32 v45, v45, v47
    v_lshlrev_b32 v46, 16, v151
    v_and_b32 v47, 0xffff0000, v151
    v_fmac_f32 v36, v46, v46
    v_fmac_f32 v44, v47, v47
    v_add_f32 v37, v37, v46
    v_add_f32 v45, v45, v47
    s_add_u32 m0, s3, 90112
    s_add_u32 s39, s43, 0
    buffer_load_dwordx4 v22, s[8:11], s39 offen lds
    s_waitcnt lgkmcnt(3)
    v_mfma_f32_32x32x16_bf16 v[176:191], v[24:27], v[172:175], v[176:191]
    s_waitcnt vmcnt(14)
    s_barrier
    s_add_u32 s71, s64, 7
    s_and_b32 s71, s71, 7
    s_lshl_b32 s42, s71, 7
    s_add_u32 s42, s42, s100
    s_mul_i32 s43, s71, 196608
    s_add_u32 m0, s101, 12288
    s_add_u32 s39, s42, 0
    buffer_load_dwordx4 v2, s[4:7], s39 offen lds
    ds_read_b128 v[144:147], v20 offset:0
    ds_read_b128 v[148:151], v21 offset:0
    ds_read_b64_tr_b16 v[160:161], v16 offset:16384
    ds_read_b64_tr_b16 v[162:163], v16 offset:16896
    ds_read_b64_tr_b16 v[164:165], v16 offset:17408
    ds_read_b64_tr_b16 v[166:167], v16 offset:17920
    ds_read_b64_tr_b16 v[168:169], v16 offset:18432
    ds_read_b64_tr_b16 v[170:171], v16 offset:18944
    ds_read_b64_tr_b16 v[172:173], v16 offset:19456
    ds_read_b64_tr_b16 v[174:175], v16 offset:19968
    ds_read_b128 v[80:83], v42 offset:16384
    ds_read_b128 v[84:87], v42 offset:49152
    ds_read_b128 v[128:131], v43 offset:16384
    s_add_u32 m0, s101, 13312
    s_add_u32 s39, s42, 0
    buffer_load_dwordx4 v3, s[4:7], s39 offen lds
    s_waitcnt lgkmcnt(12)
    v_lshlrev_b32 v46, 16, v144
    v_and_b32 v47, 0xffff0000, v144
    v_fmac_f32 v36, v46, v46
    v_fmac_f32 v44, v47, v47
    v_add_f32 v37, v37, v46
    v_add_f32 v45, v45, v47
    v_lshlrev_b32 v46, 16, v145
    v_and_b32 v47, 0xffff0000, v145
    v_fmac_f32 v36, v46, v46
    v_fmac_f32 v44, v47, v47
    v_add_f32 v37, v37, v46
    v_add_f32 v45, v45, v47
    s_waitcnt lgkmcnt(9)
    v_mfma_f32_32x32x16_bf16 v[176:191], v[24:27], v[160:163], v[176:191]
    s_add_u32 s39, s42, 15360
    buffer_load_dwordx4 v2, s[4:7], s39 offen offset:1024 lds
    v_lshlrev_b32 v46, 16, v146
    v_and_b32 v47, 0xffff0000, v146
    v_fmac_f32 v36, v46, v46
    v_fmac_f32 v44, v47, v47
    v_add_f32 v37, v37, v46
    v_add_f32 v45, v45, v47
    v_lshlrev_b32 v46, 16, v147
    v_and_b32 v47, 0xffff0000, v147
    v_fmac_f32 v36, v46, v46
    v_fmac_f32 v44, v47, v47
    v_add_f32 v37, v37, v46
    v_add_f32 v45, v45, v47
    s_add_u32 s39, s42, 14336
    buffer_load_dwordx4 v3, s[4:7], s39 offen offset:2048 lds
    s_waitcnt lgkmcnt(7)
    v_mfma_f32_32x32x16_bf16 v[176:191], v[24:27], v[164:167], v[176:191]
    s_add_u32 m0, s3, 28672
    s_add_u32 s39, s43, 1024
    buffer_load_dwordx4 v4, s[8:11], s39 offen lds
    v_lshlrev_b32 v46, 16, v148
    v_and_b32 v47, 0xffff0000, v148
    v_fmac_f32 v36, v46, v46
    v_fmac_f32 v44, v47, v47
    v_add_f32 v37, v37, v46
    v_add_f32 v45, v45, v47
    v_lshlrev_b32 v46, 16, v149
    v_and_b32 v47, 0xffff0000, v149
    v_fmac_f32 v36, v46, v46
    v_fmac_f32 v44, v47, v47
    v_add_f32 v37, v37, v46
    v_add_f32 v45, v45, v47
    s_waitcnt lgkmcnt(5)
    v_mfma_f32_32x32x16_bf16 v[176:191], v[24:27], v[168:171], v[176:191]
    s_add_u32 m0, s3, 61440
    s_add_u32 s39, s43, 2048
    buffer_load_dwordx4 v4, s[8:11], s39 offen lds
    v_lshlrev_b32 v46, 16, v150
    v_and_b32 v47, 0xffff0000, v150
    v_fmac_f32 v36, v46, v46
    v_fmac_f32 v44, v47, v47
    v_add_f32 v37, v37, v46
    v_add_f32 v45, v45, v47
    v_lshlrev_b32 v46, 16, v151
    v_and_b32 v47, 0xffff0000, v151
    v_fmac_f32 v36, v46, v46
    v_fmac_f32 v44, v47, v47
    v_add_f32 v37, v37, v46
    v_add_f32 v45, v45, v47
    s_add_u32 m0, s3, 94208
    s_add_u32 s39, s43, 0
    buffer_load_dwordx4 v22, s[8:11], s39 offen lds
    s_waitcnt lgkmcnt(3)
    v_mfma_f32_32x32x16_bf16 v[176:191], v[24:27], v[172:175], v[176:191]
    s_waitcnt vmcnt(14)
    s_barrier
    buffer_load_dwordx2 v[40:41], v19, s[32:35], 0 offen sc1
    ds_read_b128 v[144:147], v20 offset:4096
    ds_read_b128 v[148:151], v21 offset:4096
    ds_read_b64_tr_b16 v[160:161], v16 offset:20480
    ds_read_b64_tr_b16 v[162:163], v16 offset:20992
    ds_read_b64_tr_b16 v[164:165], v16 offset:21504
    ds_read_b64_tr_b16 v[166:167], v16 offset:22016
    ds_read_b64_tr_b16 v[168:169], v16 offset:22528
    ds_read_b64_tr_b16 v[170:171], v16 offset:23040
    ds_read_b64_tr_b16 v[172:173], v16 offset:23552
    ds_read_b64_tr_b16 v[174:175], v16 offset:24064
    ds_read_b128 v[88:91], v42 offset:20480
    ds_read_b128 v[92:95], v42 offset:53248
    ds_read_b128 v[132:135], v43 offset:20480
    s_waitcnt lgkmcnt(12)
    v_lshlrev_b32 v46, 16, v144
    v_and_b32 v47, 0xffff0000, v144
    v_fmac_f32 v36, v46, v46
    v_fmac_f32 v44, v47, v47
    v_add_f32 v37, v37, v46
    v_add_f32 v45, v45, v47
    v_lshlrev_b32 v46, 16, v145
    v_and_b32 v47, 0xffff0000, v145
    v_fmac_f32 v36, v46, v46
    v_fmac_f32 v44, v47, v47
    v_add_f32 v37, v37, v46
    v_add_f32 v45, v45, v47
    s_waitcnt lgkmcnt(9)
    v_mfma_f32_32x32x16_bf16 v[176:191], v[24:27], v[160:163], v[176:191]
    v_lshlrev_b32 v46, 16, v146
    v_and_b32 v47, 0xffff0000, v146
    v_fmac_f32 v36, v46, v46
    v_fmac_f32 v44, v47, v47
    v_add_f32 v37, v37, v46
    v_add_f32 v45, v45, v47
    v_lshlrev_b32 v46, 16, v147
    v_and_b32 v47, 0xffff0000, v147
    v_fmac_f32 v36, v46, v46
    v_fmac_f32 v44, v47, v47
    v_add_f32 v37, v37, v46
    v_add_f32 v45, v45, v47
    s_waitcnt lgkmcnt(7)
    v_mfma_f32_32x32x16_bf16 v[176:191], v[24:27], v[164:167], v[176:191]
    v_lshlrev_b32 v46, 16, v148
    v_and_b32 v47, 0xffff0000, v148
    v_fmac_f32 v36, v46, v46
    v_fmac_f32 v44, v47, v47
    v_add_f32 v37, v37, v46
    v_add_f32 v45, v45, v47
    v_lshlrev_b32 v46, 16, v149
    v_and_b32 v47, 0xffff0000, v149
    v_fmac_f32 v36, v46, v46
    v_fmac_f32 v44, v47, v47
    v_add_f32 v37, v37, v46
    v_add_f32 v45, v45, v47
    s_waitcnt lgkmcnt(5)
    v_mfma_f32_32x32x16_bf16 v[176:191], v[24:27], v[168:171], v[176:191]
    v_lshlrev_b32 v46, 16, v150
    v_and_b32 v47, 0xffff0000, v150
    v_fmac_f32 v36, v46, v46
    v_fmac_f32 v44, v47, v47
    v_add_f32 v37, v37, v46
    v_add_f32 v45, v45, v47
    v_lshlrev_b32 v46, 16, v151
    v_and_b32 v47, 0xffff0000, v151
    v_fmac_f32 v36, v46, v46
    v_fmac_f32 v44, v47, v47
    v_add_f32 v37, v37, v46
    v_add_f32 v45, v45, v47
    s_waitcnt lgkmcnt(3)
    v_mfma_f32_32x32x16_bf16 v[176:191], v[24:27], v[172:175], v[176:191]
    s_waitcnt vmcnt(8)
    s_barrier
    s_lshl_b32 s58, s2, 2
    s_add_u32 s58, s58, s36
    s_mul_i32 s57, s58, 512
    s_bfm_b64 exec, 4, 0
    buffer_load_dword v250, v14, s[12:15], s57 offen
    s_mov_b64 exec, -1
    s_mul_i32 s57, s58, 1408
    s_bfm_b64 exec, 11, 0
    buffer_load_dword v250, v14, s[16:19], s57 offen
    s_mov_b64 exec, -1
    s_mul_i32 s57, s58, 1408
    s_bfm_b64 exec, 11, 0
    buffer_load_dword v250, v14, s[20:23], s57 offen
    s_mov_b64 exec, -1
    ds_read_b128 v[144:147], v20 offset:8192
    ds_read_b128 v[148:151], v21 offset:8192
    ds_read_b64_tr_b16 v[160:161], v16 offset:24576
    ds_read_b64_tr_b16 v[162:163], v16 offset:25088
    ds_read_b64_tr_b16 v[164:165], v16 offset:25600
    ds_read_b64_tr_b16 v[166:167], v16 offset:26112
    ds_read_b64_tr_b16 v[168:169], v16 offset:26624
    ds_read_b64_tr_b16 v[170:171], v16 offset:27136
    ds_read_b64_tr_b16 v[172:173], v16 offset:27648
    ds_read_b64_tr_b16 v[174:175], v16 offset:28160
    ds_read_b128 v[96:99], v42 offset:24576
    ds_read_b128 v[100:103], v42 offset:57344
    ds_read_b128 v[136:139], v43 offset:24576
    s_waitcnt lgkmcnt(12)
    v_lshlrev_b32 v46, 16, v144
    v_and_b32 v47, 0xffff0000, v144
    v_fmac_f32 v36, v46, v46
    v_fmac_f32 v44, v47, v47
    v_add_f32 v37, v37, v46
    v_add_f32 v45, v45, v47
    v_lshlrev_b32 v46, 16, v145
    v_and_b32 v47, 0xffff0000, v145
    v_fmac_f32 v36, v46, v46
    v_fmac_f32 v44, v47, v47
    v_add_f32 v37, v37, v46
    v_add_f32 v45, v45, v47
    s_waitcnt lgkmcnt(9)
    v_mfma_f32_32x32x16_bf16 v[176:191], v[24:27], v[160:163], v[176:191]
    v_lshlrev_b32 v46, 16, v146
    v_and_b32 v47, 0xffff0000, v146
    v_fmac_f32 v36, v46, v46
    v_fmac_f32 v44, v47, v47
    v_add_f32 v37, v37, v46
    v_add_f32 v45, v45, v47
    v_lshlrev_b32 v46, 16, v147
    v_and_b32 v47, 0xffff0000, v147
    v_fmac_f32 v36, v46, v46
    v_fmac_f32 v44, v47, v47
    v_add_f32 v37, v37, v46
    v_add_f32 v45, v45, v47
    s_waitcnt lgkmcnt(7)
    v_mfma_f32_32x32x16_bf16 v[176:191], v[24:27], v[164:167], v[176:191]
    v_lshlrev_b32 v46, 16, v148
    v_and_b32 v47, 0xffff0000, v148
    v_fmac_f32 v36, v46, v46
    v_fmac_f32 v44, v47, v47
    v_add_f32 v37, v37, v46
    v_add_f32 v45, v45, v47
    v_lshlrev_b32 v46, 16, v149
    v_and_b32 v47, 0xffff0000, v149
    v_fmac_f32 v36, v46, v46
    v_fmac_f32 v44, v47, v47
    v_add_f32 v37, v37, v46
    v_add_f32 v45, v45, v47
    s_waitcnt lgkmcnt(5)
    v_mfma_f32_32x32x16_bf16 v[176:191], v[24:27], v[168:171], v[176:191]
    v_lshlrev_b32 v46, 16, v150
    v_and_b32 v47, 0xffff0000, v150
    v_fmac_f32 v36, v46, v46
    v_fmac_f32 v44, v47, v47
    v_add_f32 v37, v37, v46
    v_add_f32 v45, v45, v47
    v_lshlrev_b32 v46, 16, v151
    v_and_b32 v47, 0xffff0000, v151
    v_fmac_f32 v36, v46, v46
    v_fmac_f32 v44, v47, v47
    v_add_f32 v37, v37, v46
    v_add_f32 v45, v45, v47
    s_waitcnt lgkmcnt(3)
    v_mfma_f32_32x32x16_bf16 v[176:191], v[24:27], v[172:175], v[176:191]
    v_add_f32 v36, v36, v44
    v_add_f32 v37, v37, v45
    ds_write_b64 v13, v[36:37]
    s_waitcnt vmcnt(4) lgkmcnt(0)
    s_barrier
    s_mul_i32 s57, 0, 0
    s_bfm_b64 exec, 18, 0
    buffer_load_dword v250, v15, s[28:31], s57 offen
    s_mov_b64 exec, -1
    ds_read_b64_tr_b16 v[160:161], v16 offset:28672
    ds_read_b64_tr_b16 v[162:163], v16 offset:29184
    ds_read_b64_tr_b16 v[164:165], v16 offset:29696
    ds_read_b64_tr_b16 v[166:167], v16 offset:30208
    ds_read_b64_tr_b16 v[168:169], v16 offset:30720
    ds_read_b64_tr_b16 v[170:171], v16 offset:31232
    ds_read_b64_tr_b16 v[172:173], v16 offset:31744
    ds_read_b64_tr_b16 v[174:175], v16 offset:32256
    ds_read_b128 v[104:107], v42 offset:28672
    ds_read_b128 v[108:111], v42 offset:61440
    ds_read_b128 v[140:143], v43 offset:28672
    s_mul_i32 s57, s77, 2048
    s_bfm_b64 exec, 16, 0
    buffer_load_dword v250, v14, s[24:27], s57 offen
    s_mov_b64 exec, -1
    s_waitcnt lgkmcnt(9)
    s_nop 2
    v_mfma_f32_32x32x16_bf16 v[176:191], v[24:27], v[160:163], v[176:191]
    s_waitcnt lgkmcnt(7)
    v_mfma_f32_32x32x16_bf16 v[176:191], v[24:27], v[164:167], v[176:191]
    s_waitcnt lgkmcnt(5)
    v_mfma_f32_32x32x16_bf16 v[176:191], v[24:27], v[168:171], v[176:191]
    s_waitcnt lgkmcnt(3)
    v_mfma_f32_32x32x16_bf16 v[176:191], v[24:27], v[172:175], v[176:191]
    s_nop 11
    v_cvt_pk_bf16_f32 v28, v176, v176
    v_and_b32 v28, 0xffff0000, v28
    v_sub_f32 v29, v176, v28
    v_cvt_pk_bf16_f32 v38, v28, v29
    v_cvt_pk_bf16_f32 v39, v28, 0
    ds_write_b64 v13, v[38:39] offset:1024
    s_mov_b32 s61, 0
    s_mov_b32 s57, 0x01010101
    s_waitcnt vmcnt(5)
Lreg_3:
    v_dot4_u32_u8 v28, v40, s57, 0
    v_dot4_u32_u8 v28, v41, s57, v28
    s_nop 2
    v_cmp_ne_u32 vcc, 32, v28
    s_nop 3
    s_cbranch_vccnz Lagain_5
    v_readlane_b32 s90, v40, s37
    v_readlane_b32 s91, v41, s37
    s_lshl_b32 s57, s41, 3
    s_nop 2
    s_lshr_b64 s[90:91], s[90:91], s57
    s_and_b32 s90, s90, 0xff
    s_cmp_eq_u32 s90, 32
    s_cselect_b32 s40, 1, 0
    v_mov_b32 v28, s40
    ds_write_b32 v13, v28 offset:2048
    s_waitcnt lgkmcnt(0)
    s_barrier
    s_cmp_lt_u32 s36, 2
    s_cbranch_scc0 Lh23_6
    s_lshl_b32 s59, s36, 11
    v_add_u32 v11, s59, v1
    s_mov_b32 s59, 10354688
    s_waitcnt lgkmcnt(0)
    s_barrier
    ds_read_b128 v[144:147], v11 offset:49152
    ds_read_b128 v[148:151], v11 offset:50176
    ds_read_b128 v[152:155], v11 offset:53248
    ds_read_b128 v[156:159], v11 offset:54272
    ds_read_b128 v[160:163], v11 offset:57344
    ds_read_b128 v[164:167], v11 offset:58368
    ds_read_b128 v[168:171], v11 offset:61440
    ds_read_b128 v[172:175], v11 offset:62464
    s_waitcnt lgkmcnt(4)
    v_add_f32 v144, v144, v152
    v_add_f32 v145, v145, v153
    v_add_f32 v146, v146, v154
    v_add_f32 v147, v147, v155
    v_add_f32 v148, v148, v156
    v_add_f32 v149, v149, v157
    v_add_f32 v150, v150, v158
    v_add_f32 v151, v151, v159
    s_waitcnt lgkmcnt(2)
    v_add_f32 v144, v144, v160
    v_add_f32 v145, v145, v161
    v_add_f32 v146, v146, v162
    v_add_f32 v147, v147, v163
    v_add_f32 v148, v148, v164
    v_add_f32 v149, v149, v165
    v_add_f32 v150, v150, v166
    v_add_f32 v151, v151, v167
    s_waitcnt lgkmcnt(0)
    v_add_f32 v144, v144, v168
    v_add_f32 v145, v145, v169
    v_add_f32 v146, v146, v170
    v_add_f32 v147, v147, v171
    v_add_f32 v148, v148, v172
    v_add_f32 v149, v149, v173
    v_add_f32 v150, v150, v174
    v_add_f32 v151, v151, v175
    v_cvt_pk_bf16_f32 v152, v144, v145
    v_cvt_pk_bf16_f32 v153, v146, v147
    v_cvt_pk_bf16_f32 v154, v148, v149
    v_cvt_pk_bf16_f32 v155, v150, v151
    v_min_u32 v152, s89, v152
    v_min_u32 v153, s89, v153
    v_min_u32 v154, s89, v154
    v_min_u32 v155, s89, v155
    s_mov_b64 exec, s[78:79]
    buffer_store_dwordx4 v[152:155], v10, s[28:31], s59 offen sc1
    s_mov_b64 exec, -1
    s_barrier
    s_setprio 0
    s_add_u32 s59, s54, 0
    s_add_u32 s60, s55, 0
    v_add_u32 v11, s56, v9
    v_add_u32 v12, s65, v9
    s_add_u32 s58, s59, 4096
    s_waitcnt vmcnt(0)
    s_mov_b32 s61, 0
Lpp_8:
    buffer_load_dwordx4 v[144:147], v1, s[28:31], s59 offen offset:0 sc1
    buffer_load_dwordx4 v[148:151], v1, s[28:31], s59 offen offset:1024 sc1
    buffer_load_dwordx4 v[152:155], v1, s[28:31], s59 offen offset:2048 sc1
    buffer_load_dwordx4 v[156:159], v1, s[28:31], s59 offen offset:3072 sc1
    buffer_load_dword v32, v9, s[28:31], s60 offen offset:0 sc1
    buffer_load_dwordx4 v[160:163], v1, s[28:31], s58 offen offset:0 sc1
    buffer_load_dwordx4 v[164:167], v1, s[28:31], s58 offen offset:1024 sc1
    buffer_load_dwordx4 v[168:171], v1, s[28:31], s58 offen offset:2048 sc1
    buffer_load_dwordx4 v[172:175], v1, s[28:31], s58 offen offset:3072 sc1
    buffer_load_dword v33, v9, s[28:31], s60 offen offset:256 sc1
    s_add_u32 s61, s61, 1
    s_cmp_gt_u32 s61, 262144
    s_cbranch_scc1 L_end
    s_waitcnt vmcnt(5)
    v_max3_u32 v176, v32, v144, v145
    v_max3_u32 v176, v176, v146, v147
    v_max3_u32 v176, v176, v148, v149
    v_max3_u32 v176, v176, v150, v151
    v_max3_u32 v176, v176, v152, v153
    v_max3_u32 v176, v176, v154, v155
    v_max3_u32 v176, v176, v156, v157
    v_max3_u32 v176, v176, v158, v159
    s_waitcnt vmcnt(0)
    v_max_u32 v176, v176, v33
    v_max3_u32 v176, v176, v160, v161
    v_max3_u32 v176, v176, v162, v163
    v_max3_u32 v176, v176, v164, v165
    v_max3_u32 v176, v176, v166, v167
    v_max3_u32 v176, v176, v168, v169
    v_max3_u32 v176, v176, v170, v171
    v_max3_u32 v176, v176, v172, v173
    v_max3_u32 v176, v176, v174, v175
    v_cmp_eq_u32 vcc, -1, v176
    s_nop 3
    s_cbranch_vccnz Lpp_8
    s_setprio 2
    v_dot2_f32_bf16 v176, v144, s87, 0
    v_dot2_f32_bf16 v177, v144, s88, 0
    v_dot2_f32_bf16 v178, v145, s87, 0
    v_dot2_f32_bf16 v179, v145, s88, 0
    v_dot2_f32_bf16 v180, v146, s87, 0
    v_dot2_f32_bf16 v181, v146, s88, 0
    v_dot2_f32_bf16 v182, v147, s87, 0
    v_dot2_f32_bf16 v183, v147, s88, 0
    v_dot2_f32_bf16 v176, v148, s87, v176
    v_dot2_f32_bf16 v177, v148, s88, v177
    v_dot2_f32_bf16 v178, v149, s87, v178
    v_dot2_f32_bf16 v179, v149, s88, v179
    v_dot2_f32_bf16 v180, v150, s87, v180
    v_dot2_f32_bf16 v181, v150, s88, v181
    v_dot2_f32_bf16 v182, v151, s87, v182
    v_dot2_f32_bf16 v183, v151, s88, v183
    v_dot2_f32_bf16 v176, v152, s87, v176
    v_dot2_f32_bf16 v177, v152, s88, v177
    v_dot2_f32_bf16 v178, v153, s87, v178
    v_dot2_f32_bf16 v179, v153, s88, v179
    v_dot2_f32_bf16 v180, v154, s87, v180
    v_dot2_f32_bf16 v181, v154, s88, v181
    v_dot2_f32_bf16 v182, v155, s87, v182
    v_dot2_f32_bf16 v183, v155, s88, v183
    v_dot2_f32_bf16 v176, v156, s87, v176
    v_dot2_f32_bf16 v177, v156, s88, v177
    v_dot2_f32_bf16 v178, v157, s87, v178
    v_dot2_f32_bf16 v179, v157, s88, v179
    v_dot2_f32_bf16 v180, v158, s87, v180
    v_dot2_f32_bf16 v181, v158, s88, v181
    v_dot2_f32_bf16 v182, v159, s87, v182
    v_dot2_f32_bf16 v183, v159, s88, v183
    v_lshlrev_b32 v34, 16, v32
    v_and_b32 v35, 0xffff0000, v32
    v_dot2_f32_bf16 v184, v160, s87, 0
    v_dot2_f32_bf16 v185, v160, s88, 0
    v_dot2_f32_bf16 v186, v161, s87, 0
    v_dot2_f32_bf16 v187, v161, s88, 0
    v_dot2_f32_bf16 v188, v162, s87, 0
    v_dot2_f32_bf16 v189, v162, s88, 0
    v_dot2_f32_bf16 v190, v163, s87, 0
    v_dot2_f32_bf16 v191, v163, s88, 0
    v_dot2_f32_bf16 v184, v164, s87, v184
    v_dot2_f32_bf16 v185, v164, s88, v185
    v_dot2_f32_bf16 v186, v165, s87, v186
    v_dot2_f32_bf16 v187, v165, s88, v187
    v_dot2_f32_bf16 v188, v166, s87, v188
    v_dot2_f32_bf16 v189, v166, s88, v189
    v_dot2_f32_bf16 v190, v167, s87, v190
    v_dot2_f32_bf16 v191, v167, s88, v191
    v_dot2_f32_bf16 v184, v168, s87, v184
    v_dot2_f32_bf16 v185, v168, s88, v185
    v_dot2_f32_bf16 v186, v169, s87, v186
    v_dot2_f32_bf16 v187, v169, s88, v187
    v_dot2_f32_bf16 v188, v170, s87, v188
    v_dot2_f32_bf16 v189, v170, s88, v189
    v_dot2_f32_bf16 v190, v171, s87, v190
    v_dot2_f32_bf16 v191, v171, s88, v191
    v_dot2_f32_bf16 v184, v172, s87, v184
    v_dot2_f32_bf16 v185, v172, s88, v185
    v_dot2_f32_bf16 v186, v173, s87, v186
    v_dot2_f32_bf16 v187, v173, s88, v187
    v_dot2_f32_bf16 v188, v174, s87, v188
    v_dot2_f32_bf16 v189, v174, s88, v189
    v_dot2_f32_bf16 v190, v175, s87, v190
    v_dot2_f32_bf16 v191, v175, s88, v191
    v_lshlrev_b32 v36, 16, v33
    v_and_b32 v37, 0xffff0000, v33
    v_permlane32_swap_b32 v176, v180
    v_permlane32_swap_b32 v177, v181
    v_permlane32_swap_b32 v178, v182
    v_permlane32_swap_b32 v179, v183
    v_permlane32_swap_b32 v184, v188
    v_permlane32_swap_b32 v185, v189
    v_permlane32_swap_b32 v186, v190
    v_permlane32_swap_b32 v187, v191
    v_add_f32_dpp v34, v34, v34 row_ror:8 row_mask:0xf bank_mask:0xf
    v_add_f32_dpp v35, v35, v35 row_ror:8 row_mask:0xf bank_mask:0xf
    v_add_f32_dpp v36, v36, v36 row_ror:8 row_mask:0xf bank_mask:0xf
    v_add_f32_dpp v37, v37, v37 row_ror:8 row_mask:0xf bank_mask:0xf
    v_add_f32 v176, v176, v180
    v_add_f32 v177, v177, v181
    v_add_f32 v178, v178, v182
    v_add_f32 v179, v179, v183
    v_add_f32 v184, v184, v188
    v_add_f32 v185, v185, v189
    v_add_f32 v186, v186, v190
    v_add_f32 v187, v187, v191
    v_add_f32_dpp v34, v34, v34 row_ror:4 row_mask:0xf bank_mask:0xf
    v_add_f32_dpp v35, v35, v35 row_ror:4 row_mask:0xf bank_mask:0xf
    v_add_f32_dpp v36, v36, v36 row_ror:4 row_mask:0xf bank_mask:0xf
    v_add_f32_dpp v37, v37, v37 row_ror:4 row_mask:0xf bank_mask:0xf
    v_permlane16_swap_b32 v176, v178
    v_permlane16_swap_b32 v177, v179
    v_permlane16_swap_b32 v184, v186
    v_permlane16_swap_b32 v185, v187
    v_add_f32_dpp v34, v34, v34 row_ror:2 row_mask:0xf bank_mask:0xf
    v_add_f32_dpp v35, v35, v35 row_ror:2 row_mask:0xf bank_mask:0xf
    v_add_f32_dpp v36, v36, v36 row_ror:2 row_mask:0xf bank_mask:0xf
    v_add_f32_dpp v37, v37, v37 row_ror:2 row_mask:0xf bank_mask:0xf
    v_add_f32 v176, v176, v178
    v_add_f32 v177, v177, v179
    v_add_f32 v184, v184, v186
    v_add_f32 v185, v185, v187
    v_add_f32_dpp v34, v34, v34 row_ror:1 row_mask:0xf bank_mask:0xf
    v_add_f32_dpp v35, v35, v35 row_ror:1 row_mask:0xf bank_mask:0xf
    v_add_f32_dpp v36, v36, v36 row_ror:1 row_mask:0xf bank_mask:0xf
    v_add_f32_dpp v37, v37, v37 row_ror:1 row_mask:0xf bank_mask:0xf
    v_cvt_pk_bf16_f32 v176, v176, v177
    v_cvt_pk_bf16_f32 v34, v34, v35
    v_cvt_pk_bf16_f32 v184, v184, v185
    v_cvt_pk_bf16_f32 v36, v36, v37
    ds_write_b32 v11, v176 offset:0
    ds_write_b32 v12, v34 offset:0
    ds_write_b32 v11, v184 offset:512
    ds_write_b32 v12, v36 offset:512
    s_waitcnt lgkmcnt(0)
    s_setprio 0
    s_barrier
    s_barrier
    s_branch Lhjoin_7
Lh23_6:
    s_setprio 0
    s_add_u32 m0, s46, 0
    s_add_u32 s39, s45, 0
    buffer_load_dwordx4 v5, s[16:19], s39 offen lds
    s_add_u32 m0, s46, 1024
    s_add_u32 s39, s45, 0
    buffer_load_dwordx4 v6, s[16:19], s39 offen lds
    s_add_u32 m0, s46, 2048
    s_add_u32 s39, s45, 0
    buffer_load_dwordx4 v7, s[16:19], s39 offen lds
    s_add_u32 m0, s46, 6144
    s_add_u32 s39, s45, 88064
    buffer_load_dwordx4 v5, s[16:19], s39 offen lds
    s_add_u32 s39, s45, 87040
    buffer_load_dwordx4 v6, s[16:19], s39 offen offset:1024 lds
    s_add_u32 s39, s45, 86016
    buffer_load_dwordx4 v7, s[16:19], s39 offen offset:2048 lds
    s_add_u32 m0, s46, 12288
    s_add_u32 s39, s45, 176128
    buffer_load_dwordx4 v5, s[16:19], s39 offen lds
    s_add_u32 s39, s45, 175104
    buffer_load_dwordx4 v6, s[16:19], s39 offen offset:1024 lds
    s_add_u32 s39, s45, 174080
    buffer_load_dwordx4 v7, s[16:19], s39 offen offset:2048 lds
    s_add_u32 m0, s46, 18432
    s_add_u32 s39, s45, 264192
    buffer_load_dwordx4 v5, s[16:19], s39 offen lds
    s_add_u32 s39, s45, 263168
    buffer_load_dwordx4 v6, s[16:19], s39 offen offset:1024 lds
    s_add_u32 s39, s45, 262144
    buffer_load_dwordx4 v7, s[16:19], s39 offen offset:2048 lds
    s_add_u32 m0, s46, 24576
    s_add_u32 s39, s45, 352256
    buffer_load_dwordx4 v5, s[16:19], s39 offen lds
    s_add_u32 s39, s45, 351232
    buffer_load_dwordx4 v6, s[16:19], s39 offen offset:1024 lds
    s_add_u32 s39, s45, 350208
    buffer_load_dwordx4 v7, s[16:19], s39 offen offset:2048 lds
    s_add_u32 m0, s46, 30720
    s_add_u32 s39, s45, 440320
    buffer_load_dwordx4 v5, s[16:19], s39 offen lds
    s_add_u32 s39, s45, 439296
    buffer_load_dwordx4 v6, s[16:19], s39 offen offset:1024 lds
    s_add_u32 s39, s45, 438272
    buffer_load_dwordx4 v7, s[16:19], s39 offen offset:2048 lds
    s_add_u32 m0, s46, 36864
    s_add_u32 s39, s45, 528384
    buffer_load_dwordx4 v5, s[16:19], s39 offen lds
    s_add_u32 s39, s45, 527360
    buffer_load_dwordx4 v6, s[16:19], s39 offen offset:1024 lds
    s_add_u32 s39, s45, 526336
    buffer_load_dwordx4 v7, s[16:19], s39 offen offset:2048 lds
    s_add_u32 m0, s46, 43008
    s_add_u32 s39, s45, 616448
    buffer_load_dwordx4 v5, s[16:19], s39 offen lds
    s_add_u32 s39, s45, 615424
    buffer_load_dwordx4 v6, s[16:19], s39 offen offset:1024 lds
    s_add_u32 s39, s45, 614400
    buffer_load_dwordx4 v7, s[16:19], s39 offen offset:2048 lds
    s_waitcnt lgkmcnt(0)
    s_barrier
    s_barrier
    s_add_u32 m0, s48, 0
    s_add_u32 s39, s47, 0
    buffer_load_dwordx4 v8, s[12:15], s39 offen lds
    s_add_u32 s39, s47, 7168
    buffer_load_dwordx4 v8, s[12:15], s39 offen offset:1024 lds
    s_add_u32 s39, s47, 14336
    buffer_load_dwordx4 v8, s[12:15], s39 offen offset:2048 lds
    s_add_u32 s39, s47, 21504
    buffer_load_dwordx4 v8, s[12:15], s39 offen offset:3072 lds
    s_add_u32 m0, s48, 4096
    s_add_u32 s39, s47, 32768
    buffer_load_dwordx4 v8, s[12:15], s39 offen lds
    s_add_u32 s39, s47, 39936
    buffer_load_dwordx4 v8, s[12:15], s39 offen offset:1024 lds
    s_add_u32 s39, s47, 47104
    buffer_load_dwordx4 v8, s[12:15], s39 offen offset:2048 lds
    s_add_u32 s39, s47, 54272
    buffer_load_dwordx4 v8, s[12:15], s39 offen offset:3072 lds
    s_add_u32 m0, s48, 8192
    s_add_u32 s39, s47, 65536
    buffer_load_dwordx4 v8, s[12:15], s39 offen lds
    s_add_u32 s39, s47, 72704
    buffer_load_dwordx4 v8, s[12:15], s39 offen offset:1024 lds
    s_add_u32 s39, s47, 79872
    buffer_load_dwordx4 v8, s[12:15], s39 offen offset:2048 lds
    s_add_u32 s39, s47, 87040
    buffer_load_dwordx4 v8, s[12:15], s39 offen offset:3072 lds
    s_add_u32 m0, s48, 12288
    s_add_u32 s39, s47, 98304
    buffer_load_dwordx4 v8, s[12:15], s39 offen lds
    s_add_u32 s39, s47, 105472
    buffer_load_dwordx4 v8, s[12:15], s39 offen offset:1024 lds
    s_add_u32 s39, s47, 112640
    buffer_load_dwordx4 v8, s[12:15], s39 offen offset:2048 lds
    s_add_u32 s39, s47, 119808
    buffer_load_dwordx4 v8, s[12:15], s39 offen offset:3072 lds
    s_add_u32 m0, s48, 16384
    s_add_u32 s39, s47, 131072
    buffer_load_dwordx4 v8, s[12:15], s39 offen lds
    s_add_u32 s39, s47, 138240
    buffer_load_dwordx4 v8, s[12:15], s39 offen offset:1024 lds
    s_add_u32 s39, s47, 145408
    buffer_load_dwordx4 v8, s[12:15], s39 offen offset:2048 lds
    s_add_u32 s39, s47, 152576
    buffer_load_dwordx4 v8, s[12:15], s39 offen offset:3072 lds
    s_add_u32 m0, s48, 20480
    s_add_u32 s39, s47, 163840
    buffer_load_dwordx4 v8, s[12:15], s39 offen lds
    s_add_u32 s39, s47, 171008
    buffer_load_dwordx4 v8, s[12:15], s39 offen offset:1024 lds
    s_add_u32 s39, s47, 178176
    buffer_load_dwordx4 v8, s[12:15], s39 offen offset:2048 lds
    s_add_u32 s39, s47, 185344
    buffer_load_dwordx4 v8, s[12:15], s39 offen offset:3072 lds
    s_add_u32 m0, s48, 24576
    s_add_u32 s39, s47, 196608
    buffer_load_dwordx4 v8, s[12:15], s39 offen lds
    s_add_u32 s39, s47, 203776
    buffer_load_dwordx4 v8, s[12:15], s39 offen offset:1024 lds
    s_add_u32 s39, s47, 210944
    buffer_load_dwordx4 v8, s[12:15], s39 offen offset:2048 lds
    s_add_u32 s39, s47, 218112
    buffer_load_dwordx4 v8, s[12:15], s39 offen offset:3072 lds
    s_add_u32 m0, s48, 28672
    s_add_u32 s39, s47, 229376
    buffer_load_dwordx4 v8, s[12:15], s39 offen lds
    s_add_u32 s39, s47, 236544
    buffer_load_dwordx4 v8, s[12:15], s39 offen offset:1024 lds
    s_add_u32 s39, s47, 243712
    buffer_load_dwordx4 v8, s[12:15], s39 offen offset:2048 lds
    s_add_u32 s39, s47, 250880
    buffer_load_dwordx4 v8, s[12:15], s39 offen offset:3072 lds
    s_lshl_b32 s58, s38, 1
    s_add_u32 s58, s58, s36
    s_sub_u32 s58, s58, 2
    s_mul_i32 s57, s58, 11008
    s_add_u32 s57, s57, 704512
    s_mov_b64 exec, -1
    buffer_load_dword v250, v14, s[16:19], s57 offen
    s_mov_b64 exec, -1
    s_mul_i32 s57, s58, 11008
    s_add_u32 s57, s57, 712704
    s_bfm_b64 exec, 22, 0
    buffer_load_dword v250, v14, s[16:19], s57 offen
    s_mov_b64 exec, -1
    s_waitcnt vmcnt(2)
    s_barrier
    s_barrier
    s_add_u32 m0, s46, 49152
    s_add_u32 s39, s45, 704512
    buffer_load_dwordx4 v5, s[16:19], s39 offen lds
    s_add_u32 s39, s45, 703488
    buffer_load_dwordx4 v6, s[16:19], s39 offen offset:1024 lds
    s_add_u32 s39, s45, 702464
    buffer_load_dwordx4 v7, s[16:19], s39 offen offset:2048 lds
    s_add_u32 m0, s46, 55296
    s_add_u32 s39, s45, 792576
    buffer_load_dwordx4 v5, s[16:19], s39 offen lds
    s_add_u32 s39, s45, 791552
    buffer_load_dwordx4 v6, s[16:19], s39 offen offset:1024 lds
    s_add_u32 s39, s45, 790528
    buffer_load_dwordx4 v7, s[16:19], s39 offen offset:2048 lds
    s_add_u32 m0, s46, 61440
    s_add_u32 s39, s45, 880640
    buffer_load_dwordx4 v5, s[16:19], s39 offen lds
    s_add_u32 s39, s45, 879616
    buffer_load_dwordx4 v6, s[16:19], s39 offen offset:1024 lds
    s_add_u32 s39, s45, 878592
    buffer_load_dwordx4 v7, s[16:19], s39 offen offset:2048 lds
    s_add_u32 m0, s46, 67584
    s_add_u32 s39, s45, 968704
    buffer_load_dwordx4 v5, s[16:19], s39 offen lds
    s_add_u32 s39, s45, 967680
    buffer_load_dwordx4 v6, s[16:19], s39 offen offset:1024 lds
    s_add_u32 s39, s45, 966656
    buffer_load_dwordx4 v7, s[16:19], s39 offen offset:2048 lds
    s_add_u32 m0, s46, 73728
    s_add_u32 s39, s45, 1056768
    buffer_load_dwordx4 v5, s[16:19], s39 offen lds
    s_add_u32 s39, s45, 1055744
    buffer_load_dwordx4 v6, s[16:19], s39 offen offset:1024 lds
    s_add_u32 s39, s45, 1054720
    buffer_load_dwordx4 v7, s[16:19], s39 offen offset:2048 lds
    s_add_u32 m0, s46, 79872
    s_add_u32 s39, s45, 1144832
    buffer_load_dwordx4 v5, s[16:19], s39 offen lds
    s_add_u32 s39, s45, 1143808
    buffer_load_dwordx4 v6, s[16:19], s39 offen offset:1024 lds
    s_add_u32 s39, s45, 1142784
    buffer_load_dwordx4 v7, s[16:19], s39 offen offset:2048 lds
    s_add_u32 m0, s46, 86016
    s_add_u32 s39, s45, 1232896
    buffer_load_dwordx4 v5, s[16:19], s39 offen lds
    s_add_u32 s39, s45, 1231872
    buffer_load_dwordx4 v6, s[16:19], s39 offen offset:1024 lds
    s_add_u32 s39, s45, 1230848
    buffer_load_dwordx4 v7, s[16:19], s39 offen offset:2048 lds
    s_add_u32 m0, s46, 92160
    s_add_u32 s39, s45, 1320960
    buffer_load_dwordx4 v5, s[16:19], s39 offen lds
    s_add_u32 s39, s45, 1319936
    buffer_load_dwordx4 v6, s[16:19], s39 offen offset:1024 lds
    s_add_u32 s39, s45, 1318912
    buffer_load_dwordx4 v7, s[16:19], s39 offen offset:2048 lds
Lhjoin_7:
    s_barrier
    s_barrier
    s_waitcnt vmcnt(0)
    s_barrier
    s_setprio 1
    v_add_u32 v11, 49152, v18
    v_mov_b32 v28, 0
    v_mov_b32 v29, 0
    s_mul_i32 s57, s36, 12288
    v_add_u32 v13, s57, v1
    v_add_u32 v12, 49152, v13
    s_min_u32 s57, s36, 2
    s_lshl_b32 s57, s57, 6
    s_mul_i32 s58, s36, 12288
    s_sub_u32 s57, s58, s57
    v_add_u32 v13, s57, v18
    v_add_u32 v12, 49152, v13
    ds_read_b64_tr_b16 v[32:33], v18 offset:0
    ds_read_b64_tr_b16 v[34:35], v18 offset:1536
    ds_read_b64_tr_b16 v[36:37], v18 offset:3072
    ds_read_b64_tr_b16 v[38:39], v18 offset:4608
    ds_read_b64_tr_b16 v[40:41], v18 offset:6144
    ds_read_b64_tr_b16 v[42:43], v18 offset:7680
    s_waitcnt lgkmcnt(4)
    v_lshlrev_b32 v30, 16, v32
    v_and_b32 v31, 0xffff0000, v32
    v_add_f32 v28, v28, v30
    v_add_f32 v29, v29, v31
    v_lshlrev_b32 v30, 16, v33
    v_and_b32 v31, 0xffff0000, v33
    v_add_f32 v28, v28, v30
    v_add_f32 v29, v29, v31
    v_lshlrev_b32 v30, 16, v34
    v_and_b32 v31, 0xffff0000, v34
    v_add_f32 v28, v28, v30
    v_add_f32 v29, v29, v31
    v_lshlrev_b32 v30, 16, v35
    v_and_b32 v31, 0xffff0000, v35
    v_add_f32 v28, v28, v30
    v_add_f32 v29, v29, v31
    ds_read_b64_tr_b16 v[44:45], v18 offset:9216
    ds_read_b64_tr_b16 v[46:47], v18 offset:10752
    ds_read_b64_tr_b16 v[144:145], v13 offset:0
    ds_read_b64_tr_b16 v[146:147], v13 offset:1536
    s_waitcnt lgkmcnt(6)
    v_lshlrev_b32 v30, 16, v36
    v_and_b32 v31, 0xffff0000, v36
    v_add_f32 v28, v28, v30
    v_add_f32 v29, v29, v31
    v_lshlrev_b32 v30, 16, v37
    v_and_b32 v31, 0xffff0000, v37
    v_add_f32 v28, v28, v30
    v_add_f32 v29, v29, v31
    v_lshlrev_b32 v30, 16, v38
    v_and_b32 v31, 0xffff0000, v38
    v_add_f32 v28, v28, v30
    v_add_f32 v29, v29, v31
    v_lshlrev_b32 v30, 16, v39
    v_and_b32 v31, 0xffff0000, v39
    v_add_f32 v28, v28, v30
    v_add_f32 v29, v29, v31
    ds_read_b64_tr_b16 v[32:33], v18 offset:12288
    ds_read_b64_tr_b16 v[34:35], v18 offset:13824
    ds_read_b64_tr_b16 v[148:149], v13 offset:64
    ds_read_b64_tr_b16 v[150:151], v13 offset:1600
    s_waitcnt lgkmcnt(8)
    v_lshlrev_b32 v30, 16, v40
    v_and_b32 v31, 0xffff0000, v40
    v_add_f32 v28, v28, v30
    v_add_f32 v29, v29, v31
    v_lshlrev_b32 v30, 16, v41
    v_and_b32 v31, 0xffff0000, v41
    v_add_f32 v28, v28, v30
    v_add_f32 v29, v29, v31
    v_lshlrev_b32 v30, 16, v42
    v_and_b32 v31, 0xffff0000, v42
    v_add_f32 v28, v28, v30
    v_add_f32 v29, v29, v31
    v_lshlrev_b32 v30, 16, v43
    v_and_b32 v31, 0xffff0000, v43
    v_add_f32 v28, v28, v30
    v_add_f32 v29, v29, v31
    ds_read_b64_tr_b16 v[36:37], v18 offset:15360
    ds_read_b64_tr_b16 v[38:39], v18 offset:16896
    ds_read_b64_tr_b16 v[152:153], v13 offset:128
    ds_read_b64_tr_b16 v[154:155], v13 offset:1664
    s_waitcnt lgkmcnt(10)
    v_lshlrev_b32 v30, 16, v44
    v_and_b32 v31, 0xffff0000, v44
    v_add_f32 v28, v28, v30
    v_add_f32 v29, v29, v31
    v_lshlrev_b32 v30, 16, v45
    v_and_b32 v31, 0xffff0000, v45
    v_add_f32 v28, v28, v30
    v_add_f32 v29, v29, v31
    v_lshlrev_b32 v30, 16, v46
    v_and_b32 v31, 0xffff0000, v46
    v_add_f32 v28, v28, v30
    v_add_f32 v29, v29, v31
    v_lshlrev_b32 v30, 16, v47
    v_and_b32 v31, 0xffff0000, v47
    v_add_f32 v28, v28, v30
    v_add_f32 v29, v29, v31
    ds_read_b64_tr_b16 v[40:41], v18 offset:18432
    ds_read_b64_tr_b16 v[42:43], v18 offset:19968
    ds_read_b64_tr_b16 v[156:157], v13 offset:3072
    ds_read_b64_tr_b16 v[158:159], v13 offset:4608
    s_waitcnt lgkmcnt(10)
    v_lshlrev_b32 v30, 16, v32
    v_and_b32 v31, 0xffff0000, v32
    v_add_f32 v28, v28, v30
    v_add_f32 v29, v29, v31
    v_lshlrev_b32 v30, 16, v33
    v_and_b32 v31, 0xffff0000, v33
    v_add_f32 v28, v28, v30
    v_add_f32 v29, v29, v31
    v_lshlrev_b32 v30, 16, v34
    v_and_b32 v31, 0xffff0000, v34
    v_add_f32 v28, v28, v30
    v_add_f32 v29, v29, v31
    v_lshlrev_b32 v30, 16, v35
    v_and_b32 v31, 0xffff0000, v35
    v_add_f32 v28, v28, v30
    v_add_f32 v29, v29, v31
    ds_read_b64_tr_b16 v[44:45], v18 offset:21504
    ds_read_b64_tr_b16 v[46:47], v18 offset:23040
    ds_read_b64_tr_b16 v[160:161], v13 offset:3136
    ds_read_b64_tr_b16 v[162:163], v13 offset:4672
    s_waitcnt lgkmcnt(10)
    v_lshlrev_b32 v30, 16, v36
    v_and_b32 v31, 0xffff0000, v36
    v_add_f32 v28, v28, v30
    v_add_f32 v29, v29, v31
    v_lshlrev_b32 v30, 16, v37
    v_and_b32 v31, 0xffff0000, v37
    v_add_f32 v28, v28, v30
    v_add_f32 v29, v29, v31
    v_lshlrev_b32 v30, 16, v38
    v_and_b32 v31, 0xffff0000, v38
    v_add_f32 v28, v28, v30
    v_add_f32 v29, v29, v31
    v_lshlrev_b32 v30, 16, v39
    v_and_b32 v31, 0xffff0000, v39
    v_add_f32 v28, v28, v30
    v_add_f32 v29, v29, v31
    ds_read_b64_tr_b16 v[32:33], v18 offset:24576
    ds_read_b64_tr_b16 v[34:35], v18 offset:26112
    ds_read_b64_tr_b16 v[164:165], v13 offset:3200
    ds_read_b64_tr_b16 v[166:167], v13 offset:4736
    s_waitcnt lgkmcnt(10)
    v_lshlrev_b32 v30, 16, v40
    v_and_b32 v31, 0xffff0000, v40
    v_add_f32 v28, v28, v30
    v_add_f32 v29, v29, v31
    v_lshlrev_b32 v30, 16, v41
    v_and_b32 v31, 0xffff0000, v41
    v_add_f32 v28, v28, v30
    v_add_f32 v29, v29, v31
    v_lshlrev_b32 v30, 16, v42
    v_and_b32 v31, 0xffff0000, v42
    v_add_f32 v28, v28, v30
    v_add_f32 v29, v29, v31
    v_lshlrev_b32 v30, 16, v43
    v_and_b32 v31, 0xffff0000, v43
    v_add_f32 v28, v28, v30
    v_add_f32 v29, v29, v31
    ds_read_b64_tr_b16 v[36:37], v18 offset:27648
    ds_read_b64_tr_b16 v[38:39], v18 offset:29184
    ds_read_b64_tr_b16 v[168:169], v13 offset:6144
    ds_read_b64_tr_b16 v[170:171], v13 offset:7680
    s_waitcnt lgkmcnt(10)
    v_lshlrev_b32 v30, 16, v44
    v_and_b32 v31, 0xffff0000, v44
    v_add_f32 v28, v28, v30
    v_add_f32 v29, v29, v31
    v_lshlrev_b32 v30, 16, v45
    v_and_b32 v31, 0xffff0000, v45
    v_add_f32 v28, v28, v30
    v_add_f32 v29, v29, v31
    v_lshlrev_b32 v30, 16, v46
    v_and_b32 v31, 0xffff0000, v46
    v_add_f32 v28, v28, v30
    v_add_f32 v29, v29, v31
    v_lshlrev_b32 v30, 16, v47
    v_and_b32 v31, 0xffff0000, v47
    v_add_f32 v28, v28, v30
    v_add_f32 v29, v29, v31
    ds_read_b64_tr_b16 v[40:41], v18 offset:30720
    ds_read_b64_tr_b16 v[42:43], v18 offset:32256
    ds_read_b64_tr_b16 v[172:173], v13 offset:6208
    ds_read_b64_tr_b16 v[174:175], v13 offset:7744
    s_waitcnt lgkmcnt(10)
    v_lshlrev_b32 v30, 16, v32
    v_and_b32 v31, 0xffff0000, v32
    v_add_f32 v28, v28, v30
    v_add_f32 v29, v29, v31
    v_lshlrev_b32 v30, 16, v33
    v_and_b32 v31, 0xffff0000, v33
    v_add_f32 v28, v28, v30
    v_add_f32 v29, v29, v31
    v_lshlrev_b32 v30, 16, v34
    v_and_b32 v31, 0xffff0000, v34
    v_add_f32 v28, v28, v30
    v_add_f32 v29, v29, v31
    v_lshlrev_b32 v30, 16, v35
    v_and_b32 v31, 0xffff0000, v35
    v_add_f32 v28, v28, v30
    v_add_f32 v29, v29, v31
    ds_read_b64_tr_b16 v[44:45], v18 offset:33792
    ds_read_b64_tr_b16 v[46:47], v18 offset:35328
    ds_read_b64_tr_b16 v[176:177], v13 offset:6272
    ds_read_b64_tr_b16 v[178:179], v13 offset:7808
    s_waitcnt lgkmcnt(10)
    v_lshlrev_b32 v30, 16, v36
    v_and_b32 v31, 0xffff0000, v36
    v_add_f32 v28, v28, v30
    v_add_f32 v29, v29, v31
    v_lshlrev_b32 v30, 16, v37
    v_and_b32 v31, 0xffff0000, v37
    v_add_f32 v28, v28, v30
    v_add_f32 v29, v29, v31
    v_lshlrev_b32 v30, 16, v38
    v_and_b32 v31, 0xffff0000, v38
    v_add_f32 v28, v28, v30
    v_add_f32 v29, v29, v31
    v_lshlrev_b32 v30, 16, v39
    v_and_b32 v31, 0xffff0000, v39
    v_add_f32 v28, v28, v30
    v_add_f32 v29, v29, v31
    ds_read_b64_tr_b16 v[32:33], v18 offset:36864
    ds_read_b64_tr_b16 v[34:35], v18 offset:38400
    ds_read_b64_tr_b16 v[180:181], v13 offset:9216
    ds_read_b64_tr_b16 v[182:183], v13 offset:10752
    s_waitcnt lgkmcnt(10)
    v_lshlrev_b32 v30, 16, v40
    v_and_b32 v31, 0xffff0000, v40
    v_add_f32 v28, v28, v30
    v_add_f32 v29, v29, v31
    v_lshlrev_b32 v30, 16, v41
    v_and_b32 v31, 0xffff0000, v41
    v_add_f32 v28, v28, v30
    v_add_f32 v29, v29, v31
    v_lshlrev_b32 v30, 16, v42
    v_and_b32 v31, 0xffff0000, v42
    v_add_f32 v28, v28, v30
    v_add_f32 v29, v29, v31
    v_lshlrev_b32 v30, 16, v43
    v_and_b32 v31, 0xffff0000, v43
    v_add_f32 v28, v28, v30
    v_add_f32 v29, v29, v31
    ds_read_b64_tr_b16 v[36:37], v18 offset:39936
    ds_read_b64_tr_b16 v[38:39], v18 offset:41472
    ds_read_b64_tr_b16 v[184:185], v13 offset:9280
    ds_read_b64_tr_b16 v[186:187], v13 offset:10816
    s_waitcnt lgkmcnt(10)
    v_lshlrev_b32 v30, 16, v44
    v_and_b32 v31, 0xffff0000, v44
    v_add_f32 v28, v28, v30
    v_add_f32 v29, v29, v31
    v_lshlrev_b32 v30, 16, v45
    v_and_b32 v31, 0xffff0000, v45
    v_add_f32 v28, v28, v30
    v_add_f32 v29, v29, v31
    v_lshlrev_b32 v30, 16, v46
    v_and_b32 v31, 0xffff0000, v46
    v_add_f32 v28, v28, v30
    v_add_f32 v29, v29, v31
    v_lshlrev_b32 v30, 16, v47
    v_and_b32 v31, 0xffff0000, v47
    v_add_f32 v28, v28, v30
    v_add_f32 v29, v29, v31
    ds_read_b64_tr_b16 v[40:41], v18 offset:43008
    ds_read_b64_tr_b16 v[42:43], v18 offset:44544
    ds_read_b64_tr_b16 v[188:189], v13 offset:9344
    ds_read_b64_tr_b16 v[190:191], v13 offset:10880
    s_waitcnt lgkmcnt(10)
    v_lshlrev_b32 v30, 16, v32
    v_and_b32 v31, 0xffff0000, v32
    v_add_f32 v28, v28, v30
    v_add_f32 v29, v29, v31
    v_lshlrev_b32 v30, 16, v33
    v_and_b32 v31, 0xffff0000, v33
    v_add_f32 v28, v28, v30
    v_add_f32 v29, v29, v31
    v_lshlrev_b32 v30, 16, v34
    v_and_b32 v31, 0xffff0000, v34
    v_add_f32 v28, v28, v30
    v_add_f32 v29, v29, v31
    v_lshlrev_b32 v30, 16, v35
    v_and_b32 v31, 0xffff0000, v35
    v_add_f32 v28, v28, v30
    v_add_f32 v29, v29, v31
    ds_read_b64_tr_b16 v[44:45], v18 offset:46080
    ds_read_b64_tr_b16 v[46:47], v18 offset:47616
    ds_read_b64_tr_b16 v[192:193], v12 offset:0
    ds_read_b64_tr_b16 v[194:195], v12 offset:1536
    s_waitcnt lgkmcnt(10)
    v_lshlrev_b32 v30, 16, v36
    v_and_b32 v31, 0xffff0000, v36
    v_add_f32 v28, v28, v30
    v_add_f32 v29, v29, v31
    v_lshlrev_b32 v30, 16, v37
    v_and_b32 v31, 0xffff0000, v37
    v_add_f32 v28, v28, v30
    v_add_f32 v29, v29, v31
    v_lshlrev_b32 v30, 16, v38
    v_and_b32 v31, 0xffff0000, v38
    v_add_f32 v28, v28, v30
    v_add_f32 v29, v29, v31
    v_lshlrev_b32 v30, 16, v39
    v_and_b32 v31, 0xffff0000, v39
    v_add_f32 v28, v28, v30
    v_add_f32 v29, v29, v31
    ds_read_b64_tr_b16 v[32:33], v11 offset:0
    ds_read_b64_tr_b16 v[34:35], v11 offset:1536
    ds_read_b64_tr_b16 v[196:197], v12 offset:64
    ds_read_b64_tr_b16 v[198:199], v12 offset:1600
    s_waitcnt lgkmcnt(10)
    v_lshlrev_b32 v30, 16, v40
    v_and_b32 v31, 0xffff0000, v40
    v_add_f32 v28, v28, v30
    v_add_f32 v29, v29, v31
    v_lshlrev_b32 v30, 16, v41
    v_and_b32 v31, 0xffff0000, v41
    v_add_f32 v28, v28, v30
    v_add_f32 v29, v29, v31
    v_lshlrev_b32 v30, 16, v42
    v_and_b32 v31, 0xffff0000, v42
    v_add_f32 v28, v28, v30
    v_add_f32 v29, v29, v31
    v_lshlrev_b32 v30, 16, v43
    v_and_b32 v31, 0xffff0000, v43
    v_add_f32 v28, v28, v30
    v_add_f32 v29, v29, v31
    ds_read_b64_tr_b16 v[36:37], v11 offset:3072
    ds_read_b64_tr_b16 v[38:39], v11 offset:4608
    ds_read_b64_tr_b16 v[200:201], v12 offset:128
    ds_read_b64_tr_b16 v[202:203], v12 offset:1664
    s_waitcnt lgkmcnt(10)
    v_lshlrev_b32 v30, 16, v44
    v_and_b32 v31, 0xffff0000, v44
    v_add_f32 v28, v28, v30
    v_add_f32 v29, v29, v31
    v_lshlrev_b32 v30, 16, v45
    v_and_b32 v31, 0xffff0000, v45
    v_add_f32 v28, v28, v30
    v_add_f32 v29, v29, v31
    v_lshlrev_b32 v30, 16, v46
    v_and_b32 v31, 0xffff0000, v46
    v_add_f32 v28, v28, v30
    v_add_f32 v29, v29, v31
    v_lshlrev_b32 v30, 16, v47
    v_and_b32 v31, 0xffff0000, v47
    v_add_f32 v28, v28, v30
    v_add_f32 v29, v29, v31
    ds_read_b64_tr_b16 v[40:41], v11 offset:6144
    ds_read_b64_tr_b16 v[42:43], v11 offset:7680
    ds_read_b64_tr_b16 v[204:205], v12 offset:3072
    ds_read_b64_tr_b16 v[206:207], v12 offset:4608
    s_waitcnt lgkmcnt(10)
    v_lshlrev_b32 v30, 16, v32
    v_and_b32 v31, 0xffff0000, v32
    v_add_f32 v28, v28, v30
    v_add_f32 v29, v29, v31
    v_lshlrev_b32 v30, 16, v33
    v_and_b32 v31, 0xffff0000, v33
    v_add_f32 v28, v28, v30
    v_add_f32 v29, v29, v31
    v_lshlrev_b32 v30, 16, v34
    v_and_b32 v31, 0xffff0000, v34
    v_add_f32 v28, v28, v30
    v_add_f32 v29, v29, v31
    v_lshlrev_b32 v30, 16, v35
    v_and_b32 v31, 0xffff0000, v35
    v_add_f32 v28, v28, v30
    v_add_f32 v29, v29, v31
    ds_read_b64_tr_b16 v[44:45], v11 offset:9216
    ds_read_b64_tr_b16 v[46:47], v11 offset:10752
    ds_read_b64_tr_b16 v[208:209], v12 offset:3136
    ds_read_b64_tr_b16 v[210:211], v12 offset:4672
    s_waitcnt lgkmcnt(10)
    v_lshlrev_b32 v30, 16, v36
    v_and_b32 v31, 0xffff0000, v36
    v_add_f32 v28, v28, v30
    v_add_f32 v29, v29, v31
    v_lshlrev_b32 v30, 16, v37
    v_and_b32 v31, 0xffff0000, v37
    v_add_f32 v28, v28, v30
    v_add_f32 v29, v29, v31
    v_lshlrev_b32 v30, 16, v38
    v_and_b32 v31, 0xffff0000, v38
    v_add_f32 v28, v28, v30
    v_add_f32 v29, v29, v31
    v_lshlrev_b32 v30, 16, v39
    v_and_b32 v31, 0xffff0000, v39
    v_add_f32 v28, v28, v30
    v_add_f32 v29, v29, v31
    ds_read_b64_tr_b16 v[32:33], v11 offset:12288
    ds_read_b64_tr_b16 v[34:35], v11 offset:13824
    ds_read_b64_tr_b16 v[212:213], v12 offset:3200
    ds_read_b64_tr_b16 v[214:215], v12 offset:4736
    s_waitcnt lgkmcnt(10)
    v_lshlrev_b32 v30, 16, v40
    v_and_b32 v31, 0xffff0000, v40
    v_add_f32 v28, v28, v30
    v_add_f32 v29, v29, v31
    v_lshlrev_b32 v30, 16, v41
    v_and_b32 v31, 0xffff0000, v41
    v_add_f32 v28, v28, v30
    v_add_f32 v29, v29, v31
    v_lshlrev_b32 v30, 16, v42
    v_and_b32 v31, 0xffff0000, v42
    v_add_f32 v28, v28, v30
    v_add_f32 v29, v29, v31
    v_lshlrev_b32 v30, 16, v43
    v_and_b32 v31, 0xffff0000, v43
    v_add_f32 v28, v28, v30
    v_add_f32 v29, v29, v31
    ds_read_b64_tr_b16 v[36:37], v11 offset:15360
    ds_read_b64_tr_b16 v[38:39], v11 offset:16896
    ds_read_b64_tr_b16 v[216:217], v12 offset:6144
    ds_read_b64_tr_b16 v[218:219], v12 offset:7680
    s_waitcnt lgkmcnt(10)
    v_lshlrev_b32 v30, 16, v44
    v_and_b32 v31, 0xffff0000, v44
    v_add_f32 v28, v28, v30
    v_add_f32 v29, v29, v31
    v_lshlrev_b32 v30, 16, v45
    v_and_b32 v31, 0xffff0000, v45
    v_add_f32 v28, v28, v30
    v_add_f32 v29, v29, v31
    v_lshlrev_b32 v30, 16, v46
    v_and_b32 v31, 0xffff0000, v46
    v_add_f32 v28, v28, v30
    v_add_f32 v29, v29, v31
    v_lshlrev_b32 v30, 16, v47
    v_and_b32 v31, 0xffff0000, v47
    v_add_f32 v28, v28, v30
    v_add_f32 v29, v29, v31
    ds_read_b64_tr_b16 v[40:41], v11 offset:18432
    ds_read_b64_tr_b16 v[42:43], v11 offset:19968
    ds_read_b64_tr_b16 v[220:221], v12 offset:6208
    ds_read_b64_tr_b16 v[222:223], v12 offset:7744
    s_waitcnt lgkmcnt(10)
    v_lshlrev_b32 v30, 16, v32
    v_and_b32 v31, 0xffff0000, v32
    v_add_f32 v28, v28, v30
    v_add_f32 v29, v29, v31
    v_lshlrev_b32 v30, 16, v33
    v_and_b32 v31, 0xffff0000, v33
    v_add_f32 v28, v28, v30
    v_add_f32 v29, v29, v31
    v_lshlrev_b32 v30, 16, v34
    v_and_b32 v31, 0xffff0000, v34
    v_add_f32 v28, v28, v30
    v_add_f32 v29, v29, v31
    v_lshlrev_b32 v30, 16, v35
    v_and_b32 v31, 0xffff0000, v35
    v_add_f32 v28, v28, v30
    v_add_f32 v29, v29, v31
    ds_read_b64_tr_b16 v[44:45], v11 offset:21504
    ds_read_b64_tr_b16 v[46:47], v11 offset:23040
    ds_read_b64_tr_b16 v[224:225], v12 offset:6272
    ds_read_b64_tr_b16 v[226:227], v12 offset:7808
    s_waitcnt lgkmcnt(10)
    v_lshlrev_b32 v30, 16, v36
    v_and_b32 v31, 0xffff0000, v36
    v_add_f32 v28, v28, v30
    v_add_f32 v29, v29, v31
    v_lshlrev_b32 v30, 16, v37
    v_and_b32 v31, 0xffff0000, v37
    v_add_f32 v28, v28, v30
    v_add_f32 v29, v29, v31
    v_lshlrev_b32 v30, 16, v38
    v_and_b32 v31, 0xffff0000, v38
    v_add_f32 v28, v28, v30
    v_add_f32 v29, v29, v31
    v_lshlrev_b32 v30, 16, v39
    v_and_b32 v31, 0xffff0000, v39
    v_add_f32 v28, v28, v30
    v_add_f32 v29, v29, v31
    ds_read_b64_tr_b16 v[32:33], v11 offset:24576
    ds_read_b64_tr_b16 v[34:35], v11 offset:26112
    ds_read_b64_tr_b16 v[228:229], v12 offset:9216
    ds_read_b64_tr_b16 v[230:231], v12 offset:10752
    s_waitcnt lgkmcnt(10)
    v_lshlrev_b32 v30, 16, v40
    v_and_b32 v31, 0xffff0000, v40
    v_add_f32 v28, v28, v30
    v_add_f32 v29, v29, v31
    v_lshlrev_b32 v30, 16, v41
    v_and_b32 v31, 0xffff0000, v41
    v_add_f32 v28, v28, v30
    v_add_f32 v29, v29, v31
    v_lshlrev_b32 v30, 16, v42
    v_and_b32 v31, 0xffff0000, v42
    v_add_f32 v28, v28, v30
    v_add_f32 v29, v29, v31
    v_lshlrev_b32 v30, 16, v43
    v_and_b32 v31, 0xffff0000, v43
    v_add_f32 v28, v28, v30
    v_add_f32 v29, v29, v31
    ds_read_b64_tr_b16 v[36:37], v11 offset:27648
    ds_read_b64_tr_b16 v[38:39], v11 offset:29184
    ds_read_b64_tr_b16 v[232:233], v12 offset:9280
    ds_read_b64_tr_b16 v[234:235], v12 offset:10816
    s_waitcnt lgkmcnt(10)
    v_lshlrev_b32 v30, 16, v44
    v_and_b32 v31, 0xffff0000, v44
    v_add_f32 v28, v28, v30
    v_add_f32 v29, v29, v31
    v_lshlrev_b32 v30, 16, v45
    v_and_b32 v31, 0xffff0000, v45
    v_add_f32 v28, v28, v30
    v_add_f32 v29, v29, v31
    v_lshlrev_b32 v30, 16, v46
    v_and_b32 v31, 0xffff0000, v46
    v_add_f32 v28, v28, v30
    v_add_f32 v29, v29, v31
    v_lshlrev_b32 v30, 16, v47
    v_and_b32 v31, 0xffff0000, v47
    v_add_f32 v28, v28, v30
    v_add_f32 v29, v29, v31
    ds_read_b64_tr_b16 v[40:41], v11 offset:30720
    ds_read_b64_tr_b16 v[42:43], v11 offset:32256
    ds_read_b64_tr_b16 v[236:237], v12 offset:9344
    ds_read_b64_tr_b16 v[238:239], v12 offset:10880
    s_waitcnt lgkmcnt(10)
    v_lshlrev_b32 v30, 16, v32
    v_and_b32 v31, 0xffff0000, v32
    v_add_f32 v28, v28, v30
    v_add_f32 v29, v29, v31
    v_lshlrev_b32 v30, 16, v33
    v_and_b32 v31, 0xffff0000, v33
    v_add_f32 v28, v28, v30
    v_add_f32 v29, v29, v31
    v_lshlrev_b32 v30, 16, v34
    v_and_b32 v31, 0xffff0000, v34
    v_add_f32 v28, v28, v30
    v_add_f32 v29, v29, v31
    v_lshlrev_b32 v30, 16, v35
    v_and_b32 v31, 0xffff0000, v35
    v_add_f32 v28, v28, v30
    v_add_f32 v29, v29, v31
    ds_read_b64_tr_b16 v[44:45], v11 offset:33792
    ds_read_b64_tr_b16 v[46:47], v11 offset:35328
    s_mul_i32 s58, s63, 786432
    s_add_u32 s58, s58, s49
    s_add_u32 m0, s68, 0
    s_add_u32 s39, s58, 0
    buffer_load_dwordx4 v8, s[20:23], s39 offen lds
    s_mul_i32 s58, s63, 786432
    s_add_u32 s58, s58, s49
    s_add_u32 s39, s58, 14336
    buffer_load_dwordx4 v8, s[20:23], s39 offen offset:2048 lds
    s_waitcnt lgkmcnt(8)
    v_lshlrev_b32 v30, 16, v36
    v_and_b32 v31, 0xffff0000, v36
    v_add_f32 v28, v28, v30
    v_add_f32 v29, v29, v31
    v_lshlrev_b32 v30, 16, v37
    v_and_b32 v31, 0xffff0000, v37
    v_add_f32 v28, v28, v30
    v_add_f32 v29, v29, v31
    v_lshlrev_b32 v30, 16, v38
    v_and_b32 v31, 0xffff0000, v38
    v_add_f32 v28, v28, v30
    v_add_f32 v29, v29, v31
    v_lshlrev_b32 v30, 16, v39
    v_and_b32 v31, 0xffff0000, v39
    v_add_f32 v28, v28, v30
    v_add_f32 v29, v29, v31
    ds_read_b64_tr_b16 v[32:33], v11 offset:36864
    ds_read_b64_tr_b16 v[34:35], v11 offset:38400
    s_mul_i32 s58, s63, 786432
    s_add_u32 s58, s58, s49
    s_add_u32 m0, s68, 4096
    s_add_u32 s39, s58, 32768
    buffer_load_dwordx4 v8, s[20:23], s39 offen lds
    s_mul_i32 s58, s63, 786432
    s_add_u32 s58, s58, s49
    s_add_u32 s39, s58, 47104
    buffer_load_dwordx4 v8, s[20:23], s39 offen offset:2048 lds
    s_waitcnt lgkmcnt(6)
    v_lshlrev_b32 v30, 16, v40
    v_and_b32 v31, 0xffff0000, v40
    v_add_f32 v28, v28, v30
    v_add_f32 v29, v29, v31
    v_lshlrev_b32 v30, 16, v41
    v_and_b32 v31, 0xffff0000, v41
    v_add_f32 v28, v28, v30
    v_add_f32 v29, v29, v31
    v_lshlrev_b32 v30, 16, v42
    v_and_b32 v31, 0xffff0000, v42
    v_add_f32 v28, v28, v30
    v_add_f32 v29, v29, v31
    v_lshlrev_b32 v30, 16, v43
    v_and_b32 v31, 0xffff0000, v43
    v_add_f32 v28, v28, v30
    v_add_f32 v29, v29, v31
    ds_read_b64_tr_b16 v[36:37], v11 offset:39936
    ds_read_b64_tr_b16 v[38:39], v11 offset:41472
    s_mul_i32 s58, s63, 786432
    s_add_u32 s58, s58, s49
    s_add_u32 m0, s68, 8192
    s_add_u32 s39, s58, 98304
    buffer_load_dwordx4 v8, s[20:23], s39 offen lds
    s_mul_i32 s58, s63, 786432
    s_add_u32 s58, s58, s49
    s_add_u32 s39, s58, 112640
    buffer_load_dwordx4 v8, s[20:23], s39 offen offset:2048 lds
    s_waitcnt lgkmcnt(4)
    v_lshlrev_b32 v30, 16, v44
    v_and_b32 v31, 0xffff0000, v44
    v_add_f32 v28, v28, v30
    v_add_f32 v29, v29, v31
    v_lshlrev_b32 v30, 16, v45
    v_and_b32 v31, 0xffff0000, v45
    v_add_f32 v28, v28, v30
    v_add_f32 v29, v29, v31
    v_lshlrev_b32 v30, 16, v46
    v_and_b32 v31, 0xffff0000, v46
    v_add_f32 v28, v28, v30
    v_add_f32 v29, v29, v31
    v_lshlrev_b32 v30, 16, v47
    v_and_b32 v31, 0xffff0000, v47
    v_add_f32 v28, v28, v30
    v_add_f32 v29, v29, v31
    ds_read_b64_tr_b16 v[40:41], v11 offset:43008
    ds_read_b64_tr_b16 v[42:43], v11 offset:44544
    s_mul_i32 s58, s63, 786432
    s_add_u32 s58, s58, s49
    s_add_u32 m0, s68, 12288
    s_add_u32 s39, s58, 131072
    buffer_load_dwordx4 v8, s[20:23], s39 offen lds
    s_mul_i32 s58, s63, 786432
    s_add_u32 s58, s58, s49
    s_add_u32 s39, s58, 145408
    buffer_load_dwordx4 v8, s[20:23], s39 offen offset:2048 lds
    s_waitcnt lgkmcnt(4)
    v_lshlrev_b32 v30, 16, v32
    v_and_b32 v31, 0xffff0000, v32
    v_add_f32 v28, v28, v30
    v_add_f32 v29, v29, v31
    v_lshlrev_b32 v30, 16, v33
    v_and_b32 v31, 0xffff0000, v33
    v_add_f32 v28, v28, v30
    v_add_f32 v29, v29, v31
    v_lshlrev_b32 v30, 16, v34
    v_and_b32 v31, 0xffff0000, v34
    v_add_f32 v28, v28, v30
    v_add_f32 v29, v29, v31
    v_lshlrev_b32 v30, 16, v35
    v_and_b32 v31, 0xffff0000, v35
    v_add_f32 v28, v28, v30
    v_add_f32 v29, v29, v31
    ds_read_b64_tr_b16 v[44:45], v11 offset:46080
    ds_read_b64_tr_b16 v[46:47], v11 offset:47616
    s_mul_i32 s58, s63, 786432
    s_add_u32 s58, s58, s49
    s_add_u32 m0, s68, 16384
    s_add_u32 s39, s58, 196608
    buffer_load_dwordx4 v8, s[20:23], s39 offen lds
    s_mul_i32 s58, s63, 786432
    s_add_u32 s58, s58, s49
    s_add_u32 s39, s58, 210944
    buffer_load_dwordx4 v8, s[20:23], s39 offen offset:2048 lds
    s_waitcnt lgkmcnt(4)
    v_lshlrev_b32 v30, 16, v36
    v_and_b32 v31, 0xffff0000, v36
    v_add_f32 v28, v28, v30
    v_add_f32 v29, v29, v31
    v_lshlrev_b32 v30, 16, v37
    v_and_b32 v31, 0xffff0000, v37
    v_add_f32 v28, v28, v30
    v_add_f32 v29, v29, v31
    v_lshlrev_b32 v30, 16, v38
    v_and_b32 v31, 0xffff0000, v38
    v_add_f32 v28, v28, v30
    v_add_f32 v29, v29, v31
    v_lshlrev_b32 v30, 16, v39
    v_and_b32 v31, 0xffff0000, v39
    v_add_f32 v28, v28, v30
    v_add_f32 v29, v29, v31
    s_mul_i32 s58, s63, 786432
    s_add_u32 s58, s58, s49
    s_add_u32 m0, s68, 20480
    s_add_u32 s39, s58, 229376
    buffer_load_dwordx4 v8, s[20:23], s39 offen lds
    s_mul_i32 s58, s63, 786432
    s_add_u32 s58, s58, s49
    s_add_u32 s39, s58, 243712
    buffer_load_dwordx4 v8, s[20:23], s39 offen offset:2048 lds
    s_waitcnt lgkmcnt(2)
    v_lshlrev_b32 v30, 16, v40
    v_and_b32 v31, 0xffff0000, v40
    v_add_f32 v28, v28, v30
    v_add_f32 v29, v29, v31
    v_lshlrev_b32 v30, 16, v41
    v_and_b32 v31, 0xffff0000, v41
    v_add_f32 v28, v28, v30
    v_add_f32 v29, v29, v31
    v_lshlrev_b32 v30, 16, v42
    v_and_b32 v31, 0xffff0000, v42
    v_add_f32 v28, v28, v30
    v_add_f32 v29, v29, v31
    v_lshlrev_b32 v30, 16, v43
    v_and_b32 v31, 0xffff0000, v43
    v_add_f32 v28, v28, v30
    v_add_f32 v29, v29, v31
    s_mul_i32 s58, s63, 786432
    s_add_u32 s58, s58, s49
    s_add_u32 m0, s68, 24576
    s_add_u32 s39, s58, 294912
    buffer_load_dwordx4 v8, s[20:23], s39 offen lds
    s_mul_i32 s58, s63, 786432
    s_add_u32 s58, s58, s49
    s_add_u32 s39, s58, 309248
    buffer_load_dwordx4 v8, s[20:23], s39 offen offset:2048 lds
    s_waitcnt lgkmcnt(0)
    v_lshlrev_b32 v30, 16, v44
    v_and_b32 v31, 0xffff0000, v44
    v_add_f32 v28, v28, v30
    v_add_f32 v29, v29, v31
    v_lshlrev_b32 v30, 16, v45
    v_and_b32 v31, 0xffff0000, v45
    v_add_f32 v28, v28, v30
    v_add_f32 v29, v29, v31
    v_lshlrev_b32 v30, 16, v46
    v_and_b32 v31, 0xffff0000, v46
    v_add_f32 v28, v28, v30
    v_add_f32 v29, v29, v31
    v_lshlrev_b32 v30, 16, v47
    v_and_b32 v31, 0xffff0000, v47
    v_add_f32 v28, v28, v30
    v_add_f32 v29, v29, v31
    s_mul_i32 s58, s63, 786432
    s_add_u32 s58, s58, s49
    s_add_u32 m0, s68, 28672
    s_add_u32 s39, s58, 327680
    buffer_load_dwordx4 v8, s[20:23], s39 offen lds
    s_setprio 0
    v_add_f32 v28, v28, v29
    v_mov_b32 v29, v28
    s_nop 1
    v_permlane32_swap_b32 v28, v29
    v_add_f32 v28, v28, v29
    s_lshl_b32 s57, s36, 9
    s_add_u32 s57, s57, 161792
    v_lshlrev_b32 v13, 3, v0
    v_add_u32 v13, s57, v13
    v_cvt_pk_bf16_f32 v30, v28, v28
    v_and_b32 v30, 0xffff0000, v30
    v_sub_f32 v31, v28, v30
    v_cvt_pk_bf16_f32 v38, v30, v31
    v_cvt_pk_bf16_f32 v39, v30, 0
    ds_write_b64 v13, v[38:39]
    s_cmp_eq_u32 s63, 1
    s_cbranch_scc1 Lhole_10
    s_mul_i32 s58, s63, 786432
    s_add_u32 s58, s58, s49
    s_add_u32 m0, s68, 30720
    s_add_u32 s39, s58, 344064
    buffer_load_dwordx4 v8, s[20:23], s39 offen lds
Lhole_10:
    s_bfm_b64 exec, 27, 0
    buffer_load_dword v250, v14, s[28:31], s73 offen
    s_mov_b64 exec, -1
    s_waitcnt lgkmcnt(0)
    s_barrier
    s_mul_i32 s58, s63, 753664
    s_add_u32 s58, s58, s49
    s_add_u32 m0, s52, 0
    s_add_u32 s39, s58, 393216
    buffer_load_dwordx4 v8, s[20:23], s39 offen lds
    s_mul_i32 s58, s63, 753664
    s_add_u32 s58, s58, s49
    s_add_u32 s39, s58, 407552
    buffer_load_dwordx4 v8, s[20:23], s39 offen offset:2048 lds
    s_mul_i32 s58, s63, 753664
    s_add_u32 s58, s58, s49
    s_add_u32 m0, s52, 4096
    s_add_u32 s39, s58, 425984
    buffer_load_dwordx4 v8, s[20:23], s39 offen lds
    s_mul_i32 s58, s63, 753664
    s_add_u32 s58, s58, s49
    s_add_u32 s39, s58, 440320
    buffer_load_dwordx4 v8, s[20:23], s39 offen offset:2048 lds
    s_mul_i32 s58, s63, 720896
    s_add_u32 s58, s58, s49
    s_add_u32 m0, s52, 8192
    s_add_u32 s39, s58, 491520
    buffer_load_dwordx4 v8, s[20:23], s39 offen lds
    s_mul_i32 s58, s63, 720896
    s_add_u32 s58, s58, s49
    s_add_u32 s39, s58, 505856
    buffer_load_dwordx4 v8, s[20:23], s39 offen offset:2048 lds
    s_mul_i32 s58, s63, 720896
    s_add_u32 s58, s58, s49
    s_add_u32 m0, s52, 12288
    s_add_u32 s39, s58, 524288
    buffer_load_dwordx4 v8, s[20:23], s39 offen lds
    s_mul_i32 s58, s63, 720896
    s_add_u32 s58, s58, s49
    s_add_u32 s39, s58, 538624
    buffer_load_dwordx4 v8, s[20:23], s39 offen offset:2048 lds
    s_mul_i32 s58, s63, 688128
    s_add_u32 s58, s58, s49
    s_add_u32 m0, s52, 16384
    s_add_u32 s39, s58, 589824
    buffer_load_dwordx4 v8, s[20:23], s39 offen lds
    s_mul_i32 s58, s63, 688128
    s_add_u32 s58, s58, s49
    s_add_u32 s39, s58, 604160
    buffer_load_dwordx4 v8, s[20:23], s39 offen offset:2048 lds
    s_mul_i32 s58, s63, 688128
    s_add_u32 s58, s58, s49
    s_add_u32 m0, s52, 20480
    s_add_u32 s39, s58, 622592
    buffer_load_dwordx4 v8, s[20:23], s39 offen lds
    s_mul_i32 s58, s63, 688128
    s_add_u32 s58, s58, s49
    s_add_u32 s39, s58, 636928
    buffer_load_dwordx4 v8, s[20:23], s39 offen offset:2048 lds
    s_waitcnt vmcnt(13)
    s_barrier
    s_mul_i32 s58, s63, 655360
    s_add_u32 s58, s58, s49
    s_add_u32 m0, s52, 24576
    s_add_u32 s39, s58, 688128
    buffer_load_dwordx4 v8, s[20:23], s39 offen lds
    s_mul_i32 s58, s63, 655360
    s_add_u32 s58, s58, s49
    s_add_u32 s39, s58, 702464
    buffer_load_dwordx4 v8, s[20:23], s39 offen offset:2048 lds
    s_mul_i32 s58, s63, 655360
    s_add_u32 s58, s58, s49
    s_add_u32 m0, s52, 28672
    s_add_u32 s39, s58, 720896
    buffer_load_dwordx4 v8, s[20:23], s39 offen lds
    s_mul_i32 s58, s63, 655360
    s_add_u32 s58, s58, s49
    s_add_u32 s39, s58, 735232
    buffer_load_dwordx4 v8, s[20:23], s39 offen offset:2048 lds
    s_mul_i32 s58, s63, 507904
    s_add_u32 s58, s58, s49
    s_add_u32 m0, s52, 32768
    s_add_u32 s39, s58, 65536
    buffer_load_dwordx4 v8, s[20:23], s39 offen lds
    s_mul_i32 s58, s63, 573440
    s_add_u32 s58, s58, s49
    s_add_u32 s39, s58, 79872
    buffer_load_dwordx4 v8, s[20:23], s39 offen offset:2048 lds
    s_mul_i32 s58, s63, 507904
    s_add_u32 s58, s58, s49
    s_add_u32 m0, s52, 36864
    s_add_u32 s39, s58, 163840
    buffer_load_dwordx4 v8, s[20:23], s39 offen lds
    s_mul_i32 s58, s63, 573440
    s_add_u32 s58, s58, s49
    s_add_u32 s39, s58, 178176
    buffer_load_dwordx4 v8, s[20:23], s39 offen offset:2048 lds
    s_mul_i32 s58, s63, 507904
    s_add_u32 s58, s58, s49
    s_add_u32 m0, s52, 40960
    s_add_u32 s39, s58, 262144
    buffer_load_dwordx4 v8, s[20:23], s39 offen lds
    s_mul_i32 s58, s63, 573440
    s_add_u32 s58, s58, s49
    s_add_u32 s39, s58, 276480
    buffer_load_dwordx4 v8, s[20:23], s39 offen offset:2048 lds
    s_mul_i32 s58, s63, 507904
    s_add_u32 s58, s58, s49
    s_add_u32 m0, s52, 45056
    s_add_u32 s39, s58, 360448
    buffer_load_dwordx4 v8, s[20:23], s39 offen lds
    s_mul_i32 s58, s63, 573440
    s_add_u32 s58, s58, s49
    s_add_u32 s39, s58, 374784
    buffer_load_dwordx4 v8, s[20:23], s39 offen offset:2048 lds
    s_waitcnt lgkmcnt(0)
    s_cmp_eq_u32 s63, 1
    s_cbranch_scc0 Lhole_11
    s_mul_i32 s58, s63, 786432
    s_add_u32 s58, s58, s49
    s_add_u32 m0, s68, 30720
    s_add_u32 s39, s58, 344064
    buffer_load_dwordx4 v8, s[20:23], s39 offen lds
Lhole_11:
    s_waitcnt vmcnt(0)
    s_barrier
    s_mul_i32 s58, s63, 507904
    s_add_u32 s58, s58, s49
    s_add_u32 m0, s68, 0
    s_add_u32 s39, s58, 458752
    buffer_load_dwordx4 v8, s[20:23], s39 offen lds
    s_mul_i32 s58, s63, 573440
    s_add_u32 s58, s58, s49
    s_add_u32 s39, s58, 473088
    buffer_load_dwordx4 v8, s[20:23], s39 offen offset:2048 lds
    s_mul_i32 s58, s63, 507904
    s_add_u32 s58, s58, s49
    s_add_u32 m0, s68, 4096
    s_add_u32 s39, s58, 557056
    buffer_load_dwordx4 v8, s[20:23], s39 offen lds
    s_waitcnt vmcnt(0)
    s_barrier
    s_mul_i32 s57, s53, 4096
    s_bfm_b64 exec, 32, 0
    buffer_load_dword v250, v14, s[12:15], s57 offen
    s_mov_b64 exec, -1
    s_lshl_b32 s57, s36, 10
    v_add_u32 v11, s57, v1
    v_add_u32 v12, 65536, v11
    s_barrier
    ds_read_b128 v[240:243], v11 offset:0
    ds_write_b128 v11, v[48:51] offset:0
    ds_read_b128 v[48:51], v11 offset:32768
    ds_write_b128 v11, v[52:55] offset:32768
    ds_read_b128 v[52:55], v11 offset:4096
    ds_write_b128 v11, v[56:59] offset:4096
    ds_read_b128 v[56:59], v11 offset:36864
    ds_write_b128 v11, v[60:63] offset:36864
    ds_read_b128 v[60:63], v11 offset:8192
    ds_write_b128 v11, v[64:67] offset:8192
    ds_read_b128 v[64:67], v11 offset:40960
    ds_write_b128 v11, v[68:71] offset:40960
    ds_read_b128 v[68:71], v11 offset:12288
    ds_write_b128 v11, v[72:75] offset:12288
    ds_read_b128 v[72:75], v11 offset:16384
    ds_write_b128 v11, v[80:83] offset:16384
    ds_read_b128 v[80:83], v11 offset:49152
    ds_write_b128 v11, v[84:87] offset:49152
    ds_read_b128 v[84:87], v11 offset:20480
    ds_write_b128 v11, v[88:91] offset:20480
    ds_read_b128 v[88:91], v11 offset:53248
    ds_write_b128 v11, v[92:95] offset:53248
    ds_read_b128 v[92:95], v11 offset:24576
    ds_write_b128 v11, v[96:99] offset:24576
    ds_read_b128 v[96:99], v11 offset:57344
    ds_write_b128 v11, v[100:103] offset:57344
    ds_read_b128 v[100:103], v11 offset:28672
    ds_write_b128 v11, v[104:107] offset:28672
    ds_read_b128 v[104:107], v11 offset:61440
    ds_write_b128 v11, v[108:111] offset:61440
    ds_read_b128 v[108:111], v11 offset:45056
    ds_write_b128 v11, v[76:79] offset:45056
    s_waitcnt lgkmcnt(0)
    s_barrier
    s_setprio 2
    ds_read_b128 v[76:79], v12 offset:0
    ds_write_b128 v12, v[112:115] offset:0
    ds_read_b128 v[112:115], v12 offset:4096
    ds_write_b128 v12, v[116:119] offset:4096
    ds_read_b128 v[116:119], v12 offset:8192
    ds_write_b128 v12, v[120:123] offset:8192
    ds_read_b128 v[120:123], v12 offset:12288
    ds_write_b128 v12, v[124:127] offset:12288
    ds_read_b128 v[124:127], v12 offset:16384
    ds_write_b128 v12, v[128:131] offset:16384
    ds_read_b128 v[128:131], v12 offset:20480
    ds_write_b128 v12, v[132:135] offset:20480
    ds_read_b128 v[132:135], v12 offset:24576
    ds_write_b128 v12, v[136:139] offset:24576
    ds_read_b128 v[136:139], v12 offset:28672
    ds_write_b128 v12, v[140:143] offset:28672
    s_mul_i32 s57, s36, 12288
    v_add_u32 v13, s57, v1
    s_barrier
    ds_write_b128 v13, v[144:147] offset:0
    ds_write_b128 v13, v[148:151] offset:1024
    ds_write_b128 v13, v[152:155] offset:2048
    ds_write_b128 v13, v[156:159] offset:3072
    ds_write_b128 v13, v[160:163] offset:4096
    ds_write_b128 v13, v[164:167] offset:5120
    ds_write_b128 v13, v[168:171] offset:6144
    ds_write_b128 v13, v[172:175] offset:7168
    ds_write_b128 v13, v[176:179] offset:8192
    ds_write_b128 v13, v[180:183] offset:9216
    ds_write_b128 v13, v[184:187] offset:10240
    ds_write_b128 v13, v[188:191] offset:11264
    s_mul_i32 s57, s36, 12288
    s_add_u32 s57, s57, 49152
    v_add_u32 v13, s57, v1
    s_cmp_lt_u32 s36, 2
    s_cbranch_scc0 Lh23_12
    s_lshl_b32 s59, s36, 11
    v_add_u32 v11, s59, v1
    s_mov_b32 s59, 10633216
    s_waitcnt lgkmcnt(0)
    s_barrier
    ds_read_b128 v[144:147], v11 offset:49152
    ds_read_b128 v[148:151], v11 offset:50176
    ds_read_b128 v[152:155], v11 offset:53248
    ds_read_b128 v[156:159], v11 offset:54272
    ds_read_b128 v[160:163], v11 offset:57344
    ds_read_b128 v[164:167], v11 offset:58368
    ds_read_b128 v[168:171], v11 offset:61440
    ds_read_b128 v[172:175], v11 offset:62464
    s_waitcnt lgkmcnt(4)
    v_add_f32 v144, v144, v152
    v_add_f32 v145, v145, v153
    v_add_f32 v146, v146, v154
    v_add_f32 v147, v147, v155
    v_add_f32 v148, v148, v156
    v_add_f32 v149, v149, v157
    v_add_f32 v150, v150, v158
    v_add_f32 v151, v151, v159
    s_waitcnt lgkmcnt(2)
    v_add_f32 v144, v144, v160
    v_add_f32 v145, v145, v161
    v_add_f32 v146, v146, v162
    v_add_f32 v147, v147, v163
    v_add_f32 v148, v148, v164
    v_add_f32 v149, v149, v165
    v_add_f32 v150, v150, v166
    v_add_f32 v151, v151, v167
    s_waitcnt lgkmcnt(0)
    v_add_f32 v144, v144, v168
    v_add_f32 v145, v145, v169
    v_add_f32 v146, v146, v170
    v_add_f32 v147, v147, v171
    v_add_f32 v148, v148, v172
    v_add_f32 v149, v149, v173
    v_add_f32 v150, v150, v174
    v_add_f32 v151, v151, v175
    v_cvt_pk_bf16_f32 v152, v144, v145
    v_cvt_pk_bf16_f32 v153, v146, v147
    v_cvt_pk_bf16_f32 v154, v148, v149
    v_cvt_pk_bf16_f32 v155, v150, v151
    v_min_u32 v152, s89, v152
    v_min_u32 v153, s89, v153
    v_min_u32 v154, s89, v154
    v_min_u32 v155, s89, v155
    s_mov_b64 exec, s[78:79]
    buffer_store_dwordx4 v[152:155], v10, s[28:31], s59 offen sc1
    s_mov_b64 exec, -1
    s_barrier
    s_setprio 0
    s_add_u32 s59, s54, 278528
    s_add_u32 s60, s55, 278528
    v_add_u32 v11, s56, v9
    v_add_u32 v12, s65, v9
    s_add_u32 s58, s59, 4096
    s_waitcnt vmcnt(0)
    s_mov_b32 s61, 0
Lpp_14:
    buffer_load_dwordx4 v[144:147], v1, s[28:31], s59 offen offset:0 sc1
    buffer_load_dwordx4 v[148:151], v1, s[28:31], s59 offen offset:1024 sc1
    buffer_load_dwordx4 v[152:155], v1, s[28:31], s59 offen offset:2048 sc1
    buffer_load_dwordx4 v[156:159], v1, s[28:31], s59 offen offset:3072 sc1
    buffer_load_dword v32, v9, s[28:31], s60 offen offset:0 sc1
    buffer_load_dwordx4 v[160:163], v1, s[28:31], s58 offen offset:0 sc1
    buffer_load_dwordx4 v[164:167], v1, s[28:31], s58 offen offset:1024 sc1
    buffer_load_dwordx4 v[168:171], v1, s[28:31], s58 offen offset:2048 sc1
    buffer_load_dwordx4 v[172:175], v1, s[28:31], s58 offen offset:3072 sc1
    buffer_load_dword v33, v9, s[28:31], s60 offen offset:256 sc1
    s_add_u32 s61, s61, 1
    s_cmp_gt_u32 s61, 262144
    s_cbranch_scc1 L_end
    s_waitcnt vmcnt(5)
    v_max3_u32 v176, v32, v144, v145
    v_max3_u32 v176, v176, v146, v147
    v_max3_u32 v176, v176, v148, v149
    v_max3_u32 v176, v176, v150, v151
    v_max3_u32 v176, v176, v152, v153
    v_max3_u32 v176, v176, v154, v155
    v_max3_u32 v176, v176, v156, v157
    v_max3_u32 v176, v176, v158, v159
    s_waitcnt vmcnt(0)
    v_max_u32 v176, v176, v33
    v_max3_u32 v176, v176, v160, v161
    v_max3_u32 v176, v176, v162, v163
    v_max3_u32 v176, v176, v164, v165
    v_max3_u32 v176, v176, v166, v167
    v_max3_u32 v176, v176, v168, v169
    v_max3_u32 v176, v176, v170, v171
    v_max3_u32 v176, v176, v172, v173
    v_max3_u32 v176, v176, v174, v175
    v_cmp_eq_u32 vcc, -1, v176
    s_nop 3
    s_cbranch_vccnz Lpp_14
    s_setprio 2
    v_dot2_f32_bf16 v176, v144, s87, 0
    v_dot2_f32_bf16 v177, v144, s88, 0
    v_dot2_f32_bf16 v178, v145, s87, 0
    v_dot2_f32_bf16 v179, v145, s88, 0
    v_dot2_f32_bf16 v180, v146, s87, 0
    v_dot2_f32_bf16 v181, v146, s88, 0
    v_dot2_f32_bf16 v182, v147, s87, 0
    v_dot2_f32_bf16 v183, v147, s88, 0
    v_dot2_f32_bf16 v176, v148, s87, v176
    v_dot2_f32_bf16 v177, v148, s88, v177
    v_dot2_f32_bf16 v178, v149, s87, v178
    v_dot2_f32_bf16 v179, v149, s88, v179
    v_dot2_f32_bf16 v180, v150, s87, v180
    v_dot2_f32_bf16 v181, v150, s88, v181
    v_dot2_f32_bf16 v182, v151, s87, v182
    v_dot2_f32_bf16 v183, v151, s88, v183
    v_dot2_f32_bf16 v176, v152, s87, v176
    v_dot2_f32_bf16 v177, v152, s88, v177
    v_dot2_f32_bf16 v178, v153, s87, v178
    v_dot2_f32_bf16 v179, v153, s88, v179
    v_dot2_f32_bf16 v180, v154, s87, v180
    v_dot2_f32_bf16 v181, v154, s88, v181
    v_dot2_f32_bf16 v182, v155, s87, v182
    v_dot2_f32_bf16 v183, v155, s88, v183
    v_dot2_f32_bf16 v176, v156, s87, v176
    v_dot2_f32_bf16 v177, v156, s88, v177
    v_dot2_f32_bf16 v178, v157, s87, v178
    v_dot2_f32_bf16 v179, v157, s88, v179
    v_dot2_f32_bf16 v180, v158, s87, v180
    v_dot2_f32_bf16 v181, v158, s88, v181
    v_dot2_f32_bf16 v182, v159, s87, v182
    v_dot2_f32_bf16 v183, v159, s88, v183
    v_lshlrev_b32 v34, 16, v32
    v_and_b32 v35, 0xffff0000, v32
    v_dot2_f32_bf16 v184, v160, s87, 0
    v_dot2_f32_bf16 v185, v160, s88, 0
    v_dot2_f32_bf16 v186, v161, s87, 0
    v_dot2_f32_bf16 v187, v161, s88, 0
    v_dot2_f32_bf16 v188, v162, s87, 0
    v_dot2_f32_bf16 v189, v162, s88, 0
    v_dot2_f32_bf16 v190, v163, s87, 0
    v_dot2_f32_bf16 v191, v163, s88, 0
    v_dot2_f32_bf16 v184, v164, s87, v184
    v_dot2_f32_bf16 v185, v164, s88, v185
    v_dot2_f32_bf16 v186, v165, s87, v186
    v_dot2_f32_bf16 v187, v165, s88, v187
    v_dot2_f32_bf16 v188, v166, s87, v188
    v_dot2_f32_bf16 v189, v166, s88, v189
    v_dot2_f32_bf16 v190, v167, s87, v190
    v_dot2_f32_bf16 v191, v167, s88, v191
    v_dot2_f32_bf16 v184, v168, s87, v184
    v_dot2_f32_bf16 v185, v168, s88, v185
    v_dot2_f32_bf16 v186, v169, s87, v186
    v_dot2_f32_bf16 v187, v169, s88, v187
    v_dot2_f32_bf16 v188, v170, s87, v188
    v_dot2_f32_bf16 v189, v170, s88, v189
    v_dot2_f32_bf16 v190, v171, s87, v190
    v_dot2_f32_bf16 v191, v171, s88, v191
    v_dot2_f32_bf16 v184, v172, s87, v184
    v_dot2_f32_bf16 v185, v172, s88, v185
    v_dot2_f32_bf16 v186, v173, s87, v186
    v_dot2_f32_bf16 v187, v173, s88, v187
    v_dot2_f32_bf16 v188, v174, s87, v188
    v_dot2_f32_bf16 v189, v174, s88, v189
    v_dot2_f32_bf16 v190, v175, s87, v190
    v_dot2_f32_bf16 v191, v175, s88, v191
    v_lshlrev_b32 v36, 16, v33
    v_and_b32 v37, 0xffff0000, v33
    v_permlane32_swap_b32 v176, v180
    v_permlane32_swap_b32 v177, v181
    v_permlane32_swap_b32 v178, v182
    v_permlane32_swap_b32 v179, v183
    v_permlane32_swap_b32 v184, v188
    v_permlane32_swap_b32 v185, v189
    v_permlane32_swap_b32 v186, v190
    v_permlane32_swap_b32 v187, v191
    v_add_f32_dpp v34, v34, v34 row_ror:8 row_mask:0xf bank_mask:0xf
    v_add_f32_dpp v35, v35, v35 row_ror:8 row_mask:0xf bank_mask:0xf
    v_add_f32_dpp v36, v36, v36 row_ror:8 row_mask:0xf bank_mask:0xf
    v_add_f32_dpp v37, v37, v37 row_ror:8 row_mask:0xf bank_mask:0xf
    v_add_f32 v176, v176, v180
    v_add_f32 v177, v177, v181
    v_add_f32 v178, v178, v182
    v_add_f32 v179, v179, v183
    v_add_f32 v184, v184, v188
    v_add_f32 v185, v185, v189
    v_add_f32 v186, v186, v190
    v_add_f32 v187, v187, v191
    v_add_f32_dpp v34, v34, v34 row_ror:4 row_mask:0xf bank_mask:0xf
    v_add_f32_dpp v35, v35, v35 row_ror:4 row_mask:0xf bank_mask:0xf
    v_add_f32_dpp v36, v36, v36 row_ror:4 row_mask:0xf bank_mask:0xf
    v_add_f32_dpp v37, v37, v37 row_ror:4 row_mask:0xf bank_mask:0xf
    v_permlane16_swap_b32 v176, v178
    v_permlane16_swap_b32 v177, v179
    v_permlane16_swap_b32 v184, v186
    v_permlane16_swap_b32 v185, v187
    v_add_f32_dpp v34, v34, v34 row_ror:2 row_mask:0xf bank_mask:0xf
    v_add_f32_dpp v35, v35, v35 row_ror:2 row_mask:0xf bank_mask:0xf
    v_add_f32_dpp v36, v36, v36 row_ror:2 row_mask:0xf bank_mask:0xf
    v_add_f32_dpp v37, v37, v37 row_ror:2 row_mask:0xf bank_mask:0xf
    v_add_f32 v176, v176, v178
    v_add_f32 v177, v177, v179
    v_add_f32 v184, v184, v186
    v_add_f32 v185, v185, v187
    v_add_f32_dpp v34, v34, v34 row_ror:1 row_mask:0xf bank_mask:0xf
    v_add_f32_dpp v35, v35, v35 row_ror:1 row_mask:0xf bank_mask:0xf
    v_add_f32_dpp v36, v36, v36 row_ror:1 row_mask:0xf bank_mask:0xf
    v_add_f32_dpp v37, v37, v37 row_ror:1 row_mask:0xf bank_mask:0xf
    v_cvt_pk_bf16_f32 v176, v176, v177
    v_cvt_pk_bf16_f32 v34, v34, v35
    v_cvt_pk_bf16_f32 v184, v184, v185
    v_cvt_pk_bf16_f32 v36, v36, v37
    ds_write_b32 v11, v176 offset:0
    ds_write_b32 v12, v34 offset:0
    ds_write_b32 v11, v184 offset:512
    ds_write_b32 v12, v36 offset:512
    s_waitcnt lgkmcnt(0)
    s_setprio 0
    s_barrier
    s_barrier
    ds_write_b128 v13, v[192:195] offset:0
    ds_write_b128 v13, v[196:199] offset:1024
    ds_write_b128 v13, v[200:203] offset:2048
    ds_write_b128 v13, v[204:207] offset:3072
    ds_write_b128 v13, v[208:211] offset:4096
    ds_write_b128 v13, v[212:215] offset:5120
    ds_write_b128 v13, v[216:219] offset:6144
    ds_write_b128 v13, v[220:223] offset:7168
    ds_write_b128 v13, v[224:227] offset:8192
    ds_write_b128 v13, v[228:231] offset:9216
    ds_write_b128 v13, v[232:235] offset:10240
    ds_write_b128 v13, v[236:239] offset:11264
    s_branch Lhjoin_13
Lh23_12:
    s_setprio 0
    s_waitcnt lgkmcnt(0)
    s_barrier
    s_barrier
    s_add_u32 m0, s48, 0
    s_add_u32 s39, s47, 0
    buffer_load_dwordx4 v8, s[12:15], s39 offen lds
    s_add_u32 s39, s47, 7168
    buffer_load_dwordx4 v8, s[12:15], s39 offen offset:1024 lds
    s_add_u32 s39, s47, 14336
    buffer_load_dwordx4 v8, s[12:15], s39 offen offset:2048 lds
    s_add_u32 s39, s47, 21504
    buffer_load_dwordx4 v8, s[12:15], s39 offen offset:3072 lds
    s_add_u32 m0, s48, 4096
    s_add_u32 s39, s47, 32768
    buffer_load_dwordx4 v8, s[12:15], s39 offen lds
    s_add_u32 s39, s47, 39936
    buffer_load_dwordx4 v8, s[12:15], s39 offen offset:1024 lds
    s_add_u32 s39, s47, 47104
    buffer_load_dwordx4 v8, s[12:15], s39 offen offset:2048 lds
    s_add_u32 s39, s47, 54272
    buffer_load_dwordx4 v8, s[12:15], s39 offen offset:3072 lds
    s_add_u32 m0, s48, 8192
    s_add_u32 s39, s47, 65536
    buffer_load_dwordx4 v8, s[12:15], s39 offen lds
    s_add_u32 s39, s47, 72704
    buffer_load_dwordx4 v8, s[12:15], s39 offen offset:1024 lds
    s_add_u32 s39, s47, 79872
    buffer_load_dwordx4 v8, s[12:15], s39 offen offset:2048 lds
    s_add_u32 s39, s47, 87040
    buffer_load_dwordx4 v8, s[12:15], s39 offen offset:3072 lds
    s_add_u32 m0, s48, 12288
    s_add_u32 s39, s47, 98304
    buffer_load_dwordx4 v8, s[12:15], s39 offen lds
    s_add_u32 s39, s47, 105472
    buffer_load_dwordx4 v8, s[12:15], s39 offen offset:1024 lds
    s_add_u32 s39, s47, 112640
    buffer_load_dwordx4 v8, s[12:15], s39 offen offset:2048 lds
    s_add_u32 s39, s47, 119808
    buffer_load_dwordx4 v8, s[12:15], s39 offen offset:3072 lds
    s_add_u32 m0, s48, 16384
    s_add_u32 s39, s47, 131072
    buffer_load_dwordx4 v8, s[12:15], s39 offen lds
    s_add_u32 s39, s47, 138240
    buffer_load_dwordx4 v8, s[12:15], s39 offen offset:1024 lds
    s_add_u32 s39, s47, 145408
    buffer_load_dwordx4 v8, s[12:15], s39 offen offset:2048 lds
    s_add_u32 s39, s47, 152576
    buffer_load_dwordx4 v8, s[12:15], s39 offen offset:3072 lds
    s_add_u32 m0, s48, 20480
    s_add_u32 s39, s47, 163840
    buffer_load_dwordx4 v8, s[12:15], s39 offen lds
    s_add_u32 s39, s47, 171008
    buffer_load_dwordx4 v8, s[12:15], s39 offen offset:1024 lds
    s_add_u32 s39, s47, 178176
    buffer_load_dwordx4 v8, s[12:15], s39 offen offset:2048 lds
    s_add_u32 s39, s47, 185344
    buffer_load_dwordx4 v8, s[12:15], s39 offen offset:3072 lds
    s_add_u32 m0, s48, 24576
    s_add_u32 s39, s47, 196608
    buffer_load_dwordx4 v8, s[12:15], s39 offen lds
    s_add_u32 s39, s47, 203776
    buffer_load_dwordx4 v8, s[12:15], s39 offen offset:1024 lds
    s_add_u32 s39, s47, 210944
    buffer_load_dwordx4 v8, s[12:15], s39 offen offset:2048 lds
    s_add_u32 s39, s47, 218112
    buffer_load_dwordx4 v8, s[12:15], s39 offen offset:3072 lds
    s_add_u32 m0, s48, 28672
    s_add_u32 s39, s47, 229376
    buffer_load_dwordx4 v8, s[12:15], s39 offen lds
    s_add_u32 s39, s47, 236544
    buffer_load_dwordx4 v8, s[12:15], s39 offen offset:1024 lds
    s_add_u32 s39, s47, 243712
    buffer_load_dwordx4 v8, s[12:15], s39 offen offset:2048 lds
    s_add_u32 s39, s47, 250880
    buffer_load_dwordx4 v8, s[12:15], s39 offen offset:3072 lds
    s_waitcnt vmcnt(0)
    s_barrier
    s_barrier
    ds_write_b128 v13, v[192:195] offset:0
    ds_write_b128 v13, v[196:199] offset:1024
    ds_write_b128 v13, v[200:203] offset:2048
    ds_write_b128 v13, v[204:207] offset:3072
    ds_write_b128 v13, v[208:211] offset:4096
    ds_write_b128 v13, v[212:215] offset:5120
    ds_write_b128 v13, v[216:219] offset:6144
    ds_write_b128 v13, v[220:223] offset:7168
    ds_write_b128 v13, v[224:227] offset:8192
    ds_write_b128 v13, v[228:231] offset:9216
    ds_write_b128 v13, v[232:235] offset:10240
    ds_write_b128 v13, v[236:239] offset:11264
Lhjoin_13:
    s_barrier
    s_barrier
    s_waitcnt vmcnt(0) lgkmcnt(0)
    s_barrier
    s_barrier
    s_mul_i32 s58, s63, 786432
    s_add_u32 s58, s58, s49
    s_add_u32 m0, s68, 0
    s_add_u32 s39, s58, 0
    buffer_load_dwordx4 v8, s[20:23], s39 offen lds
    s_mul_i32 s58, s63, 786432
    s_add_u32 s58, s58, s49
    s_add_u32 s39, s58, 14336
    buffer_load_dwordx4 v8, s[20:23], s39 offen offset:2048 lds
    s_mul_i32 s58, s63, 786432
    s_add_u32 s58, s58, s49
    s_add_u32 m0, s68, 4096
    s_add_u32 s39, s58, 32768
    buffer_load_dwordx4 v8, s[20:23], s39 offen lds
    s_mul_i32 s58, s63, 786432
    s_add_u32 s58, s58, s49
    s_add_u32 s39, s58, 47104
    buffer_load_dwordx4 v8, s[20:23], s39 offen offset:2048 lds
    s_mul_i32 s58, s63, 786432
    s_add_u32 s58, s58, s49
    s_add_u32 m0, s68, 8192
    s_add_u32 s39, s58, 98304
    buffer_load_dwordx4 v8, s[20:23], s39 offen lds
    s_mul_i32 s58, s63, 786432
    s_add_u32 s58, s58, s49
    s_add_u32 s39, s58, 112640
    buffer_load_dwordx4 v8, s[20:23], s39 offen offset:2048 lds
    s_mul_i32 s58, s63, 786432
    s_add_u32 s58, s58, s49
    s_add_u32 m0, s68, 12288
    s_add_u32 s39, s58, 131072
    buffer_load_dwordx4 v8, s[20:23], s39 offen lds
    s_mul_i32 s58, s63, 786432
    s_add_u32 s58, s58, s49
    s_add_u32 s39, s58, 145408
    buffer_load_dwordx4 v8, s[20:23], s39 offen offset:2048 lds
    s_mul_i32 s58, s63, 786432
    s_add_u32 s58, s58, s49
    s_add_u32 m0, s68, 16384
    s_add_u32 s39, s58, 196608
    buffer_load_dwordx4 v8, s[20:23], s39 offen lds
    s_mul_i32 s58, s63, 786432
    s_add_u32 s58, s58, s49
    s_add_u32 s39, s58, 210944
    buffer_load_dwordx4 v8, s[20:23], s39 offen offset:2048 lds
    s_mul_i32 s58, s63, 786432
    s_add_u32 s58, s58, s49
    s_add_u32 m0, s68, 20480
    s_add_u32 s39, s58, 229376
    buffer_load_dwordx4 v8, s[20:23], s39 offen lds
    s_mul_i32 s58, s63, 786432
    s_add_u32 s58, s58, s49
    s_add_u32 s39, s58, 243712
    buffer_load_dwordx4 v8, s[20:23], s39 offen offset:2048 lds
    s_mul_i32 s58, s63, 786432
    s_add_u32 s58, s58, s49
    s_add_u32 m0, s68, 24576
    s_add_u32 s39, s58, 294912
    buffer_load_dwordx4 v8, s[20:23], s39 offen lds
    s_mul_i32 s58, s63, 786432
    s_add_u32 s58, s58, s49
    s_add_u32 s39, s58, 309248
    buffer_load_dwordx4 v8, s[20:23], s39 offen offset:2048 lds
    s_mul_i32 s58, s63, 786432
    s_add_u32 s58, s58, s49
    s_add_u32 m0, s68, 28672
    s_add_u32 s39, s58, 327680
    buffer_load_dwordx4 v8, s[20:23], s39 offen lds
    s_mul_i32 s58, s63, 786432
    s_add_u32 s58, s58, s49
    s_add_u32 s39, s58, 342016
    buffer_load_dwordx4 v8, s[20:23], s39 offen offset:2048 lds
    s_waitcnt lgkmcnt(0)
    s_barrier
    s_lshl_b32 s57, s36, 10
    v_add_u32 v11, s57, v1
    v_add_u32 v12, 65536, v11
    ds_write_b128 v11, v[240:243] offset:0
    ds_write_b128 v11, v[48:51] offset:32768
    ds_write_b128 v11, v[52:55] offset:4096
    ds_write_b128 v11, v[56:59] offset:36864
    ds_write_b128 v11, v[60:63] offset:8192
    ds_write_b128 v11, v[64:67] offset:40960
    ds_write_b128 v11, v[68:71] offset:12288
    ds_write_b128 v11, v[72:75] offset:16384
    ds_write_b128 v11, v[80:83] offset:49152
    ds_write_b128 v11, v[84:87] offset:20480
    ds_write_b128 v11, v[88:91] offset:53248
    ds_write_b128 v11, v[92:95] offset:24576
    ds_write_b128 v11, v[96:99] offset:57344
    ds_write_b128 v11, v[100:103] offset:28672
    ds_write_b128 v11, v[104:107] offset:61440
    ds_write_b128 v11, v[108:111] offset:45056
    ds_write_b128 v12, v[76:79] offset:0
    ds_write_b128 v12, v[112:115] offset:4096
    ds_write_b128 v12, v[116:119] offset:8192
    ds_write_b128 v12, v[120:123] offset:12288
    ds_write_b128 v12, v[124:127] offset:16384
    ds_write_b128 v12, v[128:131] offset:20480
    ds_write_b128 v12, v[132:135] offset:24576
    ds_write_b128 v12, v[136:139] offset:28672
    s_waitcnt vmcnt(0)
    s_barrier
    s_waitcnt vmcnt(0) lgkmcnt(0)
    s_barrier
    s_mul_i32 s58, s63, 507904
    s_add_u32 s58, s58, s49
    s_add_u32 m0, s68, 0
    s_add_u32 s39, s58, 458752
    buffer_load_dwordx4 v8, s[20:23], s39 offen lds
    s_mul_i32 s58, s63, 573440
    s_add_u32 s58, s58, s49
    s_add_u32 s39, s58, 473088
    buffer_load_dwordx4 v8, s[20:23], s39 offen offset:2048 lds
    s_mul_i32 s58, s63, 507904
    s_add_u32 s58, s58, s49
    s_add_u32 m0, s68, 4096
    s_add_u32 s39, s58, 557056
    buffer_load_dwordx4 v8, s[20:23], s39 offen lds
    s_waitcnt vmcnt(0)
    s_barrier
    s_barrier
    s_endpgm
L_compute:
    v_mov_b32 v176, v0
    v_lshlrev_b32 v244, 4, v176
    v_and_b32 v177, 15, v176
    v_lshrrev_b32 v178, 4, v176
    v_lshrrev_b32 v179, 5, v176
    v_and_b32 v180, 31, v176
    v_lshrrev_b32 v181, 2, v177
    v_and_b32 v182, 1, v178
    v_lshlrev_b32 v182, 5, v182
    v_and_b32 v183, 3, v177
    v_lshl_add_u32 v182, v183, 3, v182
    v_lshl_add_u32 v183, v179, 3, v181
    v_lshl_add_u32 v245, v183, 6, v182
    v_add_u32 v246, 256, v245
    v_lshl_add_u32 v183, v179, 2, v181
    v_mul_u32_u24 v247, 192, v183
    v_add_u32 v247, v247, v182
    v_lshl_add_u32 v248, v183, 7, v182
    s_lshr_b32 s63, s93, 1
    v_lshrrev_b32 v181, 3, v177
    v_xor_b32 v181, s63, v181
    v_lshlrev_b32 v181, 6, v181
    v_xor_b32 v182, 64, v181
    s_lshl_b32 s59, s63, 15
    s_add_u32 s59, s59, 98304
    v_add_u32 v248, s59, v248
    v_add_u32 v249, v248, v182
    v_add_u32 v248, v248, v181
    s_lshl_b32 s66, s93, 14
    s_add_u32 s66, s66, 98304
    v_lshrrev_b32 v181, 1, v180
    v_and_b32 v181, 7, v181
    v_xor_b32 v181, v181, v179
    v_lshlrev_b32 v182, 7, v180
    v_add_u32 v182, s66, v182
    v_xor_b32 v236, 0, v181
    v_lshl_add_u32 v236, v236, 4, v182
    v_xor_b32 v237, 2, v181
    v_lshl_add_u32 v237, v237, 4, v182
    v_xor_b32 v238, 4, v181
    v_lshl_add_u32 v238, v238, 4, v182
    v_xor_b32 v239, 6, v181
    v_lshl_add_u32 v239, v239, 4, v182
    v_lshlrev_b32 v254, 10, v180
    v_lshl_add_u32 v254, v179, 4, v254
    v_lshlrev_b32 v250, 4, v180
    v_lshl_add_u32 v250, v179, 2, v250
    s_mov_b32 s86, 0x3f803f80
    v_mov_b32 v218, s86
    v_mov_b32 v219, s86
    v_mov_b32 v220, s86
    v_mov_b32 v221, s86
    v_mov_b32 v214, 0
    v_mov_b32 v215, 0
    v_mov_b32 v217, 0
    v_mov_b32 v234, 0
    v_mov_b32 v235, 0
    v_mov_b32 v226, 0
    v_mov_b32 v227, 0
    v_mov_b32 v228, 0
    v_mov_b32 v229, 0
    v_mov_b32 v230, 0
    v_mov_b32 v231, 0
    v_mov_b32 v232, 0
    v_mov_b32 v233, 0
    s_waitcnt lgkmcnt(0)
    s_mov_b32 s4, s36
    s_and_b32 s5, s37, 0xffff
    s_mov_b32 s6, 2097152
    s_mov_b32 s7, 0x20000
    s_mov_b32 s24, s48
    s_and_b32 s25, s49, 0xffff
    s_mov_b32 s26, 2097152
    s_mov_b32 s27, 0x20000
    s_mov_b32 s28, s52
    s_and_b32 s29, s53, 0xffff
    s_mov_b32 s30, 11534336
    s_mov_b32 s31, 0x20000
    s_mov_b32 s12, s40
    s_mov_b32 s13, s41
    s_mov_b32 s16, s44
    s_mov_b32 s17, s45
    s_mov_b32 s20, s46
    s_mov_b32 s21, s47
    s_mov_b32 s36, s93
    s_mov_b32 s37, s95
    s_mov_b32 s38, s96
    s_lshl_b32 s42, s99, 15
    s_add_u32 s42, s42, 0
    s_lshl_b32 s43, s99, 12
    s_add_u32 s43, s43, 9830400
    s_mul_i32 s59, s97, 3
    s_lshl_b32 s60, s97, 1
    s_add_u32 s60, s60, 11
    s_cmp_lt_u32 s97, 11
    s_cselect_b32 s57, s59, s60
    s_cselect_b32 s56, 3, 2
    s_mul_i32 s45, s99, 88064
    s_add_u32 s45, s45, 4194304
    s_add_u32 s59, s97, 0
    s_and_b32 s59, s59, 15
    s_lshl_b32 s59, s59, 11
    s_add_u32 s44, s45, s59
    s_lshl_b32 s59, s97, 1
    s_add_u32 s59, s59, 32
    s_add_u32 s60, s59, 32
    s_cmp_lt_u32 s59, 43
    s_cselect_b32 s59, s59, s60
    s_lshl_b32 s59, s59, 10
    s_add_u32 s49, s45, s59
    s_lshl_b32 s59, s97, 1
    s_add_u32 s59, s59, 33
    s_add_u32 s60, s59, 32
    s_cmp_lt_u32 s59, 43
    s_cselect_b32 s59, s59, s60
    s_lshl_b32 s59, s59, 10
    s_add_u32 s54, s45, s59
    s_lshr_b32 s59, s97, 3
    s_mul_i32 s59, s59, 44032
    s_add_u32 s45, s45, s59
    s_and_b32 s59, s97, 7
    s_lshl_b32 s59, s59, 12
    s_add_u32 s45, s45, s59
    s_lshl_b32 s59, s99, 7
    s_add_u32 s53, s59, 10919936
    s_lshl_b32 s60, s97, 2
    s_add_u32 s50, s59, s60
    s_add_u32 s50, s50, 10911744
    s_lshr_b32 s58, s38, 3
    s_lshl_b32 s94, s37, 2
    s_add_u32 s94, s94, s58
    s_lshl_b32 s94, s94, 1
    s_and_b32 s59, s36, 1
    s_add_u32 s94, s94, s59
    s_and_b32 s95, s38, 7
    s_lshl_b32 s95, s95, 1
    s_add_u32 s95, s95, s63
    s_lshl_b32 s59, s94, 15
    s_lshl_b32 s60, s95, 11
    s_add_u32 s48, s59, s60
    s_add_u32 s48, s48, 0
    s_lshl_b32 s60, s95, 6
    s_add_u32 s65, s59, s60
    s_mul_i32 s47, s94, 88064
    s_add_u32 s47, s47, 4194304
    s_lshl_b32 s60, s63, 14
    s_add_u32 s46, s47, s60
    s_mul_i32 s60, s63, 44032
    s_add_u32 s47, s47, s60
    s_lshl_b32 s55, s94, 12
    s_add_u32 s55, s55, 9830400
    s_lshl_b32 s59, s94, 7
    s_add_u32 s51, s59, 10911744
    s_lshl_b32 s60, s95, 2
    s_add_u32 s52, s59, s60
    s_add_u32 s52, s52, 10919936
    s_and_b32 s59, s95, 1
    s_lshl_b32 s59, s59, 3
    s_lshr_b32 s60, s95, 3
    s_lshl_b32 s60, s60, 9
    s_add_u32 s59, s59, s60
    s_and_b32 s60, s95, 6
    s_lshl_b32 s60, s60, 9
    s_add_u32 s59, s59, s60
    v_add_u32 v250, s59, v250
    s_mov_b32 s74, -1
    s_mov_b32 s75, 0
    s_mov_b32 s76, 0xffff
    s_mov_b32 s77, 0xffff
    s_mov_b32 s80, 0x3fb8aa3b
    s_mov_b32 s81, 0x3fb8aa3b
    s_mov_b32 s82, 0x358637bd
    s_mov_b32 s83, 0x358637bd
    s_mov_b32 s84, 1.0
    s_mov_b32 s85, 1.0
    v_mov_b32 v160, 0
    v_mov_b32 v161, 0
    v_mov_b32 v162, 0
    v_mov_b32 v163, 0
    s_waitcnt vmcnt(0) lgkmcnt(0)
    v_lshrrev_b32 v253, 1, v244
    v_add_u32 v252, s66, v253
    s_barrier
    ds_read_b128 v[0:3], v236 offset:0
    ds_read_b128 v[4:7], v237 offset:0
    ds_read_b128 v[8:11], v238 offset:0
    ds_read_b128 v[12:15], v239 offset:0
    ds_read_b64_tr_b16 v[176:177], v245 offset:0
    ds_read_b64_tr_b16 v[178:179], v246 offset:0
    ds_read_b64_tr_b16 v[180:181], v245 offset:32768
    ds_read_b64_tr_b16 v[182:183], v246 offset:32768
    ds_read_b64_tr_b16 v[184:185], v245 offset:1024
    ds_read_b64_tr_b16 v[186:187], v246 offset:1024
    ds_read_b64_tr_b16 v[188:189], v245 offset:33792
    ds_read_b64_tr_b16 v[190:191], v246 offset:33792
    s_waitcnt lgkmcnt(6)
    v_mfma_f32_32x32x16_bf16 v[128:143], v[0:3], v[176:179], 0
    ds_read_b64_tr_b16 v[192:193], v245 offset:2048
    ds_read_b64_tr_b16 v[194:195], v246 offset:2048
    s_waitcnt lgkmcnt(6)
    v_mfma_f32_32x32x16_bf16 v[144:159], v[0:3], v[180:183], 0
    ds_read_b64_tr_b16 v[196:197], v245 offset:34816
    ds_read_b64_tr_b16 v[198:199], v246 offset:34816
    v_lshlrev_b32 v164, 16, v8
    v_and_b32 v165, 0xffff0000, v8
    v_fmac_f32 v160, v164, v164
    v_fmac_f32 v162, v165, v165
    v_add_f32 v161, v161, v164
    v_add_f32 v163, v163, v165
    v_lshlrev_b32 v164, 16, v9
    v_and_b32 v165, 0xffff0000, v9
    v_fmac_f32 v160, v164, v164
    v_fmac_f32 v162, v165, v165
    v_add_f32 v161, v161, v164
    v_add_f32 v163, v163, v165
    v_lshlrev_b32 v164, 16, v10
    v_and_b32 v165, 0xffff0000, v10
    v_fmac_f32 v160, v164, v164
    v_fmac_f32 v162, v165, v165
    v_add_f32 v161, v161, v164
    v_add_f32 v163, v163, v165
    v_lshlrev_b32 v164, 16, v11
    v_and_b32 v165, 0xffff0000, v11
    v_fmac_f32 v160, v164, v164
    v_fmac_f32 v162, v165, v165
    v_add_f32 v161, v161, v164
    v_add_f32 v163, v163, v165
    s_waitcnt lgkmcnt(4)
    v_mfma_f32_32x32x16_bf16 v[128:143], v[4:7], v[184:187], v[128:143]
    ds_read_b64_tr_b16 v[176:177], v245 offset:3072
    ds_read_b64_tr_b16 v[178:179], v246 offset:3072
    v_mfma_f32_32x32x16_bf16 v[144:159], v[4:7], v[188:191], v[144:159]
    ds_read_b64_tr_b16 v[180:181], v245 offset:35840
    ds_read_b64_tr_b16 v[182:183], v246 offset:35840
    v_lshlrev_b32 v164, 16, v12
    v_and_b32 v165, 0xffff0000, v12
    v_fmac_f32 v160, v164, v164
    v_fmac_f32 v162, v165, v165
    v_add_f32 v161, v161, v164
    v_add_f32 v163, v163, v165
    v_lshlrev_b32 v164, 16, v13
    v_and_b32 v165, 0xffff0000, v13
    v_fmac_f32 v160, v164, v164
    v_fmac_f32 v162, v165, v165
    v_add_f32 v161, v161, v164
    v_add_f32 v163, v163, v165
    v_lshlrev_b32 v164, 16, v14
    v_and_b32 v165, 0xffff0000, v14
    v_fmac_f32 v160, v164, v164
    v_fmac_f32 v162, v165, v165
    v_add_f32 v161, v161, v164
    v_add_f32 v163, v163, v165
    v_lshlrev_b32 v164, 16, v15
    v_and_b32 v165, 0xffff0000, v15
    v_fmac_f32 v160, v164, v164
    v_fmac_f32 v162, v165, v165
    v_add_f32 v161, v161, v164
    v_add_f32 v163, v163, v165
    s_waitcnt lgkmcnt(4)
    v_mfma_f32_32x32x16_bf16 v[128:143], v[8:11], v[192:195], v[128:143]
    s_barrier
    ds_read_b128 v[16:19], v236 offset:4096
    ds_read_b128 v[20:23], v237 offset:4096
    ds_read_b128 v[24:27], v238 offset:4096
    ds_read_b128 v[28:31], v239 offset:4096
    ds_read_b64_tr_b16 v[184:185], v245 offset:4096
    ds_read_b64_tr_b16 v[186:187], v246 offset:4096
    v_mfma_f32_32x32x16_bf16 v[144:159], v[8:11], v[196:199], v[144:159]
    ds_read_b64_tr_b16 v[188:189], v245 offset:36864
    ds_read_b64_tr_b16 v[190:191], v246 offset:36864
    s_waitcnt lgkmcnt(8)
    v_mfma_f32_32x32x16_bf16 v[128:143], v[12:15], v[176:179], v[128:143]
    ds_read_b64_tr_b16 v[192:193], v245 offset:5120
    ds_read_b64_tr_b16 v[194:195], v246 offset:5120
    v_mfma_f32_32x32x16_bf16 v[144:159], v[12:15], v[180:183], v[144:159]
    ds_read_b64_tr_b16 v[196:197], v245 offset:37888
    ds_read_b64_tr_b16 v[198:199], v246 offset:37888
    s_waitcnt lgkmcnt(4)
    v_mfma_f32_32x32x16_bf16 v[128:143], v[16:19], v[184:187], v[128:143]
    ds_read_b64_tr_b16 v[176:177], v245 offset:6144
    ds_read_b64_tr_b16 v[178:179], v246 offset:6144
    v_mfma_f32_32x32x16_bf16 v[144:159], v[16:19], v[188:191], v[144:159]
    ds_read_b64_tr_b16 v[180:181], v245 offset:38912
    ds_read_b64_tr_b16 v[182:183], v246 offset:38912
    v_lshlrev_b32 v164, 16, v24
    v_and_b32 v165, 0xffff0000, v24
    v_fmac_f32 v160, v164, v164
    v_fmac_f32 v162, v165, v165
    v_add_f32 v161, v161, v164
    v_add_f32 v163, v163, v165
    v_lshlrev_b32 v164, 16, v25
    v_and_b32 v165, 0xffff0000, v25
    v_fmac_f32 v160, v164, v164
    v_fmac_f32 v162, v165, v165
    v_add_f32 v161, v161, v164
    v_add_f32 v163, v163, v165
    v_lshlrev_b32 v164, 16, v26
    v_and_b32 v165, 0xffff0000, v26
    v_fmac_f32 v160, v164, v164
    v_fmac_f32 v162, v165, v165
    v_add_f32 v161, v161, v164
    v_add_f32 v163, v163, v165
    v_lshlrev_b32 v164, 16, v27
    v_and_b32 v165, 0xffff0000, v27
    v_fmac_f32 v160, v164, v164
    v_fmac_f32 v162, v165, v165
    v_add_f32 v161, v161, v164
    v_add_f32 v163, v163, v165
    s_waitcnt lgkmcnt(4)
    v_mfma_f32_32x32x16_bf16 v[128:143], v[20:23], v[192:195], v[128:143]
    ds_read_b64_tr_b16 v[184:185], v245 offset:7168
    ds_read_b64_tr_b16 v[186:187], v246 offset:7168
    v_mfma_f32_32x32x16_bf16 v[144:159], v[20:23], v[196:199], v[144:159]
    ds_read_b64_tr_b16 v[188:189], v245 offset:39936
    ds_read_b64_tr_b16 v[190:191], v246 offset:39936
    v_lshlrev_b32 v164, 16, v28
    v_and_b32 v165, 0xffff0000, v28
    v_fmac_f32 v160, v164, v164
    v_fmac_f32 v162, v165, v165
    v_add_f32 v161, v161, v164
    v_add_f32 v163, v163, v165
    v_lshlrev_b32 v164, 16, v29
    v_and_b32 v165, 0xffff0000, v29
    v_fmac_f32 v160, v164, v164
    v_fmac_f32 v162, v165, v165
    v_add_f32 v161, v161, v164
    v_add_f32 v163, v163, v165
    v_lshlrev_b32 v164, 16, v30
    v_and_b32 v165, 0xffff0000, v30
    v_fmac_f32 v160, v164, v164
    v_fmac_f32 v162, v165, v165
    v_add_f32 v161, v161, v164
    v_add_f32 v163, v163, v165
    v_lshlrev_b32 v164, 16, v31
    v_and_b32 v165, 0xffff0000, v31
    v_fmac_f32 v160, v164, v164
    v_fmac_f32 v162, v165, v165
    v_add_f32 v161, v161, v164
    v_add_f32 v163, v163, v165
    s_waitcnt lgkmcnt(4)
    v_mfma_f32_32x32x16_bf16 v[128:143], v[24:27], v[176:179], v[128:143]
    s_barrier
    ds_read_b128 v[32:35], v236 offset:8192
    ds_read_b128 v[36:39], v237 offset:8192
    ds_read_b128 v[40:43], v238 offset:8192
    ds_read_b128 v[44:47], v239 offset:8192
    ds_read_b64_tr_b16 v[192:193], v245 offset:8192
    ds_read_b64_tr_b16 v[194:195], v246 offset:8192
    v_mfma_f32_32x32x16_bf16 v[144:159], v[24:27], v[180:183], v[144:159]
    ds_read_b64_tr_b16 v[196:197], v245 offset:40960
    ds_read_b64_tr_b16 v[198:199], v246 offset:40960
    s_waitcnt lgkmcnt(8)
    v_mfma_f32_32x32x16_bf16 v[128:143], v[28:31], v[184:187], v[128:143]
    ds_read_b64_tr_b16 v[176:177], v245 offset:9216
    ds_read_b64_tr_b16 v[178:179], v246 offset:9216
    v_mfma_f32_32x32x16_bf16 v[144:159], v[28:31], v[188:191], v[144:159]
    ds_read_b64_tr_b16 v[180:181], v245 offset:41984
    ds_read_b64_tr_b16 v[182:183], v246 offset:41984
    s_waitcnt lgkmcnt(4)
    v_mfma_f32_32x32x16_bf16 v[128:143], v[32:35], v[192:195], v[128:143]
    ds_read_b64_tr_b16 v[184:185], v245 offset:10240
    ds_read_b64_tr_b16 v[186:187], v246 offset:10240
    v_mfma_f32_32x32x16_bf16 v[144:159], v[32:35], v[196:199], v[144:159]
    ds_read_b64_tr_b16 v[188:189], v245 offset:43008
    ds_read_b64_tr_b16 v[190:191], v246 offset:43008
    v_lshlrev_b32 v164, 16, v40
    v_and_b32 v165, 0xffff0000, v40
    v_fmac_f32 v160, v164, v164
    v_fmac_f32 v162, v165, v165
    v_add_f32 v161, v161, v164
    v_add_f32 v163, v163, v165
    v_lshlrev_b32 v164, 16, v41
    v_and_b32 v165, 0xffff0000, v41
    v_fmac_f32 v160, v164, v164
    v_fmac_f32 v162, v165, v165
    v_add_f32 v161, v161, v164
    v_add_f32 v163, v163, v165
    v_lshlrev_b32 v164, 16, v42
    v_and_b32 v165, 0xffff0000, v42
    v_fmac_f32 v160, v164, v164
    v_fmac_f32 v162, v165, v165
    v_add_f32 v161, v161, v164
    v_add_f32 v163, v163, v165
    v_lshlrev_b32 v164, 16, v43
    v_and_b32 v165, 0xffff0000, v43
    v_fmac_f32 v160, v164, v164
    v_fmac_f32 v162, v165, v165
    v_add_f32 v161, v161, v164
    v_add_f32 v163, v163, v165
    s_waitcnt lgkmcnt(4)
    v_mfma_f32_32x32x16_bf16 v[128:143], v[36:39], v[176:179], v[128:143]
    ds_read_b64_tr_b16 v[192:193], v245 offset:11264
    ds_read_b64_tr_b16 v[194:195], v246 offset:11264
    v_mfma_f32_32x32x16_bf16 v[144:159], v[36:39], v[180:183], v[144:159]
    ds_read_b64_tr_b16 v[196:197], v245 offset:44032
    ds_read_b64_tr_b16 v[198:199], v246 offset:44032
    v_lshlrev_b32 v164, 16, v44
    v_and_b32 v165, 0xffff0000, v44
    v_fmac_f32 v160, v164, v164
    v_fmac_f32 v162, v165, v165
    v_add_f32 v161, v161, v164
    v_add_f32 v163, v163, v165
    v_lshlrev_b32 v164, 16, v45
    v_and_b32 v165, 0xffff0000, v45
    v_fmac_f32 v160, v164, v164
    v_fmac_f32 v162, v165, v165
    v_add_f32 v161, v161, v164
    v_add_f32 v163, v163, v165
    v_lshlrev_b32 v164, 16, v46
    v_and_b32 v165, 0xffff0000, v46
    v_fmac_f32 v160, v164, v164
    v_fmac_f32 v162, v165, v165
    v_add_f32 v161, v161, v164
    v_add_f32 v163, v163, v165
    v_lshlrev_b32 v164, 16, v47
    v_and_b32 v165, 0xffff0000, v47
    v_fmac_f32 v160, v164, v164
    v_fmac_f32 v162, v165, v165
    v_add_f32 v161, v161, v164
    v_add_f32 v163, v163, v165
    s_waitcnt lgkmcnt(4)
    v_mfma_f32_32x32x16_bf16 v[128:143], v[40:43], v[184:187], v[128:143]
    s_barrier
    ds_read_b128 v[48:51], v236 offset:12288
    ds_read_b128 v[52:55], v237 offset:12288
    ds_read_b128 v[56:59], v238 offset:12288
    ds_read_b128 v[60:63], v239 offset:12288
    ds_read_b64_tr_b16 v[176:177], v245 offset:12288
    ds_read_b64_tr_b16 v[178:179], v246 offset:12288
    v_mfma_f32_32x32x16_bf16 v[144:159], v[40:43], v[188:191], v[144:159]
    ds_read_b64_tr_b16 v[180:181], v245 offset:45056
    ds_read_b64_tr_b16 v[182:183], v246 offset:45056
    s_waitcnt lgkmcnt(8)
    v_mfma_f32_32x32x16_bf16 v[128:143], v[44:47], v[192:195], v[128:143]
    ds_read_b64_tr_b16 v[184:185], v245 offset:13312
    ds_read_b64_tr_b16 v[186:187], v246 offset:13312
    v_mfma_f32_32x32x16_bf16 v[144:159], v[44:47], v[196:199], v[144:159]
    ds_read_b64_tr_b16 v[188:189], v245 offset:46080
    ds_read_b64_tr_b16 v[190:191], v246 offset:46080
    s_waitcnt lgkmcnt(4)
    v_mfma_f32_32x32x16_bf16 v[128:143], v[48:51], v[176:179], v[128:143]
    ds_read_b64_tr_b16 v[192:193], v245 offset:14336
    ds_read_b64_tr_b16 v[194:195], v246 offset:14336
    v_mfma_f32_32x32x16_bf16 v[144:159], v[48:51], v[180:183], v[144:159]
    ds_read_b64_tr_b16 v[196:197], v245 offset:47104
    ds_read_b64_tr_b16 v[198:199], v246 offset:47104
    v_lshlrev_b32 v164, 16, v56
    v_and_b32 v165, 0xffff0000, v56
    v_fmac_f32 v160, v164, v164
    v_fmac_f32 v162, v165, v165
    v_add_f32 v161, v161, v164
    v_add_f32 v163, v163, v165
    v_lshlrev_b32 v164, 16, v57
    v_and_b32 v165, 0xffff0000, v57
    v_fmac_f32 v160, v164, v164
    v_fmac_f32 v162, v165, v165
    v_add_f32 v161, v161, v164
    v_add_f32 v163, v163, v165
    v_lshlrev_b32 v164, 16, v58
    v_and_b32 v165, 0xffff0000, v58
    v_fmac_f32 v160, v164, v164
    v_fmac_f32 v162, v165, v165
    v_add_f32 v161, v161, v164
    v_add_f32 v163, v163, v165
    v_lshlrev_b32 v164, 16, v59
    v_and_b32 v165, 0xffff0000, v59
    v_fmac_f32 v160, v164, v164
    v_fmac_f32 v162, v165, v165
    v_add_f32 v161, v161, v164
    v_add_f32 v163, v163, v165
    s_waitcnt lgkmcnt(4)
    v_mfma_f32_32x32x16_bf16 v[128:143], v[52:55], v[184:187], v[128:143]
    ds_read_b64_tr_b16 v[176:177], v245 offset:15360
    ds_read_b64_tr_b16 v[178:179], v246 offset:15360
    v_mfma_f32_32x32x16_bf16 v[144:159], v[52:55], v[188:191], v[144:159]
    ds_read_b64_tr_b16 v[180:181], v245 offset:48128
    ds_read_b64_tr_b16 v[182:183], v246 offset:48128
    v_lshlrev_b32 v164, 16, v60
    v_and_b32 v165, 0xffff0000, v60
    v_fmac_f32 v160, v164, v164
    v_fmac_f32 v162, v165, v165
    v_add_f32 v161, v161, v164
    v_add_f32 v163, v163, v165
    v_lshlrev_b32 v164, 16, v61
    v_and_b32 v165, 0xffff0000, v61
    v_fmac_f32 v160, v164, v164
    v_fmac_f32 v162, v165, v165
    v_add_f32 v161, v161, v164
    v_add_f32 v163, v163, v165
    v_lshlrev_b32 v164, 16, v62
    v_and_b32 v165, 0xffff0000, v62
    v_fmac_f32 v160, v164, v164
    v_fmac_f32 v162, v165, v165
    v_add_f32 v161, v161, v164
    v_add_f32 v163, v163, v165
    v_lshlrev_b32 v164, 16, v63
    v_and_b32 v165, 0xffff0000, v63
    v_fmac_f32 v160, v164, v164
    v_fmac_f32 v162, v165, v165
    v_add_f32 v161, v161, v164
    v_add_f32 v163, v163, v165
    s_waitcnt lgkmcnt(4)
    v_mfma_f32_32x32x16_bf16 v[128:143], v[56:59], v[192:195], v[128:143]
    s_barrier
    ds_read_b128 v[64:67], v236 offset:0
    ds_read_b128 v[68:71], v237 offset:0
    ds_read_b128 v[72:75], v238 offset:0
    ds_read_b128 v[76:79], v239 offset:0
    ds_read_b64_tr_b16 v[184:185], v245 offset:16384
    ds_read_b64_tr_b16 v[186:187], v246 offset:16384
    v_mfma_f32_32x32x16_bf16 v[144:159], v[56:59], v[196:199], v[144:159]
    ds_read_b64_tr_b16 v[188:189], v245 offset:49152
    ds_read_b64_tr_b16 v[190:191], v246 offset:49152
    s_waitcnt lgkmcnt(8)
    v_mfma_f32_32x32x16_bf16 v[128:143], v[60:63], v[176:179], v[128:143]
    ds_read_b64_tr_b16 v[192:193], v245 offset:17408
    ds_read_b64_tr_b16 v[194:195], v246 offset:17408
    v_mfma_f32_32x32x16_bf16 v[144:159], v[60:63], v[180:183], v[144:159]
    ds_read_b64_tr_b16 v[196:197], v245 offset:50176
    ds_read_b64_tr_b16 v[198:199], v246 offset:50176
    s_waitcnt lgkmcnt(4)
    v_mfma_f32_32x32x16_bf16 v[128:143], v[64:67], v[184:187], v[128:143]
    ds_read_b64_tr_b16 v[176:177], v245 offset:18432
    ds_read_b64_tr_b16 v[178:179], v246 offset:18432
    v_mfma_f32_32x32x16_bf16 v[144:159], v[64:67], v[188:191], v[144:159]
    ds_read_b64_tr_b16 v[180:181], v245 offset:51200
    ds_read_b64_tr_b16 v[182:183], v246 offset:51200
    v_lshlrev_b32 v164, 16, v72
    v_and_b32 v165, 0xffff0000, v72
    v_fmac_f32 v160, v164, v164
    v_fmac_f32 v162, v165, v165
    v_add_f32 v161, v161, v164
    v_add_f32 v163, v163, v165
    v_lshlrev_b32 v164, 16, v73
    v_and_b32 v165, 0xffff0000, v73
    v_fmac_f32 v160, v164, v164
    v_fmac_f32 v162, v165, v165
    v_add_f32 v161, v161, v164
    v_add_f32 v163, v163, v165
    v_lshlrev_b32 v164, 16, v74
    v_and_b32 v165, 0xffff0000, v74
    v_fmac_f32 v160, v164, v164
    v_fmac_f32 v162, v165, v165
    v_add_f32 v161, v161, v164
    v_add_f32 v163, v163, v165
    v_lshlrev_b32 v164, 16, v75
    v_and_b32 v165, 0xffff0000, v75
    v_fmac_f32 v160, v164, v164
    v_fmac_f32 v162, v165, v165
    v_add_f32 v161, v161, v164
    v_add_f32 v163, v163, v165
    s_waitcnt lgkmcnt(4)
    v_mfma_f32_32x32x16_bf16 v[128:143], v[68:71], v[192:195], v[128:143]
    ds_read_b64_tr_b16 v[184:185], v245 offset:19456
    ds_read_b64_tr_b16 v[186:187], v246 offset:19456
    v_mfma_f32_32x32x16_bf16 v[144:159], v[68:71], v[196:199], v[144:159]
    ds_read_b64_tr_b16 v[188:189], v245 offset:52224
    ds_read_b64_tr_b16 v[190:191], v246 offset:52224
    v_lshlrev_b32 v164, 16, v76
    v_and_b32 v165, 0xffff0000, v76
    v_fmac_f32 v160, v164, v164
    v_fmac_f32 v162, v165, v165
    v_add_f32 v161, v161, v164
    v_add_f32 v163, v163, v165
    v_lshlrev_b32 v164, 16, v77
    v_and_b32 v165, 0xffff0000, v77
    v_fmac_f32 v160, v164, v164
    v_fmac_f32 v162, v165, v165
    v_add_f32 v161, v161, v164
    v_add_f32 v163, v163, v165
    v_lshlrev_b32 v164, 16, v78
    v_and_b32 v165, 0xffff0000, v78
    v_fmac_f32 v160, v164, v164
    v_fmac_f32 v162, v165, v165
    v_add_f32 v161, v161, v164
    v_add_f32 v163, v163, v165
    v_lshlrev_b32 v164, 16, v79
    v_and_b32 v165, 0xffff0000, v79
    v_fmac_f32 v160, v164, v164
    v_fmac_f32 v162, v165, v165
    v_add_f32 v161, v161, v164
    v_add_f32 v163, v163, v165
    s_waitcnt lgkmcnt(4)
    v_mfma_f32_32x32x16_bf16 v[128:143], v[72:75], v[176:179], v[128:143]
    s_barrier
    ds_read_b128 v[80:83], v236 offset:4096
    ds_read_b128 v[84:87], v237 offset:4096
    ds_read_b128 v[88:91], v238 offset:4096
    ds_read_b128 v[92:95], v239 offset:4096
    ds_read_b64_tr_b16 v[192:193], v245 offset:20480
    ds_read_b64_tr_b16 v[194:195], v246 offset:20480
    v_mfma_f32_32x32x16_bf16 v[144:159], v[72:75], v[180:183], v[144:159]
    ds_read_b64_tr_b16 v[196:197], v245 offset:53248
    ds_read_b64_tr_b16 v[198:199], v246 offset:53248
    s_waitcnt lgkmcnt(8)
    v_mfma_f32_32x32x16_bf16 v[128:143], v[76:79], v[184:187], v[128:143]
    ds_read_b64_tr_b16 v[176:177], v245 offset:21504
    ds_read_b64_tr_b16 v[178:179], v246 offset:21504
    v_mfma_f32_32x32x16_bf16 v[144:159], v[76:79], v[188:191], v[144:159]
    ds_read_b64_tr_b16 v[180:181], v245 offset:54272
    ds_read_b64_tr_b16 v[182:183], v246 offset:54272
    s_waitcnt lgkmcnt(4)
    v_mfma_f32_32x32x16_bf16 v[128:143], v[80:83], v[192:195], v[128:143]
    ds_read_b64_tr_b16 v[184:185], v245 offset:22528
    ds_read_b64_tr_b16 v[186:187], v246 offset:22528
    v_mfma_f32_32x32x16_bf16 v[144:159], v[80:83], v[196:199], v[144:159]
    ds_read_b64_tr_b16 v[188:189], v245 offset:55296
    ds_read_b64_tr_b16 v[190:191], v246 offset:55296
    v_lshlrev_b32 v164, 16, v88
    v_and_b32 v165, 0xffff0000, v88
    v_fmac_f32 v160, v164, v164
    v_fmac_f32 v162, v165, v165
    v_add_f32 v161, v161, v164
    v_add_f32 v163, v163, v165
    v_lshlrev_b32 v164, 16, v89
    v_and_b32 v165, 0xffff0000, v89
    v_fmac_f32 v160, v164, v164
    v_fmac_f32 v162, v165, v165
    v_add_f32 v161, v161, v164
    v_add_f32 v163, v163, v165
    v_lshlrev_b32 v164, 16, v90
    v_and_b32 v165, 0xffff0000, v90
    v_fmac_f32 v160, v164, v164
    v_fmac_f32 v162, v165, v165
    v_add_f32 v161, v161, v164
    v_add_f32 v163, v163, v165
    v_lshlrev_b32 v164, 16, v91
    v_and_b32 v165, 0xffff0000, v91
    v_fmac_f32 v160, v164, v164
    v_fmac_f32 v162, v165, v165
    v_add_f32 v161, v161, v164
    v_add_f32 v163, v163, v165
    s_waitcnt lgkmcnt(4)
    v_mfma_f32_32x32x16_bf16 v[128:143], v[84:87], v[176:179], v[128:143]
    ds_read_b64_tr_b16 v[192:193], v245 offset:23552
    ds_read_b64_tr_b16 v[194:195], v246 offset:23552
    v_mfma_f32_32x32x16_bf16 v[144:159], v[84:87], v[180:183], v[144:159]
    ds_read_b64_tr_b16 v[196:197], v245 offset:56320
    ds_read_b64_tr_b16 v[198:199], v246 offset:56320
    v_lshlrev_b32 v164, 16, v92
    v_and_b32 v165, 0xffff0000, v92
    v_fmac_f32 v160, v164, v164
    v_fmac_f32 v162, v165, v165
    v_add_f32 v161, v161, v164
    v_add_f32 v163, v163, v165
    v_lshlrev_b32 v164, 16, v93
    v_and_b32 v165, 0xffff0000, v93
    v_fmac_f32 v160, v164, v164
    v_fmac_f32 v162, v165, v165
    v_add_f32 v161, v161, v164
    v_add_f32 v163, v163, v165
    v_lshlrev_b32 v164, 16, v94
    v_and_b32 v165, 0xffff0000, v94
    v_fmac_f32 v160, v164, v164
    v_fmac_f32 v162, v165, v165
    v_add_f32 v161, v161, v164
    v_add_f32 v163, v163, v165
    v_lshlrev_b32 v164, 16, v95
    v_and_b32 v165, 0xffff0000, v95
    v_fmac_f32 v160, v164, v164
    v_fmac_f32 v162, v165, v165
    v_add_f32 v161, v161, v164
    v_add_f32 v163, v163, v165
    s_waitcnt lgkmcnt(4)
    v_mfma_f32_32x32x16_bf16 v[128:143], v[88:91], v[184:187], v[128:143]
    s_barrier
    ds_read_b128 v[96:99], v236 offset:8192
    ds_read_b128 v[100:103], v237 offset:8192
    ds_read_b128 v[104:107], v238 offset:8192
    ds_read_b128 v[108:111], v239 offset:8192
    ds_read_b64_tr_b16 v[176:177], v245 offset:24576
    ds_read_b64_tr_b16 v[178:179], v246 offset:24576
    v_mfma_f32_32x32x16_bf16 v[144:159], v[88:91], v[188:191], v[144:159]
    ds_read_b64_tr_b16 v[180:181], v245 offset:57344
    ds_read_b64_tr_b16 v[182:183], v246 offset:57344
    s_waitcnt lgkmcnt(8)
    v_mfma_f32_32x32x16_bf16 v[128:143], v[92:95], v[192:195], v[128:143]
    ds_read_b64_tr_b16 v[184:185], v245 offset:25600
    ds_read_b64_tr_b16 v[186:187], v246 offset:25600
    v_mfma_f32_32x32x16_bf16 v[144:159], v[92:95], v[196:199], v[144:159]
    ds_read_b64_tr_b16 v[188:189], v245 offset:58368
    ds_read_b64_tr_b16 v[190:191], v246 offset:58368
    s_waitcnt lgkmcnt(4)
    v_mfma_f32_32x32x16_bf16 v[128:143], v[96:99], v[176:179], v[128:143]
    ds_read_b64_tr_b16 v[192:193], v245 offset:26624
    ds_read_b64_tr_b16 v[194:195], v246 offset:26624
    v_mfma_f32_32x32x16_bf16 v[144:159], v[96:99], v[180:183], v[144:159]
    ds_read_b64_tr_b16 v[196:197], v245 offset:59392
    ds_read_b64_tr_b16 v[198:199], v246 offset:59392
    v_lshlrev_b32 v164, 16, v104
    v_and_b32 v165, 0xffff0000, v104
    v_fmac_f32 v160, v164, v164
    v_fmac_f32 v162, v165, v165
    v_add_f32 v161, v161, v164
    v_add_f32 v163, v163, v165
    v_lshlrev_b32 v164, 16, v105
    v_and_b32 v165, 0xffff0000, v105
    v_fmac_f32 v160, v164, v164
    v_fmac_f32 v162, v165, v165
    v_add_f32 v161, v161, v164
    v_add_f32 v163, v163, v165
    v_lshlrev_b32 v164, 16, v106
    v_and_b32 v165, 0xffff0000, v106
    v_fmac_f32 v160, v164, v164
    v_fmac_f32 v162, v165, v165
    v_add_f32 v161, v161, v164
    v_add_f32 v163, v163, v165
    v_lshlrev_b32 v164, 16, v107
    v_and_b32 v165, 0xffff0000, v107
    v_fmac_f32 v160, v164, v164
    v_fmac_f32 v162, v165, v165
    v_add_f32 v161, v161, v164
    v_add_f32 v163, v163, v165
    s_waitcnt lgkmcnt(4)
    v_mfma_f32_32x32x16_bf16 v[128:143], v[100:103], v[184:187], v[128:143]
    ds_read_b64_tr_b16 v[176:177], v245 offset:27648
    ds_read_b64_tr_b16 v[178:179], v246 offset:27648
    v_mfma_f32_32x32x16_bf16 v[144:159], v[100:103], v[188:191], v[144:159]
    ds_read_b64_tr_b16 v[180:181], v245 offset:60416
    ds_read_b64_tr_b16 v[182:183], v246 offset:60416
    v_lshlrev_b32 v164, 16, v108
    v_and_b32 v165, 0xffff0000, v108
    v_fmac_f32 v160, v164, v164
    v_fmac_f32 v162, v165, v165
    v_add_f32 v161, v161, v164
    v_add_f32 v163, v163, v165
    v_lshlrev_b32 v164, 16, v109
    v_and_b32 v165, 0xffff0000, v109
    v_fmac_f32 v160, v164, v164
    v_fmac_f32 v162, v165, v165
    v_add_f32 v161, v161, v164
    v_add_f32 v163, v163, v165
    v_lshlrev_b32 v164, 16, v110
    v_and_b32 v165, 0xffff0000, v110
    v_fmac_f32 v160, v164, v164
    v_fmac_f32 v162, v165, v165
    v_add_f32 v161, v161, v164
    v_add_f32 v163, v163, v165
    v_lshlrev_b32 v164, 16, v111
    v_and_b32 v165, 0xffff0000, v111
    v_fmac_f32 v160, v164, v164
    v_fmac_f32 v162, v165, v165
    v_add_f32 v161, v161, v164
    v_add_f32 v163, v163, v165
    s_waitcnt lgkmcnt(4)
    v_mfma_f32_32x32x16_bf16 v[128:143], v[104:107], v[192:195], v[128:143]
    s_barrier
    ds_read_b128 v[112:115], v236 offset:12288
    ds_read_b128 v[116:119], v237 offset:12288
    ds_read_b128 v[120:123], v238 offset:12288
    ds_read_b128 v[124:127], v239 offset:12288
    ds_read_b64 v[166:167], v252
    ds_read_b64_tr_b16 v[184:185], v245 offset:28672
    ds_read_b64_tr_b16 v[186:187], v246 offset:28672
    v_mfma_f32_32x32x16_bf16 v[144:159], v[104:107], v[196:199], v[144:159]
    ds_read_b64_tr_b16 v[188:189], v245 offset:61440
    ds_read_b64_tr_b16 v[190:191], v246 offset:61440
    s_waitcnt lgkmcnt(9)
    v_mfma_f32_32x32x16_bf16 v[128:143], v[108:111], v[176:179], v[128:143]
    ds_read_b64_tr_b16 v[192:193], v245 offset:29696
    ds_read_b64_tr_b16 v[194:195], v246 offset:29696
    v_mfma_f32_32x32x16_bf16 v[144:159], v[108:111], v[180:183], v[144:159]
    ds_read_b64_tr_b16 v[196:197], v245 offset:62464
    ds_read_b64_tr_b16 v[198:199], v246 offset:62464
    s_waitcnt lgkmcnt(12)
    v_lshlrev_b32 v164, 16, v112
    v_and_b32 v165, 0xffff0000, v112
    v_fmac_f32 v160, v164, v164
    v_fmac_f32 v162, v165, v165
    v_add_f32 v161, v161, v164
    v_add_f32 v163, v163, v165
    v_lshlrev_b32 v164, 16, v113
    v_and_b32 v165, 0xffff0000, v113
    v_fmac_f32 v160, v164, v164
    v_fmac_f32 v162, v165, v165
    v_add_f32 v161, v161, v164
    v_add_f32 v163, v163, v165
    v_lshlrev_b32 v164, 16, v114
    v_and_b32 v165, 0xffff0000, v114
    v_fmac_f32 v160, v164, v164
    v_fmac_f32 v162, v165, v165
    v_add_f32 v161, v161, v164
    v_add_f32 v163, v163, v165
    v_lshlrev_b32 v164, 16, v115
    v_and_b32 v165, 0xffff0000, v115
    v_fmac_f32 v160, v164, v164
    v_fmac_f32 v162, v165, v165
    v_add_f32 v161, v161, v164
    v_add_f32 v163, v163, v165
    s_waitcnt lgkmcnt(4)
    v_mfma_f32_32x32x16_bf16 v[128:143], v[112:115], v[184:187], v[128:143]
    ds_read_b64_tr_b16 v[176:177], v245 offset:30720
    ds_read_b64_tr_b16 v[178:179], v246 offset:30720
    v_mfma_f32_32x32x16_bf16 v[144:159], v[112:115], v[188:191], v[144:159]
    ds_read_b64_tr_b16 v[180:181], v245 offset:63488
    ds_read_b64_tr_b16 v[182:183], v246 offset:63488
    v_lshlrev_b32 v164, 16, v116
    v_and_b32 v165, 0xffff0000, v116
    v_fmac_f32 v160, v164, v164
    v_fmac_f32 v162, v165, v165
    v_add_f32 v161, v161, v164
    v_add_f32 v163, v163, v165
    v_lshlrev_b32 v164, 16, v117
    v_and_b32 v165, 0xffff0000, v117
    v_fmac_f32 v160, v164, v164
    v_fmac_f32 v162, v165, v165
    v_add_f32 v161, v161, v164
    v_add_f32 v163, v163, v165
    v_lshlrev_b32 v164, 16, v118
    v_and_b32 v165, 0xffff0000, v118
    v_fmac_f32 v160, v164, v164
    v_fmac_f32 v162, v165, v165
    v_add_f32 v161, v161, v164
    v_add_f32 v163, v163, v165
    v_lshlrev_b32 v164, 16, v119
    v_and_b32 v165, 0xffff0000, v119
    v_fmac_f32 v160, v164, v164
    v_fmac_f32 v162, v165, v165
    v_add_f32 v161, v161, v164
    v_add_f32 v163, v163, v165
    s_waitcnt lgkmcnt(4)
    v_mfma_f32_32x32x16_bf16 v[128:143], v[116:119], v[192:195], v[128:143]
    ds_read_b64_tr_b16 v[184:185], v245 offset:31744
    ds_read_b64_tr_b16 v[186:187], v246 offset:31744
    v_mfma_f32_32x32x16_bf16 v[144:159], v[116:119], v[196:199], v[144:159]
    ds_read_b64_tr_b16 v[188:189], v245 offset:64512
    ds_read_b64_tr_b16 v[190:191], v246 offset:64512
    v_lshlrev_b32 v164, 16, v120
    v_and_b32 v165, 0xffff0000, v120
    v_fmac_f32 v160, v164, v164
    v_fmac_f32 v162, v165, v165
    v_add_f32 v161, v161, v164
    v_add_f32 v163, v163, v165
    v_lshlrev_b32 v164, 16, v121
    v_and_b32 v165, 0xffff0000, v121
    v_fmac_f32 v160, v164, v164
    v_fmac_f32 v162, v165, v165
    v_add_f32 v161, v161, v164
    v_add_f32 v163, v163, v165
    v_lshlrev_b32 v164, 16, v122
    v_and_b32 v165, 0xffff0000, v122
    v_fmac_f32 v160, v164, v164
    v_fmac_f32 v162, v165, v165
    v_add_f32 v161, v161, v164
    v_add_f32 v163, v163, v165
    v_lshlrev_b32 v164, 16, v123
    v_and_b32 v165, 0xffff0000, v123
    v_fmac_f32 v160, v164, v164
    v_fmac_f32 v162, v165, v165
    v_add_f32 v161, v161, v164
    v_add_f32 v163, v163, v165
    s_waitcnt lgkmcnt(4)
    v_mfma_f32_32x32x16_bf16 v[128:143], v[120:123], v[176:179], v[128:143]
    v_mfma_f32_32x32x16_bf16 v[144:159], v[120:123], v[180:183], v[144:159]
    v_lshlrev_b32 v164, 16, v124
    v_and_b32 v165, 0xffff0000, v124
    v_fmac_f32 v160, v164, v164
    v_fmac_f32 v162, v165, v165
    v_add_f32 v161, v161, v164
    v_add_f32 v163, v163, v165
    v_lshlrev_b32 v164, 16, v125
    v_and_b32 v165, 0xffff0000, v125
    v_fmac_f32 v160, v164, v164
    v_fmac_f32 v162, v165, v165
    v_add_f32 v161, v161, v164
    v_add_f32 v163, v163, v165
    v_lshlrev_b32 v164, 16, v126
    v_and_b32 v165, 0xffff0000, v126
    v_fmac_f32 v160, v164, v164
    v_fmac_f32 v162, v165, v165
    v_add_f32 v161, v161, v164
    v_add_f32 v163, v163, v165
    v_lshlrev_b32 v164, 16, v127
    v_and_b32 v165, 0xffff0000, v127
    v_fmac_f32 v160, v164, v164
    v_fmac_f32 v162, v165, v165
    v_add_f32 v161, v161, v164
    v_add_f32 v163, v163, v165
    s_waitcnt lgkmcnt(0)
    v_mfma_f32_32x32x16_bf16 v[128:143], v[124:127], v[184:187], v[128:143]
    v_mfma_f32_32x32x16_bf16 v[144:159], v[124:127], v[188:191], v[144:159]
    v_lshrrev_b32 v253, 1, v244
    v_add_u32 v253, 98304, v253
    v_add_f32 v160, v160, v162
    v_add_f32 v161, v161, v163
    v_add_f32 v160, v160, v166
    v_add_f32 v161, v161, v167
    s_nop 1
    v_permlane32_swap_b32 v161, v160
    v_add_f32 v161, v161, v160
    v_mov_b32 v160, v161
    s_nop 1
    v_permlane32_swap_b32 v161, v160
    v_mul_f32 v238, 0xbb000000, v161
    v_mul_f32 v160, 0x3b000000, v160
    v_fma_f32 v160, -v238, v238, v160
    v_max_f32 v160, 0, v160
    v_add_f32 v160, 0x3727c5ac, v160
    v_rsq_f32 v251, v160
    v_cvt_pk_bf16_f32 v236, v238, v238
    v_and_b32 v236, 0xffff0000, v236
    v_sub_f32 v237, v238, v236
    v_cvt_pk_bf16_f32 v212, v236, v236
    v_cvt_pk_bf16_f32 v213, v237, 0
    v_cndmask_b32 v212, 0, v212, s[74:75]
    v_cndmask_b32 v213, 0, v213, s[74:75]
    v_cvt_pk_bf16_f32 v236, v251, v251
    v_and_b32 v236, 0xffff0000, v236
    v_sub_f32 v237, v251, v236
    v_cvt_pk_bf16_f32 v216, v236, v237
    v_cndmask_b32 v216, 0, v216, s[74:75]
    s_nop 1
    v_mfma_f32_32x32x16_bf16 v[160:175], v[214:217], v[218:221], 0
    s_barrier
    ds_read_b64 v[222:223], v253 offset:1024
    ds_read_b64 v[224:225], v253 offset:17408
    ds_read_b64 v[226:227], v253 offset:33792
    ds_read_b32 v240, v253 offset:2048
    s_waitcnt lgkmcnt(0)
    v_readfirstlane_b32 s40, v240
    v_mfma_f32_32x32x16_bf16 v[128:143], v[212:215], v[222:225], v[128:143]
    v_mfma_f32_32x32x16_bf16 v[144:159], v[212:215], v[224:227], v[144:159]
    s_nop 10
    v_pk_fma_f32 v[128:129], v[128:129], v[160:161], s[82:83]
    v_pk_fma_f32 v[130:131], v[130:131], v[162:163], s[82:83]
    v_pk_mul_f32 v[236:237], v[128:129], s[80:81]
    v_pk_mul_f32 v[238:239], v[130:131], s[80:81]
    v_exp_f32_e64 v236, v236 clamp
    v_exp_f32_e64 v237, v237 clamp
    v_exp_f32_e64 v238, v238 clamp
    v_exp_f32_e64 v239, v239 clamp
    v_max_f32 v128, s82, v128
    v_max_f32 v129, s82, v129
    v_max_f32 v130, s82, v130
    v_max_f32 v131, s82, v131
    v_pk_mul_f32 v[144:145], v[144:145], v[160:161]
    v_pk_mul_f32 v[146:147], v[146:147], v[162:163]
    v_pk_add_f32 v[128:129], v[128:129], v[236:237]
    v_pk_add_f32 v[130:131], v[130:131], v[238:239]
    v_cvt_pk_bf16_f32 v184, v144, v145
    v_cvt_pk_bf16_f32 v185, v146, v147
    v_cvt_pk_bf16_f32 v176, v128, v129
    v_cvt_pk_bf16_f32 v177, v130, v131
    v_pk_fma_f32 v[132:133], v[132:133], v[164:165], s[82:83]
    v_pk_fma_f32 v[134:135], v[134:135], v[166:167], s[82:83]
    v_pk_mul_f32 v[240:241], v[132:133], s[80:81]
    v_pk_mul_f32 v[242:243], v[134:135], s[80:81]
    v_exp_f32_e64 v240, v240 clamp
    v_exp_f32_e64 v241, v241 clamp
    v_exp_f32_e64 v242, v242 clamp
    v_exp_f32_e64 v243, v243 clamp
    v_max_f32 v132, s82, v132
    v_max_f32 v133, s82, v133
    v_max_f32 v134, s82, v134
    v_max_f32 v135, s82, v135
    v_pk_mul_f32 v[148:149], v[148:149], v[164:165]
    v_pk_mul_f32 v[150:151], v[150:151], v[166:167]
    v_pk_add_f32 v[132:133], v[132:133], v[240:241]
    v_pk_add_f32 v[134:135], v[134:135], v[242:243]
    v_cvt_pk_bf16_f32 v186, v148, v149
    v_cvt_pk_bf16_f32 v187, v150, v151
    v_cvt_pk_bf16_f32 v178, v132, v133
    v_cvt_pk_bf16_f32 v179, v134, v135
    s_nop 1
    v_mfma_f32_32x32x16_bf16 v[192:207], v[176:179], v[184:187], 0
    v_pk_fma_f32 v[136:137], v[136:137], v[168:169], s[82:83]
    v_pk_fma_f32 v[138:139], v[138:139], v[170:171], s[82:83]
    v_pk_mul_f32 v[236:237], v[136:137], s[80:81]
    v_pk_mul_f32 v[238:239], v[138:139], s[80:81]
    v_exp_f32_e64 v236, v236 clamp
    v_exp_f32_e64 v237, v237 clamp
    v_exp_f32_e64 v238, v238 clamp
    v_exp_f32_e64 v239, v239 clamp
    v_max_f32 v136, s82, v136
    v_max_f32 v137, s82, v137
    v_max_f32 v138, s82, v138
    v_max_f32 v139, s82, v139
    v_pk_mul_f32 v[152:153], v[152:153], v[168:169]
    v_pk_mul_f32 v[154:155], v[154:155], v[170:171]
    v_pk_add_f32 v[136:137], v[136:137], v[236:237]
    v_pk_add_f32 v[138:139], v[138:139], v[238:239]
    v_cvt_pk_bf16_f32 v188, v152, v153
    v_cvt_pk_bf16_f32 v189, v154, v155
    v_cvt_pk_bf16_f32 v180, v136, v137
    v_cvt_pk_bf16_f32 v181, v138, v139
    v_pk_fma_f32 v[140:141], v[140:141], v[172:173], s[82:83]
    v_pk_fma_f32 v[142:143], v[142:143], v[174:175], s[82:83]
    v_pk_mul_f32 v[240:241], v[140:141], s[80:81]
    v_pk_mul_f32 v[242:243], v[142:143], s[80:81]
    v_exp_f32_e64 v240, v240 clamp
    v_exp_f32_e64 v241, v241 clamp
    v_exp_f32_e64 v242, v242 clamp
    v_exp_f32_e64 v243, v243 clamp
    v_max_f32 v140, s82, v140
    v_max_f32 v141, s82, v141
    v_max_f32 v142, s82, v142
    v_max_f32 v143, s82, v143
    v_pk_mul_f32 v[156:157], v[156:157], v[172:173]
    v_pk_mul_f32 v[158:159], v[158:159], v[174:175]
    v_pk_add_f32 v[140:141], v[140:141], v[240:241]
    v_pk_add_f32 v[142:143], v[142:143], v[242:243]
    v_cvt_pk_bf16_f32 v190, v156, v157
    v_cvt_pk_bf16_f32 v191, v158, v159
    v_cvt_pk_bf16_f32 v182, v140, v141
    v_cvt_pk_bf16_f32 v183, v142, v143
    v_mfma_f32_32x32x16_bf16 v[144:159], v[176:179], v[218:221], 0
    s_nop 0
    v_mfma_f32_32x32x16_bf16 v[192:207], v[180:183], v[188:191], v[192:207]
    v_mfma_f32_32x32x16_bf16 v[144:159], v[180:183], v[218:221], v[144:159]
    s_lshl_b32 s59, s36, 12
    v_add_u32 v252, s59, v244
    v_add_u32 v236, 65536, v245
    v_add_u32 v237, 65536, v246
    s_nop 7
    v_cndmask_b32 v192, v144, v192, s[76:77]
    v_cndmask_b32 v193, v145, v193, s[76:77]
    v_cndmask_b32 v194, v146, v194, s[76:77]
    v_cndmask_b32 v195, v147, v195, s[76:77]
    ds_write_b128 v252, v[192:195] offset:49152
    v_cndmask_b32 v196, v148, v196, s[76:77]
    v_cndmask_b32 v197, v149, v197, s[76:77]
    v_cndmask_b32 v198, v150, v198, s[76:77]
    v_cndmask_b32 v199, v151, v199, s[76:77]
    ds_write_b128 v252, v[196:199] offset:50176
    v_cndmask_b32 v200, v200, v152, s[76:77]
    v_cndmask_b32 v201, v201, v153, s[76:77]
    v_cndmask_b32 v202, v202, v154, s[76:77]
    v_cndmask_b32 v203, v203, v155, s[76:77]
    ds_write_b128 v252, v[200:203] offset:51200
    v_cndmask_b32 v204, v204, v156, s[76:77]
    v_cndmask_b32 v205, v205, v157, s[76:77]
    v_cndmask_b32 v206, v206, v158, s[76:77]
    v_cndmask_b32 v207, v207, v159, s[76:77]
    ds_write_b128 v252, v[204:207] offset:52224
    s_waitcnt lgkmcnt(0)
    s_barrier
    ds_read_b64_tr_b16 v[176:177], v236 offset:0
    ds_read_b64_tr_b16 v[178:179], v237 offset:0
    ds_read_b64_tr_b16 v[180:181], v236 offset:1024
    ds_read_b64_tr_b16 v[182:183], v237 offset:1024
    ds_read_b64_tr_b16 v[184:185], v236 offset:2048
    ds_read_b64_tr_b16 v[186:187], v237 offset:2048
    ds_read_b64_tr_b16 v[188:189], v236 offset:3072
    ds_read_b64_tr_b16 v[190:191], v237 offset:3072
    s_waitcnt lgkmcnt(6)
    v_mfma_f32_32x32x16_bf16 v[160:175], v[176:179], v[0:3], 0
    ds_read_b64_tr_b16 v[192:193], v236 offset:4096
    ds_read_b64_tr_b16 v[194:195], v237 offset:4096
    s_waitcnt lgkmcnt(6)
    v_mfma_f32_32x32x16_bf16 v[160:175], v[180:183], v[4:7], v[160:175]
    ds_read_b64_tr_b16 v[176:177], v236 offset:5120
    ds_read_b64_tr_b16 v[178:179], v237 offset:5120
    s_waitcnt lgkmcnt(6)
    v_mfma_f32_32x32x16_bf16 v[160:175], v[184:187], v[8:11], v[160:175]
    ds_read_b64_tr_b16 v[180:181], v236 offset:6144
    ds_read_b64_tr_b16 v[182:183], v237 offset:6144
    s_waitcnt lgkmcnt(6)
    v_mfma_f32_32x32x16_bf16 v[160:175], v[188:191], v[12:15], v[160:175]
    ds_read_b64_tr_b16 v[184:185], v236 offset:7168
    ds_read_b64_tr_b16 v[186:187], v237 offset:7168
    s_waitcnt lgkmcnt(6)
    v_mfma_f32_32x32x16_bf16 v[160:175], v[192:195], v[16:19], v[160:175]
    ds_read_b64_tr_b16 v[188:189], v236 offset:8192
    ds_read_b64_tr_b16 v[190:191], v237 offset:8192
    s_waitcnt lgkmcnt(6)
    v_mfma_f32_32x32x16_bf16 v[160:175], v[176:179], v[20:23], v[160:175]
    ds_read_b64_tr_b16 v[192:193], v236 offset:9216
    ds_read_b64_tr_b16 v[194:195], v237 offset:9216
    s_waitcnt lgkmcnt(6)
    v_mfma_f32_32x32x16_bf16 v[160:175], v[180:183], v[24:27], v[160:175]
    ds_read_b64_tr_b16 v[176:177], v236 offset:10240
    ds_read_b64_tr_b16 v[178:179], v237 offset:10240
    s_waitcnt lgkmcnt(6)
    v_mfma_f32_32x32x16_bf16 v[160:175], v[184:187], v[28:31], v[160:175]
    ds_read_b64_tr_b16 v[180:181], v236 offset:11264
    ds_read_b64_tr_b16 v[182:183], v237 offset:11264
    s_waitcnt lgkmcnt(6)
    v_mfma_f32_32x32x16_bf16 v[160:175], v[188:191], v[32:35], v[160:175]
    ds_read_b64_tr_b16 v[184:185], v236 offset:12288
    ds_read_b64_tr_b16 v[186:187], v237 offset:12288
    s_waitcnt lgkmcnt(6)
    v_mfma_f32_32x32x16_bf16 v[160:175], v[192:195], v[36:39], v[160:175]
    ds_read_b64_tr_b16 v[188:189], v236 offset:13312
    ds_read_b64_tr_b16 v[190:191], v237 offset:13312
    s_waitcnt lgkmcnt(6)
    v_mfma_f32_32x32x16_bf16 v[160:175], v[176:179], v[40:43], v[160:175]
    s_barrier
    ds_read_b64_tr_b16 v[192:193], v236 offset:14336
    ds_read_b64_tr_b16 v[194:195], v237 offset:14336
    s_waitcnt lgkmcnt(6)
    v_mfma_f32_32x32x16_bf16 v[160:175], v[180:183], v[44:47], v[160:175]
    ds_read_b64_tr_b16 v[176:177], v236 offset:15360
    ds_read_b64_tr_b16 v[178:179], v237 offset:15360
    s_waitcnt lgkmcnt(6)
    v_mfma_f32_32x32x16_bf16 v[160:175], v[184:187], v[48:51], v[160:175]
    ds_read_b64_tr_b16 v[180:181], v236 offset:16384
    ds_read_b64_tr_b16 v[182:183], v237 offset:16384
    s_waitcnt lgkmcnt(6)
    v_mfma_f32_32x32x16_bf16 v[160:175], v[188:191], v[52:55], v[160:175]
    ds_read_b64_tr_b16 v[184:185], v236 offset:17408
    ds_read_b64_tr_b16 v[186:187], v237 offset:17408
    s_waitcnt lgkmcnt(6)
    v_mfma_f32_32x32x16_bf16 v[160:175], v[192:195], v[56:59], v[160:175]
    ds_read_b64_tr_b16 v[188:189], v236 offset:18432
    ds_read_b64_tr_b16 v[190:191], v237 offset:18432
    s_waitcnt lgkmcnt(6)
    v_mfma_f32_32x32x16_bf16 v[160:175], v[176:179], v[60:63], v[160:175]
    ds_read_b64_tr_b16 v[192:193], v236 offset:19456
    ds_read_b64_tr_b16 v[194:195], v237 offset:19456
    s_waitcnt lgkmcnt(6)
    v_mfma_f32_32x32x16_bf16 v[160:175], v[180:183], v[64:67], v[160:175]
    ds_read_b64_tr_b16 v[176:177], v236 offset:20480
    ds_read_b64_tr_b16 v[178:179], v237 offset:20480
    s_waitcnt lgkmcnt(6)
    v_mfma_f32_32x32x16_bf16 v[160:175], v[184:187], v[68:71], v[160:175]
    ds_read_b64_tr_b16 v[180:181], v236 offset:21504
    ds_read_b64_tr_b16 v[182:183], v237 offset:21504
    s_waitcnt lgkmcnt(6)
    v_mfma_f32_32x32x16_bf16 v[160:175], v[188:191], v[72:75], v[160:175]
    ds_read_b64_tr_b16 v[184:185], v236 offset:22528
    ds_read_b64_tr_b16 v[186:187], v237 offset:22528
    s_waitcnt lgkmcnt(6)
    v_mfma_f32_32x32x16_bf16 v[160:175], v[192:195], v[76:79], v[160:175]
    ds_read_b64_tr_b16 v[188:189], v236 offset:23552
    ds_read_b64_tr_b16 v[190:191], v237 offset:23552
    s_waitcnt lgkmcnt(6)
    v_mfma_f32_32x32x16_bf16 v[160:175], v[176:179], v[80:83], v[160:175]
    ds_read_b64_tr_b16 v[192:193], v236 offset:24576
    ds_read_b64_tr_b16 v[194:195], v237 offset:24576
    s_waitcnt lgkmcnt(6)
    v_mfma_f32_32x32x16_bf16 v[160:175], v[180:183], v[84:87], v[160:175]
    ds_read_b64_tr_b16 v[176:177], v236 offset:25600
    ds_read_b64_tr_b16 v[178:179], v237 offset:25600
    s_waitcnt lgkmcnt(6)
    v_mfma_f32_32x32x16_bf16 v[160:175], v[184:187], v[88:91], v[160:175]
    ds_read_b64_tr_b16 v[180:181], v236 offset:26624
    ds_read_b64_tr_b16 v[182:183], v237 offset:26624
    s_waitcnt lgkmcnt(6)
    v_mfma_f32_32x32x16_bf16 v[160:175], v[188:191], v[92:95], v[160:175]
    ds_read_b64_tr_b16 v[184:185], v236 offset:27648
    ds_read_b64_tr_b16 v[186:187], v237 offset:27648
    s_waitcnt lgkmcnt(6)
    v_mfma_f32_32x32x16_bf16 v[160:175], v[192:195], v[96:99], v[160:175]
    ds_read_b64_tr_b16 v[188:189], v236 offset:28672
    ds_read_b64_tr_b16 v[190:191], v237 offset:28672
    s_waitcnt lgkmcnt(6)
    v_mfma_f32_32x32x16_bf16 v[160:175], v[176:179], v[100:103], v[160:175]
    ds_read_b64_tr_b16 v[192:193], v236 offset:29696
    ds_read_b64_tr_b16 v[194:195], v237 offset:29696
    s_waitcnt lgkmcnt(6)
    v_mfma_f32_32x32x16_bf16 v[160:175], v[180:183], v[104:107], v[160:175]
    ds_read_b64_tr_b16 v[176:177], v236 offset:30720
    ds_read_b64_tr_b16 v[178:179], v237 offset:30720
    s_waitcnt lgkmcnt(6)
    v_mfma_f32_32x32x16_bf16 v[160:175], v[184:187], v[108:111], v[160:175]
    ds_read_b64_tr_b16 v[180:181], v236 offset:31744
    ds_read_b64_tr_b16 v[182:183], v237 offset:31744
    s_waitcnt lgkmcnt(6)
    v_mfma_f32_32x32x16_bf16 v[160:175], v[188:191], v[112:115], v[160:175]
    s_waitcnt lgkmcnt(4)
    v_mfma_f32_32x32x16_bf16 v[160:175], v[192:195], v[116:119], v[160:175]
    s_waitcnt lgkmcnt(2)
    v_mfma_f32_32x32x16_bf16 v[160:175], v[176:179], v[120:123], v[160:175]
    s_waitcnt lgkmcnt(0)
    v_mfma_f32_32x32x16_bf16 v[160:175], v[180:183], v[124:127], v[160:175]
    v_mfma_f32_32x32x16_bf16 v[160:175], v[226:229], v[212:215], v[160:175]
    v_mul_f32 v253, s80, v251
    v_mov_b32 v252, v251
    s_nop 9
    v_pk_mul_f32 v[236:237], v[160:161], v[252:253] op_sel:[0,1] op_sel_hi:[1,1]
    v_pk_mul_f32 v[238:239], v[162:163], v[252:253] op_sel:[0,1] op_sel_hi:[1,1]
    v_max_f32 v160, 0, v160
    v_max_f32 v161, 0, v161
    v_max_f32 v162, 0, v162
    v_max_f32 v163, 0, v163
    v_exp_f32_e64 v236, v236 clamp
    v_exp_f32_e64 v237, v237 clamp
    v_exp_f32_e64 v238, v238 clamp
    v_exp_f32_e64 v239, v239 clamp
    v_pk_fma_f32 v[160:161], v[160:161], v[252:253], s[82:83] op_sel_hi:[1,0,1]
    v_pk_fma_f32 v[162:163], v[162:163], v[252:253], s[82:83] op_sel_hi:[1,0,1]
    v_pk_add_f32 v[160:161], v[160:161], v[236:237]
    v_pk_add_f32 v[162:163], v[162:163], v[238:239]
    v_cvt_pk_bf16_f32 v176, v160, v161
    v_cvt_pk_bf16_f32 v177, v162, v163
    v_pk_mul_f32 v[240:241], v[164:165], v[252:253] op_sel:[0,1] op_sel_hi:[1,1]
    v_pk_mul_f32 v[242:243], v[166:167], v[252:253] op_sel:[0,1] op_sel_hi:[1,1]
    v_max_f32 v164, 0, v164
    v_max_f32 v165, 0, v165
    v_max_f32 v166, 0, v166
    v_max_f32 v167, 0, v167
    v_exp_f32_e64 v240, v240 clamp
    v_exp_f32_e64 v241, v241 clamp
    v_exp_f32_e64 v242, v242 clamp
    v_exp_f32_e64 v243, v243 clamp
    v_pk_fma_f32 v[164:165], v[164:165], v[252:253], s[82:83] op_sel_hi:[1,0,1]
    v_pk_fma_f32 v[166:167], v[166:167], v[252:253], s[82:83] op_sel_hi:[1,0,1]
    v_pk_add_f32 v[164:165], v[164:165], v[240:241]
    v_pk_add_f32 v[166:167], v[166:167], v[242:243]
    v_cvt_pk_bf16_f32 v178, v164, v165
    v_cvt_pk_bf16_f32 v179, v166, v167
    v_pk_mul_f32 v[236:237], v[168:169], v[252:253] op_sel:[0,1] op_sel_hi:[1,1]
    v_pk_mul_f32 v[238:239], v[170:171], v[252:253] op_sel:[0,1] op_sel_hi:[1,1]
    v_max_f32 v168, 0, v168
    v_max_f32 v169, 0, v169
    v_max_f32 v170, 0, v170
    v_max_f32 v171, 0, v171
    v_exp_f32_e64 v236, v236 clamp
    v_exp_f32_e64 v237, v237 clamp
    v_exp_f32_e64 v238, v238 clamp
    v_exp_f32_e64 v239, v239 clamp
    v_pk_fma_f32 v[168:169], v[168:169], v[252:253], s[82:83] op_sel_hi:[1,0,1]
    v_pk_fma_f32 v[170:171], v[170:171], v[252:253], s[82:83] op_sel_hi:[1,0,1]
    v_pk_add_f32 v[168:169], v[168:169], v[236:237]
    v_pk_add_f32 v[170:171], v[170:171], v[238:239]
    v_cvt_pk_bf16_f32 v180, v168, v169
    v_cvt_pk_bf16_f32 v181, v170, v171
    v_pk_mul_f32 v[240:241], v[172:173], v[252:253] op_sel:[0,1] op_sel_hi:[1,1]
    v_pk_mul_f32 v[242:243], v[174:175], v[252:253] op_sel:[0,1] op_sel_hi:[1,1]
    v_max_f32 v172, 0, v172
    v_max_f32 v173, 0, v173
    v_max_f32 v174, 0, v174
    v_max_f32 v175, 0, v175
    v_exp_f32_e64 v240, v240 clamp
    v_exp_f32_e64 v241, v241 clamp
    v_exp_f32_e64 v242, v242 clamp
    v_exp_f32_e64 v243, v243 clamp
    v_pk_fma_f32 v[172:173], v[172:173], v[252:253], s[82:83] op_sel_hi:[1,0,1]
    v_pk_fma_f32 v[174:175], v[174:175], v[252:253], s[82:83] op_sel_hi:[1,0,1]
    v_pk_add_f32 v[172:173], v[172:173], v[240:241]
    v_pk_add_f32 v[174:175], v[174:175], v[242:243]
    v_cvt_pk_bf16_f32 v182, v172, v173
    v_cvt_pk_bf16_f32 v183, v174, v175
    v_add_u32 v0, 49152, v244
    s_barrier
    ds_read_b128 v[184:187], v0 offset:0
    ds_read_b128 v[188:191], v0 offset:2048
    s_waitcnt lgkmcnt(1)
    v_mfma_f32_32x32x16_bf16 v[128:143], v[184:187], v[176:179], 0
    s_waitcnt lgkmcnt(0)
    v_mfma_f32_32x32x16_bf16 v[144:159], v[188:191], v[180:183], 0
    s_nop 9
    v_add_f32 v252, s82, v136
    v_rcp_f32 v252, v252
    s_nop 0
    v_pk_mul_f32 v[128:129], v[128:129], v[252:253] op_sel_hi:[1,0]
    v_pk_mul_f32 v[130:131], v[130:131], v[252:253] op_sel_hi:[1,0]
    v_pk_mul_f32 v[132:133], v[132:133], v[252:253] op_sel_hi:[1,0]
    v_pk_mul_f32 v[134:135], v[134:135], v[252:253] op_sel_hi:[1,0]
    v_cvt_pk_bf16_f32 v192, v128, v129
    v_cvt_pk_bf16_f32 v193, v130, v131
    v_cvt_pk_bf16_f32 v194, v132, v133
    v_cvt_pk_bf16_f32 v195, v134, v135
    s_cmp_eq_u32 s40, 1
    s_cbranch_scc0 Lf_16
    buffer_store_dwordx4 v[192:195], v244, s[28:31], s44 offen offset:0 nt
Le_17:
    v_add_f32 v252, s82, v144
    v_rcp_f32 v252, v252
    s_nop 0
    v_pk_mul_f32 v[152:153], v[152:153], v[252:253] op_sel_hi:[1,0]
    v_pk_mul_f32 v[154:155], v[154:155], v[252:253] op_sel_hi:[1,0]
    v_pk_mul_f32 v[156:157], v[156:157], v[252:253] op_sel_hi:[1,0]
    v_pk_mul_f32 v[158:159], v[158:159], v[252:253] op_sel_hi:[1,0]
    v_cvt_pk_bf16_f32 v196, v152, v153
    v_cvt_pk_bf16_f32 v197, v154, v155
    v_cvt_pk_bf16_f32 v198, v156, v157
    v_cvt_pk_bf16_f32 v199, v158, v159
    s_cmp_eq_u32 s40, 1
    s_cbranch_scc0 Lf_18
    buffer_store_dwordx4 v[196:199], v244, s[28:31], s44 offen offset:1024 nt
Le_19:
    s_barrier
    s_waitcnt vmcnt(0)
    v_mov_b32 v252, 1
    s_mov_b64 exec, 1
    s_cmp_eq_u32 s40, 1
    s_cbranch_scc0 Lf_20
    buffer_store_dword v252, off, s[28:31], s50
Le_21:
    s_mov_b64 exec, -1
    v_lshrrev_b32 v253, 2, v244
    v_and_b32 v253, 60, v253
    s_mov_b32 s61, 0
Lpoll_22:
    buffer_load_dword v252, v253, s[28:31], s51 offen sc1
    s_add_u32 s61, s61, 1
    s_cmp_gt_u32 s61, 262144
    s_cbranch_scc1 L_end
    s_waitcnt vmcnt(0)
    v_cmp_gt_i32 vcc, 1, v252
    s_nop 3
    s_cbranch_vccnz Lpoll_22
    s_add_u32 s59, s46, 0
    buffer_load_dwordx4 v[0:3], v244, s[28:31], s59 offen offset:0 sc1
    buffer_load_dwordx4 v[4:7], v244, s[28:31], s59 offen offset:1024 sc1
    buffer_load_dwordx4 v[8:11], v244, s[28:31], s59 offen offset:2048 sc1
    buffer_load_dwordx4 v[12:15], v244, s[28:31], s59 offen offset:3072 sc1
    s_add_u32 s59, s46, 4096
    buffer_load_dwordx4 v[16:19], v244, s[28:31], s59 offen offset:0 sc1
    buffer_load_dwordx4 v[20:23], v244, s[28:31], s59 offen offset:1024 sc1
    buffer_load_dwordx4 v[24:27], v244, s[28:31], s59 offen offset:2048 sc1
    buffer_load_dwordx4 v[28:31], v244, s[28:31], s59 offen offset:3072 sc1
    s_add_u32 s59, s46, 8192
    buffer_load_dwordx4 v[32:35], v244, s[28:31], s59 offen offset:0 sc1
    ds_read_b64_tr_b16 v[176:177], v248 offset:0
    ds_read_b64_tr_b16 v[178:179], v248 offset:1024
    ds_read_b64_tr_b16 v[180:181], v249 offset:0
    ds_read_b64_tr_b16 v[182:183], v249 offset:1024
    ds_read_b64_tr_b16 v[184:185], v248 offset:2048
    ds_read_b64_tr_b16 v[186:187], v248 offset:3072
    ds_read_b64_tr_b16 v[188:189], v249 offset:2048
    ds_read_b64_tr_b16 v[190:191], v249 offset:3072
    s_waitcnt vmcnt(8) lgkmcnt(6)
    v_mfma_f32_32x32x16_bf16 v[128:143], v[176:179], v[0:3], 0
    ds_read_b64_tr_b16 v[192:193], v248 offset:4096
    ds_read_b64_tr_b16 v[194:195], v248 offset:5120
    buffer_load_dwordx4 v[36:39], v244, s[28:31], s59 offen offset:1024 sc1
    s_waitcnt lgkmcnt(6)
    v_mfma_f32_32x32x16_bf16 v[144:159], v[180:183], v[0:3], 0
    ds_read_b64_tr_b16 v[196:197], v249 offset:4096
    ds_read_b64_tr_b16 v[198:199], v249 offset:5120
    s_waitcnt vmcnt(8) lgkmcnt(4)
    v_mfma_f32_32x32x16_bf16 v[128:143], v[184:187], v[4:7], v[128:143]
    ds_read_b64_tr_b16 v[176:177], v248 offset:6144
    ds_read_b64_tr_b16 v[178:179], v248 offset:7168
    buffer_load_dwordx4 v[40:43], v244, s[28:31], s59 offen offset:2048 sc1
    v_mfma_f32_32x32x16_bf16 v[144:159], v[188:191], v[4:7], v[144:159]
    ds_read_b64_tr_b16 v[180:181], v249 offset:6144
    ds_read_b64_tr_b16 v[182:183], v249 offset:7168
    s_waitcnt vmcnt(8) lgkmcnt(4)
    v_mfma_f32_32x32x16_bf16 v[128:143], v[192:195], v[8:11], v[128:143]
    ds_read_b64_tr_b16 v[184:185], v248 offset:8192
    ds_read_b64_tr_b16 v[186:187], v248 offset:9216
    buffer_load_dwordx4 v[44:47], v244, s[28:31], s59 offen offset:3072 sc1
    v_mfma_f32_32x32x16_bf16 v[144:159], v[196:199], v[8:11], v[144:159]
    ds_read_b64_tr_b16 v[188:189], v249 offset:8192
    ds_read_b64_tr_b16 v[190:191], v249 offset:9216
    s_waitcnt vmcnt(8) lgkmcnt(4)
    v_mfma_f32_32x32x16_bf16 v[128:143], v[176:179], v[12:15], v[128:143]
    ds_read_b64_tr_b16 v[192:193], v248 offset:10240
    ds_read_b64_tr_b16 v[194:195], v248 offset:11264
    s_add_u32 s59, s46, 12288
    buffer_load_dwordx4 v[48:51], v244, s[28:31], s59 offen offset:0 sc1
    v_mfma_f32_32x32x16_bf16 v[144:159], v[180:183], v[12:15], v[144:159]
    ds_read_b64_tr_b16 v[196:197], v249 offset:10240
    ds_read_b64_tr_b16 v[198:199], v249 offset:11264
    s_waitcnt vmcnt(8) lgkmcnt(4)
    v_mfma_f32_32x32x16_bf16 v[128:143], v[184:187], v[16:19], v[128:143]
    ds_read_b64_tr_b16 v[176:177], v248 offset:12288
    ds_read_b64_tr_b16 v[178:179], v248 offset:13312
    buffer_load_dwordx4 v[52:55], v244, s[28:31], s59 offen offset:1024 sc1
    v_mfma_f32_32x32x16_bf16 v[144:159], v[188:191], v[16:19], v[144:159]
    ds_read_b64_tr_b16 v[180:181], v249 offset:12288
    ds_read_b64_tr_b16 v[182:183], v249 offset:13312
    s_waitcnt vmcnt(8) lgkmcnt(4)
    v_mfma_f32_32x32x16_bf16 v[128:143], v[192:195], v[20:23], v[128:143]
    ds_read_b64_tr_b16 v[184:185], v248 offset:14336
    ds_read_b64_tr_b16 v[186:187], v248 offset:15360
    buffer_load_dwordx4 v[56:59], v244, s[28:31], s59 offen offset:2048 sc1
    v_mfma_f32_32x32x16_bf16 v[144:159], v[196:199], v[20:23], v[144:159]
    ds_read_b64_tr_b16 v[188:189], v249 offset:14336
    ds_read_b64_tr_b16 v[190:191], v249 offset:15360
    s_waitcnt vmcnt(8) lgkmcnt(4)
    v_mfma_f32_32x32x16_bf16 v[128:143], v[176:179], v[24:27], v[128:143]
    ds_read_b64_tr_b16 v[192:193], v248 offset:16384
    ds_read_b64_tr_b16 v[194:195], v248 offset:17408
    buffer_load_dwordx4 v[60:63], v244, s[28:31], s59 offen offset:3072 sc1
    v_mfma_f32_32x32x16_bf16 v[144:159], v[180:183], v[24:27], v[144:159]
    ds_read_b64_tr_b16 v[196:197], v249 offset:16384
    ds_read_b64_tr_b16 v[198:199], v249 offset:17408
    s_waitcnt vmcnt(8) lgkmcnt(4)
    v_mfma_f32_32x32x16_bf16 v[128:143], v[184:187], v[28:31], v[128:143]
    ds_read_b64_tr_b16 v[176:177], v248 offset:18432
    ds_read_b64_tr_b16 v[178:179], v248 offset:19456
    buffer_load_dwordx4 v[236:239], v254, s[4:7], s65 offen
    buffer_load_dwordx4 v[240:243], v254, s[4:7], s65 offen offset:32
    v_mfma_f32_32x32x16_bf16 v[144:159], v[188:191], v[28:31], v[144:159]
    ds_read_b64_tr_b16 v[180:181], v249 offset:18432
    ds_read_b64_tr_b16 v[182:183], v249 offset:19456
    s_waitcnt vmcnt(9) lgkmcnt(4)
    v_mfma_f32_32x32x16_bf16 v[128:143], v[192:195], v[32:35], v[128:143]
    ds_read_b64_tr_b16 v[184:185], v248 offset:20480
    ds_read_b64_tr_b16 v[186:187], v248 offset:21504
    v_mfma_f32_32x32x16_bf16 v[144:159], v[196:199], v[32:35], v[144:159]
    ds_read_b64_tr_b16 v[188:189], v249 offset:20480
    ds_read_b64_tr_b16 v[190:191], v249 offset:21504
    s_waitcnt vmcnt(8) lgkmcnt(4)
    v_mfma_f32_32x32x16_bf16 v[128:143], v[176:179], v[36:39], v[128:143]
    ds_read_b64_tr_b16 v[192:193], v248 offset:22528
    ds_read_b64_tr_b16 v[194:195], v248 offset:23552
    v_mfma_f32_32x32x16_bf16 v[144:159], v[180:183], v[36:39], v[144:159]
    ds_read_b64_tr_b16 v[196:197], v249 offset:22528
    ds_read_b64_tr_b16 v[198:199], v249 offset:23552
    s_waitcnt vmcnt(7) lgkmcnt(4)
    v_mfma_f32_32x32x16_bf16 v[128:143], v[184:187], v[40:43], v[128:143]
    ds_read_b64_tr_b16 v[176:177], v248 offset:24576
    ds_read_b64_tr_b16 v[178:179], v248 offset:25600
    v_mfma_f32_32x32x16_bf16 v[144:159], v[188:191], v[40:43], v[144:159]
    ds_read_b64_tr_b16 v[180:181], v249 offset:24576
    ds_read_b64_tr_b16 v[182:183], v249 offset:25600
    s_waitcnt vmcnt(6) lgkmcnt(4)
    v_mfma_f32_32x32x16_bf16 v[128:143], v[192:195], v[44:47], v[128:143]
    ds_read_b64_tr_b16 v[184:185], v248 offset:26624
    ds_read_b64_tr_b16 v[186:187], v248 offset:27648
    v_mfma_f32_32x32x16_bf16 v[144:159], v[196:199], v[44:47], v[144:159]
    ds_read_b64_tr_b16 v[188:189], v249 offset:26624
    ds_read_b64_tr_b16 v[190:191], v249 offset:27648
    s_waitcnt vmcnt(5) lgkmcnt(4)
    v_mfma_f32_32x32x16_bf16 v[128:143], v[176:179], v[48:51], v[128:143]
    ds_read_b64_tr_b16 v[192:193], v248 offset:28672
    ds_read_b64_tr_b16 v[194:195], v248 offset:29696
    v_mfma_f32_32x32x16_bf16 v[144:159], v[180:183], v[48:51], v[144:159]
    ds_read_b64_tr_b16 v[196:197], v249 offset:28672
    ds_read_b64_tr_b16 v[198:199], v249 offset:29696
    s_waitcnt vmcnt(4) lgkmcnt(4)
    v_mfma_f32_32x32x16_bf16 v[128:143], v[184:187], v[52:55], v[128:143]
    s_barrier
    ds_read_b64_tr_b16 v[176:177], v248 offset:30720
    ds_read_b64_tr_b16 v[178:179], v248 offset:31744
    v_mfma_f32_32x32x16_bf16 v[144:159], v[188:191], v[52:55], v[144:159]
    ds_read_b64_tr_b16 v[180:181], v249 offset:30720
    ds_read_b64_tr_b16 v[182:183], v249 offset:31744
    s_waitcnt vmcnt(3) lgkmcnt(4)
    v_mfma_f32_32x32x16_bf16 v[128:143], v[192:195], v[56:59], v[128:143]
    v_mfma_f32_32x32x16_bf16 v[144:159], v[196:199], v[56:59], v[144:159]
    s_waitcnt vmcnt(2) lgkmcnt(0)
    v_mfma_f32_32x32x16_bf16 v[128:143], v[176:179], v[60:63], v[128:143]
    v_mfma_f32_32x32x16_bf16 v[144:159], v[180:183], v[60:63], v[144:159]
    s_lshl_b32 s59, s36, 12
    s_add_u32 s59, s59, 106496
    v_add_u32 v252, s59, v244
    s_xor_b32 s59, s36, 2
    s_lshl_b32 s59, s59, 12
    s_add_u32 s59, s59, 106496
    v_add_u32 v253, s59, v244
    s_nop 4
    ds_write_b128 v252, v[144:147] offset:0
    ds_write_b128 v252, v[148:151] offset:1024
    ds_write_b128 v252, v[152:155] offset:2048
    ds_write_b128 v252, v[156:159] offset:3072
    s_waitcnt vmcnt(0)
    v_permlane32_swap_b32 v236, v238
    v_permlane32_swap_b32 v237, v239
    v_permlane32_swap_b32 v240, v242
    v_permlane32_swap_b32 v241, v243
    v_lshlrev_b32 v160, 16, v236
    v_and_b32 v161, 0xffff0000, v236
    v_lshlrev_b32 v162, 16, v237
    v_and_b32 v163, 0xffff0000, v237
    v_lshlrev_b32 v164, 16, v238
    v_and_b32 v165, 0xffff0000, v238
    v_lshlrev_b32 v166, 16, v239
    v_and_b32 v167, 0xffff0000, v239
    v_lshlrev_b32 v168, 16, v240
    v_and_b32 v169, 0xffff0000, v240
    v_lshlrev_b32 v170, 16, v241
    v_and_b32 v171, 0xffff0000, v241
    v_lshlrev_b32 v172, 16, v242
    v_and_b32 v173, 0xffff0000, v242
    v_lshlrev_b32 v174, 16, v243
    v_and_b32 v175, 0xffff0000, v243
    v_pk_add_f32 v[128:129], v[128:129], v[160:161]
    v_pk_add_f32 v[130:131], v[130:131], v[162:163]
    v_pk_add_f32 v[132:133], v[132:133], v[164:165]
    v_pk_add_f32 v[134:135], v[134:135], v[166:167]
    v_pk_add_f32 v[136:137], v[136:137], v[168:169]
    v_pk_add_f32 v[138:139], v[138:139], v[170:171]
    v_pk_add_f32 v[140:141], v[140:141], v[172:173]
    v_pk_add_f32 v[142:143], v[142:143], v[174:175]
    s_waitcnt lgkmcnt(0)
    s_barrier
    ds_read_b128 v[144:147], v253 offset:0
    ds_read_b128 v[148:151], v253 offset:1024
    ds_read_b128 v[152:155], v253 offset:2048
    ds_read_b128 v[156:159], v253 offset:3072
    s_waitcnt lgkmcnt(3)
    v_pk_add_f32 v[128:129], v[128:129], v[144:145]
    v_cvt_pk_bf16_f32 v176, v128, v129
    v_pk_add_f32 v[130:131], v[130:131], v[146:147]
    v_cvt_pk_bf16_f32 v177, v130, v131
    v_dot2_f32_bf16 v184, v176, s86, 0
    v_dot2_f32_bf16 v185, v176, v176, 0
    v_dot2_f32_bf16 v184, v177, s86, v184
    v_dot2_f32_bf16 v185, v177, v177, v185
    s_waitcnt lgkmcnt(2)
    v_pk_add_f32 v[132:133], v[132:133], v[148:149]
    v_cvt_pk_bf16_f32 v178, v132, v133
    v_pk_add_f32 v[134:135], v[134:135], v[150:151]
    v_cvt_pk_bf16_f32 v179, v134, v135
    v_dot2_f32_bf16 v184, v178, s86, v184
    v_dot2_f32_bf16 v185, v178, v178, v185
    v_dot2_f32_bf16 v184, v179, s86, v184
    v_dot2_f32_bf16 v185, v179, v179, v185
    s_cmp_eq_u32 s40, 1
    s_cbranch_scc0 Lf_24
    buffer_store_dwordx4 v[176:179], v244, s[24:27], s48 offen offset:0 nt
Le_25:
    s_waitcnt lgkmcnt(1)
    v_pk_add_f32 v[136:137], v[136:137], v[152:153]
    v_cvt_pk_bf16_f32 v180, v136, v137
    v_pk_add_f32 v[138:139], v[138:139], v[154:155]
    v_cvt_pk_bf16_f32 v181, v138, v139
    v_dot2_f32_bf16 v184, v180, s86, v184
    v_dot2_f32_bf16 v185, v180, v180, v185
    v_dot2_f32_bf16 v184, v181, s86, v184
    v_dot2_f32_bf16 v185, v181, v181, v185
    s_waitcnt lgkmcnt(0)
    v_pk_add_f32 v[140:141], v[140:141], v[156:157]
    v_cvt_pk_bf16_f32 v182, v140, v141
    v_pk_add_f32 v[142:143], v[142:143], v[158:159]
    v_cvt_pk_bf16_f32 v183, v142, v143
    s_cmp_eq_u32 s40, 1
    s_cbranch_scc0 Lf_26
    buffer_store_dwordx4 v[180:183], v244, s[24:27], s48 offen offset:1024 nt
Le_27:
    v_dot2_f32_bf16 v184, v182, s86, v184
    v_dot2_f32_bf16 v185, v182, v182, v185
    v_dot2_f32_bf16 v184, v183, s86, v184
    v_dot2_f32_bf16 v185, v183, v183, v185
    s_nop 2
    v_permlane32_swap_b32 v184, v185
    v_add_f32 v184, v184, v185
    s_cmp_eq_u32 s40, 1
    s_cbranch_scc0 Lf_28
    buffer_store_dword v184, v250, s[28:31], s55 offen nt
Le_29:
    s_waitcnt vmcnt(0)
    v_mov_b32 v252, 1
    s_mov_b64 exec, 1
    s_cmp_eq_u32 s40, 1
    s_cbranch_scc0 Lf_30
    buffer_store_dword v252, off, s[28:31], s52
Le_31:
    s_mov_b64 exec, -1
    s_barrier
    v_lshrrev_b32 v253, 2, v244
    v_and_b32 v253, 60, v253
    s_mov_b32 s61, 0
Lpoll_32:
    buffer_load_dword v252, v253, s[28:31], s53 offen sc1
    s_add_u32 s61, s61, 1
    s_cmp_gt_u32 s61, 262144
    s_cbranch_scc1 L_end
    s_waitcnt vmcnt(0)
    v_cmp_gt_i32 vcc, 1, v252
    s_nop 3
    s_cbranch_vccnz Lpoll_32
    s_add_u32 s59, s42, 0
    buffer_load_dwordx4 v[0:3], v244, s[24:27], s59 offen offset:0 sc1
    buffer_load_dwordx4 v[4:7], v244, s[24:27], s59 offen offset:1024 sc1
    buffer_load_dwordx4 v[8:11], v244, s[24:27], s59 offen offset:2048 sc1
    buffer_load_dwordx4 v[12:15], v244, s[24:27], s59 offen offset:3072 sc1
    s_add_u32 s59, s42, 4096
    buffer_load_dwordx4 v[16:19], v244, s[24:27], s59 offen offset:0 sc1
    buffer_load_dwordx4 v[20:23], v244, s[24:27], s59 offen offset:1024 sc1
    v_add_u32 v239, 49152, v247
    ds_read_b64_tr_b16 v[176:177], v247 offset:0
    ds_read_b64_tr_b16 v[178:179], v247 offset:1536
    ds_read_b64_tr_b16 v[180:181], v247 offset:64
    ds_read_b64_tr_b16 v[182:183], v247 offset:1600
    ds_read_b64_tr_b16 v[184:185], v247 offset:128
    ds_read_b64_tr_b16 v[186:187], v247 offset:1664
    ds_read_b64_tr_b16 v[188:189], v247 offset:3072
    ds_read_b64_tr_b16 v[190:191], v247 offset:4608
    ds_read_b64_tr_b16 v[192:193], v247 offset:3136
    ds_read_b64_tr_b16 v[194:195], v247 offset:4672
    ds_read_b64_tr_b16 v[196:197], v247 offset:3200
    ds_read_b64_tr_b16 v[198:199], v247 offset:4736
    s_waitcnt vmcnt(5) lgkmcnt(10)
    v_mfma_f32_32x32x16_bf16 v[128:143], v[176:179], v[0:3], 0
    ds_read_b64_tr_b16 v[200:201], v247 offset:6144
    ds_read_b64_tr_b16 v[202:203], v247 offset:7680
    buffer_load_dwordx4 v[24:27], v244, s[24:27], s59 offen offset:2048 sc1
    s_waitcnt lgkmcnt(10)
    v_mfma_f32_32x32x16_bf16 v[144:159], v[180:183], v[0:3], 0
    ds_read_b64_tr_b16 v[204:205], v247 offset:6208
    ds_read_b64_tr_b16 v[206:207], v247 offset:7744
    s_waitcnt lgkmcnt(10)
    v_mfma_f32_32x32x16_bf16 v[160:175], v[184:187], v[0:3], 0
    ds_read_b64_tr_b16 v[208:209], v247 offset:6272
    ds_read_b64_tr_b16 v[210:211], v247 offset:7808
    s_waitcnt vmcnt(5) lgkmcnt(6)
    v_mfma_f32_32x32x16_bf16 v[128:143], v[188:191], v[4:7], v[128:143]
    ds_read_b64_tr_b16 v[176:177], v247 offset:9216
    ds_read_b64_tr_b16 v[178:179], v247 offset:10752
    buffer_load_dwordx4 v[28:31], v244, s[24:27], s59 offen offset:3072 sc1
    v_mfma_f32_32x32x16_bf16 v[144:159], v[192:195], v[4:7], v[144:159]
    ds_read_b64_tr_b16 v[180:181], v247 offset:9280
    ds_read_b64_tr_b16 v[182:183], v247 offset:10816
    v_mfma_f32_32x32x16_bf16 v[160:175], v[196:199], v[4:7], v[160:175]
    ds_read_b64_tr_b16 v[184:185], v247 offset:9344
    ds_read_b64_tr_b16 v[186:187], v247 offset:10880
    buffer_load_dwordx4 v[112:115], v244, s[28:31], s43 offen offset:0 sc1
    buffer_load_dwordx4 v[116:119], v244, s[28:31], s43 offen offset:1024 sc1
    buffer_load_dwordx4 v[120:123], v244, s[28:31], s43 offen offset:2048 sc1
    buffer_load_dwordx4 v[124:127], v244, s[28:31], s43 offen offset:3072 sc1
    s_waitcnt vmcnt(9) lgkmcnt(6)
    v_mfma_f32_32x32x16_bf16 v[128:143], v[200:203], v[8:11], v[128:143]
    ds_read_b64_tr_b16 v[188:189], v247 offset:12288
    ds_read_b64_tr_b16 v[190:191], v247 offset:13824
    s_add_u32 s59, s42, 8192
    buffer_load_dwordx4 v[32:35], v244, s[24:27], s59 offen offset:0 sc1
    v_mfma_f32_32x32x16_bf16 v[144:159], v[204:207], v[8:11], v[144:159]
    ds_read_b64_tr_b16 v[192:193], v247 offset:12352
    ds_read_b64_tr_b16 v[194:195], v247 offset:13888
    v_mfma_f32_32x32x16_bf16 v[160:175], v[208:211], v[8:11], v[160:175]
    ds_read_b64_tr_b16 v[196:197], v247 offset:12416
    ds_read_b64_tr_b16 v[198:199], v247 offset:13952
    s_waitcnt vmcnt(9) lgkmcnt(6)
    v_mfma_f32_32x32x16_bf16 v[128:143], v[176:179], v[12:15], v[128:143]
    ds_read_b64_tr_b16 v[200:201], v247 offset:15360
    ds_read_b64_tr_b16 v[202:203], v247 offset:16896
    buffer_load_dwordx4 v[36:39], v244, s[24:27], s59 offen offset:1024 sc1
    v_mfma_f32_32x32x16_bf16 v[144:159], v[180:183], v[12:15], v[144:159]
    ds_read_b64_tr_b16 v[204:205], v247 offset:15424
    ds_read_b64_tr_b16 v[206:207], v247 offset:16960
    v_mfma_f32_32x32x16_bf16 v[160:175], v[184:187], v[12:15], v[160:175]
    ds_read_b64_tr_b16 v[208:209], v247 offset:15488
    ds_read_b64_tr_b16 v[210:211], v247 offset:17024
    buffer_load_dwordx4 v[40:43], v244, s[24:27], s59 offen offset:2048 sc1
    s_waitcnt vmcnt(10) lgkmcnt(6)
    v_mfma_f32_32x32x16_bf16 v[128:143], v[188:191], v[16:19], v[128:143]
    ds_read_b64_tr_b16 v[176:177], v247 offset:18432
    ds_read_b64_tr_b16 v[178:179], v247 offset:19968
    buffer_load_dwordx4 v[44:47], v244, s[24:27], s59 offen offset:3072 sc1
    v_mfma_f32_32x32x16_bf16 v[144:159], v[192:195], v[16:19], v[144:159]
    ds_read_b64_tr_b16 v[180:181], v247 offset:18496
    ds_read_b64_tr_b16 v[182:183], v247 offset:20032
    v_mfma_f32_32x32x16_bf16 v[160:175], v[196:199], v[16:19], v[160:175]
    ds_read_b64_tr_b16 v[184:185], v247 offset:18560
    ds_read_b64_tr_b16 v[186:187], v247 offset:20096
    s_waitcnt vmcnt(10) lgkmcnt(6)
    v_mfma_f32_32x32x16_bf16 v[128:143], v[200:203], v[20:23], v[128:143]
    ds_read_b64_tr_b16 v[188:189], v247 offset:21504
    ds_read_b64_tr_b16 v[190:191], v247 offset:23040
    s_add_u32 s59, s42, 12288
    buffer_load_dwordx4 v[48:51], v244, s[24:27], s59 offen offset:0 sc1
    v_mfma_f32_32x32x16_bf16 v[144:159], v[204:207], v[20:23], v[144:159]
    ds_read_b64_tr_b16 v[192:193], v247 offset:21568
    ds_read_b64_tr_b16 v[194:195], v247 offset:23104
    v_mfma_f32_32x32x16_bf16 v[160:175], v[208:211], v[20:23], v[160:175]
    ds_read_b64_tr_b16 v[196:197], v247 offset:21632
    ds_read_b64_tr_b16 v[198:199], v247 offset:23168
    buffer_load_dwordx4 v[52:55], v244, s[24:27], s59 offen offset:1024 sc1
    s_waitcnt vmcnt(11) lgkmcnt(6)
    v_mfma_f32_32x32x16_bf16 v[128:143], v[176:179], v[24:27], v[128:143]
    ds_read_b64_tr_b16 v[200:201], v247 offset:24576
    ds_read_b64_tr_b16 v[202:203], v247 offset:26112
    buffer_load_dwordx4 v[56:59], v244, s[24:27], s59 offen offset:2048 sc1
    v_mfma_f32_32x32x16_bf16 v[144:159], v[180:183], v[24:27], v[144:159]
    ds_read_b64_tr_b16 v[204:205], v247 offset:24640
    ds_read_b64_tr_b16 v[206:207], v247 offset:26176
    v_mfma_f32_32x32x16_bf16 v[160:175], v[184:187], v[24:27], v[160:175]
    ds_read_b64_tr_b16 v[208:209], v247 offset:24704
    ds_read_b64_tr_b16 v[210:211], v247 offset:26240
    s_waitcnt vmcnt(11) lgkmcnt(6)
    v_mfma_f32_32x32x16_bf16 v[128:143], v[188:191], v[28:31], v[128:143]
    ds_read_b64_tr_b16 v[176:177], v247 offset:27648
    ds_read_b64_tr_b16 v[178:179], v247 offset:29184
    buffer_load_dwordx4 v[60:63], v244, s[24:27], s59 offen offset:3072 sc1
    v_mfma_f32_32x32x16_bf16 v[144:159], v[192:195], v[28:31], v[144:159]
    ds_read_b64_tr_b16 v[180:181], v247 offset:27712
    ds_read_b64_tr_b16 v[182:183], v247 offset:29248
    v_mfma_f32_32x32x16_bf16 v[160:175], v[196:199], v[28:31], v[160:175]
    ds_read_b64_tr_b16 v[184:185], v247 offset:27776
    ds_read_b64_tr_b16 v[186:187], v247 offset:29312
    s_add_u32 s59, s42, 16384
    buffer_load_dwordx4 v[64:67], v244, s[24:27], s59 offen offset:0 sc1
    s_waitcnt vmcnt(8) lgkmcnt(6)
    v_mfma_f32_32x32x16_bf16 v[128:143], v[200:203], v[32:35], v[128:143]
    ds_read_b64_tr_b16 v[188:189], v247 offset:30720
    ds_read_b64_tr_b16 v[190:191], v247 offset:32256
    buffer_load_dwordx4 v[68:71], v244, s[24:27], s59 offen offset:1024 sc1
    v_mfma_f32_32x32x16_bf16 v[144:159], v[204:207], v[32:35], v[144:159]
    ds_read_b64_tr_b16 v[192:193], v247 offset:30784
    ds_read_b64_tr_b16 v[194:195], v247 offset:32320
    v_mfma_f32_32x32x16_bf16 v[160:175], v[208:211], v[32:35], v[160:175]
    ds_read_b64_tr_b16 v[196:197], v247 offset:30848
    ds_read_b64_tr_b16 v[198:199], v247 offset:32384
    s_waitcnt vmcnt(8) lgkmcnt(6)
    v_mfma_f32_32x32x16_bf16 v[128:143], v[176:179], v[36:39], v[128:143]
    ds_read_b64_tr_b16 v[200:201], v247 offset:33792
    ds_read_b64_tr_b16 v[202:203], v247 offset:35328
    buffer_load_dwordx4 v[72:75], v244, s[24:27], s59 offen offset:2048 sc1
    v_mfma_f32_32x32x16_bf16 v[144:159], v[180:183], v[36:39], v[144:159]
    ds_read_b64_tr_b16 v[204:205], v247 offset:33856
    ds_read_b64_tr_b16 v[206:207], v247 offset:35392
    v_add_f32 v112, v112, v114
    v_mfma_f32_32x32x16_bf16 v[160:175], v[184:187], v[36:39], v[160:175]
    ds_read_b64_tr_b16 v[208:209], v247 offset:33920
    ds_read_b64_tr_b16 v[210:211], v247 offset:35456
    buffer_load_dwordx4 v[76:79], v244, s[24:27], s59 offen offset:3072 sc1
    v_add_f32 v113, v113, v115
    s_waitcnt vmcnt(9) lgkmcnt(6)
    v_mfma_f32_32x32x16_bf16 v[128:143], v[188:191], v[40:43], v[128:143]
    ds_read_b64_tr_b16 v[176:177], v247 offset:36864
    ds_read_b64_tr_b16 v[178:179], v247 offset:38400
    s_add_u32 s59, s42, 20480
    buffer_load_dwordx4 v[80:83], v244, s[24:27], s59 offen offset:0 sc1
    v_mfma_f32_32x32x16_bf16 v[144:159], v[192:195], v[40:43], v[144:159]
    ds_read_b64_tr_b16 v[180:181], v247 offset:36928
    ds_read_b64_tr_b16 v[182:183], v247 offset:38464
    v_add_f32 v112, v112, v116
    v_mfma_f32_32x32x16_bf16 v[160:175], v[196:199], v[40:43], v[160:175]
    ds_read_b64_tr_b16 v[184:185], v247 offset:36992
    ds_read_b64_tr_b16 v[186:187], v247 offset:38528
    v_add_f32 v113, v113, v117
    s_waitcnt vmcnt(9) lgkmcnt(6)
    v_mfma_f32_32x32x16_bf16 v[128:143], v[200:203], v[44:47], v[128:143]
    ds_read_b64_tr_b16 v[188:189], v247 offset:39936
    ds_read_b64_tr_b16 v[190:191], v247 offset:41472
    buffer_load_dwordx4 v[84:87], v244, s[24:27], s59 offen offset:1024 sc1
    v_mfma_f32_32x32x16_bf16 v[144:159], v[204:207], v[44:47], v[144:159]
    ds_read_b64_tr_b16 v[192:193], v247 offset:40000
    ds_read_b64_tr_b16 v[194:195], v247 offset:41536
    v_add_f32 v112, v112, v118
    v_mfma_f32_32x32x16_bf16 v[160:175], v[208:211], v[44:47], v[160:175]
    ds_read_b64_tr_b16 v[196:197], v247 offset:40064
    ds_read_b64_tr_b16 v[198:199], v247 offset:41600
    buffer_load_dwordx4 v[88:91], v244, s[24:27], s59 offen offset:2048 sc1
    v_add_f32 v113, v113, v119
    s_waitcnt vmcnt(10) lgkmcnt(6)
    v_mfma_f32_32x32x16_bf16 v[128:143], v[176:179], v[48:51], v[128:143]
    ds_read_b64_tr_b16 v[200:201], v247 offset:43008
    ds_read_b64_tr_b16 v[202:203], v247 offset:44544
    buffer_load_dwordx4 v[92:95], v244, s[24:27], s59 offen offset:3072 sc1
    v_mfma_f32_32x32x16_bf16 v[144:159], v[180:183], v[48:51], v[144:159]
    ds_read_b64_tr_b16 v[204:205], v247 offset:43072
    ds_read_b64_tr_b16 v[206:207], v247 offset:44608
    v_add_f32 v112, v112, v120
    v_mfma_f32_32x32x16_bf16 v[160:175], v[184:187], v[48:51], v[160:175]
    ds_read_b64_tr_b16 v[208:209], v247 offset:43136
    ds_read_b64_tr_b16 v[210:211], v247 offset:44672
    v_add_f32 v113, v113, v121
    s_waitcnt vmcnt(10) lgkmcnt(6)
    v_mfma_f32_32x32x16_bf16 v[128:143], v[188:191], v[52:55], v[128:143]
    ds_read_b64_tr_b16 v[176:177], v247 offset:46080
    ds_read_b64_tr_b16 v[178:179], v247 offset:47616
    s_add_u32 s59, s42, 24576
    buffer_load_dwordx4 v[96:99], v244, s[24:27], s59 offen offset:0 sc1
    v_mfma_f32_32x32x16_bf16 v[144:159], v[192:195], v[52:55], v[144:159]
    ds_read_b64_tr_b16 v[180:181], v247 offset:46144
    ds_read_b64_tr_b16 v[182:183], v247 offset:47680
    v_add_f32 v112, v112, v122
    v_mfma_f32_32x32x16_bf16 v[160:175], v[196:199], v[52:55], v[160:175]
    ds_read_b64_tr_b16 v[184:185], v247 offset:46208
    ds_read_b64_tr_b16 v[186:187], v247 offset:47744
    buffer_load_dwordx4 v[100:103], v244, s[24:27], s59 offen offset:1024 sc1
    v_add_f32 v113, v113, v123
    s_waitcnt vmcnt(11) lgkmcnt(6)
    v_mfma_f32_32x32x16_bf16 v[128:143], v[200:203], v[56:59], v[128:143]
    ds_read_b64_tr_b16 v[188:189], v239 offset:0
    ds_read_b64_tr_b16 v[190:191], v239 offset:1536
    buffer_load_dwordx4 v[104:107], v244, s[24:27], s59 offen offset:2048 sc1
    v_mfma_f32_32x32x16_bf16 v[144:159], v[204:207], v[56:59], v[144:159]
    ds_read_b64_tr_b16 v[192:193], v239 offset:64
    ds_read_b64_tr_b16 v[194:195], v239 offset:1600
    v_add_f32 v112, v112, v124
    v_mfma_f32_32x32x16_bf16 v[160:175], v[208:211], v[56:59], v[160:175]
    ds_read_b64_tr_b16 v[196:197], v239 offset:128
    ds_read_b64_tr_b16 v[198:199], v239 offset:1664
    v_add_f32 v113, v113, v125
    s_waitcnt vmcnt(11) lgkmcnt(6)
    v_mfma_f32_32x32x16_bf16 v[128:143], v[176:179], v[60:63], v[128:143]
    ds_read_b64_tr_b16 v[200:201], v239 offset:3072
    ds_read_b64_tr_b16 v[202:203], v239 offset:4608
    buffer_load_dwordx4 v[108:111], v244, s[24:27], s59 offen offset:3072 sc1
    v_mfma_f32_32x32x16_bf16 v[144:159], v[180:183], v[60:63], v[144:159]
    ds_read_b64_tr_b16 v[204:205], v239 offset:3136
    ds_read_b64_tr_b16 v[206:207], v239 offset:4672
    v_add_f32 v112, v112, v126
    v_mfma_f32_32x32x16_bf16 v[160:175], v[184:187], v[60:63], v[160:175]
    ds_read_b64_tr_b16 v[208:209], v239 offset:3200
    ds_read_b64_tr_b16 v[210:211], v239 offset:4736
    s_add_u32 s59, s42, 28672
    buffer_load_dwordx4 v[0:3], v244, s[24:27], s59 offen offset:0 sc1
    v_add_f32 v113, v113, v127
    s_waitcnt vmcnt(12) lgkmcnt(6)
    v_mfma_f32_32x32x16_bf16 v[128:143], v[188:191], v[64:67], v[128:143]
    ds_read_b64_tr_b16 v[176:177], v239 offset:6144
    ds_read_b64_tr_b16 v[178:179], v239 offset:7680
    buffer_load_dwordx4 v[4:7], v244, s[24:27], s59 offen offset:1024 sc1
    v_mfma_f32_32x32x16_bf16 v[144:159], v[192:195], v[64:67], v[144:159]
    ds_read_b64_tr_b16 v[180:181], v239 offset:6208
    ds_read_b64_tr_b16 v[182:183], v239 offset:7744
    v_permlane32_swap_b32 v112, v113
    v_mfma_f32_32x32x16_bf16 v[160:175], v[196:199], v[64:67], v[160:175]
    ds_read_b64_tr_b16 v[184:185], v239 offset:6272
    ds_read_b64_tr_b16 v[186:187], v239 offset:7808
    v_add_f32 v112, v112, v113
    s_waitcnt vmcnt(12) lgkmcnt(6)
    v_mfma_f32_32x32x16_bf16 v[128:143], v[200:203], v[68:71], v[128:143]
    ds_read_b64_tr_b16 v[188:189], v239 offset:9216
    ds_read_b64_tr_b16 v[190:191], v239 offset:10752
    buffer_load_dwordx4 v[8:11], v244, s[24:27], s59 offen offset:2048 sc1
    v_mfma_f32_32x32x16_bf16 v[144:159], v[204:207], v[68:71], v[144:159]
    ds_read_b64_tr_b16 v[192:193], v239 offset:9280
    ds_read_b64_tr_b16 v[194:195], v239 offset:10816
    v_mov_b32 v113, v112
    v_mfma_f32_32x32x16_bf16 v[160:175], v[208:211], v[68:71], v[160:175]
    ds_read_b64_tr_b16 v[196:197], v239 offset:9344
    ds_read_b64_tr_b16 v[198:199], v239 offset:10880
    buffer_load_dwordx4 v[12:15], v244, s[24:27], s59 offen offset:3072 sc1
    v_permlane32_swap_b32 v112, v113
    s_waitcnt vmcnt(13) lgkmcnt(6)
    v_mfma_f32_32x32x16_bf16 v[128:143], v[176:179], v[72:75], v[128:143]
    ds_read_b64_tr_b16 v[200:201], v239 offset:12288
    ds_read_b64_tr_b16 v[202:203], v239 offset:13824
    v_mfma_f32_32x32x16_bf16 v[144:159], v[180:183], v[72:75], v[144:159]
    ds_read_b64_tr_b16 v[204:205], v239 offset:12352
    ds_read_b64_tr_b16 v[206:207], v239 offset:13888
    v_mul_f32 v238, 0xbb000000, v112
    buffer_load_dwordx4 v[120:123], v244, s[24:27], s48 offen sc1
    buffer_load_dwordx4 v[124:127], v244, s[24:27], s48 offen offset:1024 sc1
    v_mfma_f32_32x32x16_bf16 v[160:175], v[184:187], v[72:75], v[160:175]
    ds_read_b64_tr_b16 v[208:209], v239 offset:12416
    ds_read_b64_tr_b16 v[210:211], v239 offset:13952
    v_mul_f32 v113, 0x3b000000, v113
    s_waitcnt vmcnt(14) lgkmcnt(6)
    v_mfma_f32_32x32x16_bf16 v[128:143], v[188:191], v[76:79], v[128:143]
    ds_read_b64_tr_b16 v[176:177], v239 offset:15360
    ds_read_b64_tr_b16 v[178:179], v239 offset:16896
    v_mfma_f32_32x32x16_bf16 v[144:159], v[192:195], v[76:79], v[144:159]
    ds_read_b64_tr_b16 v[180:181], v239 offset:15424
    ds_read_b64_tr_b16 v[182:183], v239 offset:16960
    v_fma_f32 v113, -v238, v238, v113
    v_mfma_f32_32x32x16_bf16 v[160:175], v[196:199], v[76:79], v[160:175]
    ds_read_b64_tr_b16 v[184:185], v239 offset:15488
    ds_read_b64_tr_b16 v[186:187], v239 offset:17024
    v_max_f32 v113, 0, v113
    s_waitcnt vmcnt(13) lgkmcnt(6)
    v_mfma_f32_32x32x16_bf16 v[128:143], v[200:203], v[80:83], v[128:143]
    ds_read_b64_tr_b16 v[188:189], v239 offset:18432
    ds_read_b64_tr_b16 v[190:191], v239 offset:19968
    v_mfma_f32_32x32x16_bf16 v[144:159], v[204:207], v[80:83], v[144:159]
    ds_read_b64_tr_b16 v[192:193], v239 offset:18496
    ds_read_b64_tr_b16 v[194:195], v239 offset:20032
    v_add_f32 v113, 0x3727c5ac, v113
    v_mfma_f32_32x32x16_bf16 v[160:175], v[208:211], v[80:83], v[160:175]
    ds_read_b64_tr_b16 v[196:197], v239 offset:18560
    ds_read_b64_tr_b16 v[198:199], v239 offset:20096
    v_rsq_f32 v251, v113
    s_waitcnt vmcnt(12) lgkmcnt(6)
    v_mfma_f32_32x32x16_bf16 v[128:143], v[176:179], v[84:87], v[128:143]
    ds_read_b64_tr_b16 v[200:201], v239 offset:21504
    ds_read_b64_tr_b16 v[202:203], v239 offset:23040
    v_mfma_f32_32x32x16_bf16 v[144:159], v[180:183], v[84:87], v[144:159]
    ds_read_b64_tr_b16 v[204:205], v239 offset:21568
    ds_read_b64_tr_b16 v[206:207], v239 offset:23104
    v_cvt_pk_bf16_f32 v236, v238, v238
    v_mfma_f32_32x32x16_bf16 v[160:175], v[184:187], v[84:87], v[160:175]
    ds_read_b64_tr_b16 v[208:209], v239 offset:21632
    ds_read_b64_tr_b16 v[210:211], v239 offset:23168
    v_and_b32 v236, 0xffff0000, v236
    s_waitcnt vmcnt(11) lgkmcnt(6)
    v_mfma_f32_32x32x16_bf16 v[128:143], v[188:191], v[88:91], v[128:143]
    ds_read_b64_tr_b16 v[176:177], v239 offset:24576
    ds_read_b64_tr_b16 v[178:179], v239 offset:26112
    v_mfma_f32_32x32x16_bf16 v[144:159], v[192:195], v[88:91], v[144:159]
    ds_read_b64_tr_b16 v[180:181], v239 offset:24640
    ds_read_b64_tr_b16 v[182:183], v239 offset:26176
    v_sub_f32 v237, v238, v236
    v_mfma_f32_32x32x16_bf16 v[160:175], v[196:199], v[88:91], v[160:175]
    ds_read_b64_tr_b16 v[184:185], v239 offset:24704
    ds_read_b64_tr_b16 v[186:187], v239 offset:26240
    v_cvt_pk_bf16_f32 v212, v236, v236
    s_waitcnt vmcnt(10) lgkmcnt(6)
    v_mfma_f32_32x32x16_bf16 v[128:143], v[200:203], v[92:95], v[128:143]
    ds_read_b64_tr_b16 v[188:189], v239 offset:27648
    ds_read_b64_tr_b16 v[190:191], v239 offset:29184
    v_mfma_f32_32x32x16_bf16 v[144:159], v[204:207], v[92:95], v[144:159]
    ds_read_b64_tr_b16 v[192:193], v239 offset:27712
    ds_read_b64_tr_b16 v[194:195], v239 offset:29248
    v_cvt_pk_bf16_f32 v213, v237, 0
    v_mfma_f32_32x32x16_bf16 v[160:175], v[208:211], v[92:95], v[160:175]
    ds_read_b64_tr_b16 v[196:197], v239 offset:27776
    ds_read_b64_tr_b16 v[198:199], v239 offset:29312
    v_cndmask_b32 v212, 0, v212, s[74:75]
    s_waitcnt vmcnt(9) lgkmcnt(6)
    v_mfma_f32_32x32x16_bf16 v[128:143], v[176:179], v[96:99], v[128:143]
    ds_read_b64_tr_b16 v[200:201], v239 offset:30720
    ds_read_b64_tr_b16 v[202:203], v239 offset:32256
    v_mfma_f32_32x32x16_bf16 v[144:159], v[180:183], v[96:99], v[144:159]
    ds_read_b64_tr_b16 v[204:205], v239 offset:30784
    ds_read_b64_tr_b16 v[206:207], v239 offset:32320
    v_cndmask_b32 v213, 0, v213, s[74:75]
    v_mfma_f32_32x32x16_bf16 v[160:175], v[184:187], v[96:99], v[160:175]
    ds_read_b64_tr_b16 v[208:209], v239 offset:30848
    ds_read_b64_tr_b16 v[210:211], v239 offset:32384
    v_cvt_pk_bf16_f32 v236, v251, v251
    s_waitcnt vmcnt(8) lgkmcnt(6)
    v_mfma_f32_32x32x16_bf16 v[128:143], v[188:191], v[100:103], v[128:143]
    ds_read_b64_tr_b16 v[176:177], v239 offset:33792
    ds_read_b64_tr_b16 v[178:179], v239 offset:35328
    v_mfma_f32_32x32x16_bf16 v[144:159], v[192:195], v[100:103], v[144:159]
    ds_read_b64_tr_b16 v[180:181], v239 offset:33856
    ds_read_b64_tr_b16 v[182:183], v239 offset:35392
    v_and_b32 v236, 0xffff0000, v236
    v_mfma_f32_32x32x16_bf16 v[160:175], v[196:199], v[100:103], v[160:175]
    ds_read_b64_tr_b16 v[184:185], v239 offset:33920
    ds_read_b64_tr_b16 v[186:187], v239 offset:35456
    v_sub_f32 v237, v251, v236
    s_waitcnt vmcnt(7) lgkmcnt(6)
    v_mfma_f32_32x32x16_bf16 v[128:143], v[200:203], v[104:107], v[128:143]
    ds_read_b64_tr_b16 v[188:189], v239 offset:36864
    ds_read_b64_tr_b16 v[190:191], v239 offset:38400
    v_mfma_f32_32x32x16_bf16 v[144:159], v[204:207], v[104:107], v[144:159]
    ds_read_b64_tr_b16 v[192:193], v239 offset:36928
    ds_read_b64_tr_b16 v[194:195], v239 offset:38464
    v_cvt_pk_bf16_f32 v216, v236, v237
    v_mfma_f32_32x32x16_bf16 v[160:175], v[208:211], v[104:107], v[160:175]
    ds_read_b64_tr_b16 v[196:197], v239 offset:36992
    ds_read_b64_tr_b16 v[198:199], v239 offset:38528
    v_cndmask_b32 v216, 0, v216, s[74:75]
    s_waitcnt vmcnt(6) lgkmcnt(6)
    v_mfma_f32_32x32x16_bf16 v[128:143], v[176:179], v[108:111], v[128:143]
    ds_read_b64_tr_b16 v[200:201], v239 offset:39936
    ds_read_b64_tr_b16 v[202:203], v239 offset:41472
    v_mfma_f32_32x32x16_bf16 v[144:159], v[180:183], v[108:111], v[144:159]
    ds_read_b64_tr_b16 v[204:205], v239 offset:40000
    ds_read_b64_tr_b16 v[206:207], v239 offset:41536
    v_mfma_f32_32x32x16_bf16 v[160:175], v[184:187], v[108:111], v[160:175]
    ds_read_b64_tr_b16 v[208:209], v239 offset:40064
    ds_read_b64_tr_b16 v[210:211], v239 offset:41600
    s_waitcnt vmcnt(5) lgkmcnt(6)
    v_mfma_f32_32x32x16_bf16 v[128:143], v[188:191], v[0:3], v[128:143]
    ds_read_b64_tr_b16 v[176:177], v239 offset:43008
    ds_read_b64_tr_b16 v[178:179], v239 offset:44544
    v_mfma_f32_32x32x16_bf16 v[144:159], v[192:195], v[0:3], v[144:159]
    ds_read_b64_tr_b16 v[180:181], v239 offset:43072
    ds_read_b64_tr_b16 v[182:183], v239 offset:44608
    v_mfma_f32_32x32x16_bf16 v[160:175], v[196:199], v[0:3], v[160:175]
    ds_read_b64_tr_b16 v[184:185], v239 offset:43136
    ds_read_b64_tr_b16 v[186:187], v239 offset:44672
    s_waitcnt vmcnt(4) lgkmcnt(6)
    v_mfma_f32_32x32x16_bf16 v[128:143], v[200:203], v[4:7], v[128:143]
    ds_read_b64_tr_b16 v[188:189], v239 offset:46080
    ds_read_b64_tr_b16 v[190:191], v239 offset:47616
    v_mfma_f32_32x32x16_bf16 v[144:159], v[204:207], v[4:7], v[144:159]
    ds_read_b64_tr_b16 v[192:193], v239 offset:46144
    ds_read_b64_tr_b16 v[194:195], v239 offset:47680
    v_mfma_f32_32x32x16_bf16 v[160:175], v[208:211], v[4:7], v[160:175]
    ds_read_b64_tr_b16 v[196:197], v239 offset:46208
    ds_read_b64_tr_b16 v[198:199], v239 offset:47744
    s_waitcnt vmcnt(3) lgkmcnt(6)
    v_mfma_f32_32x32x16_bf16 v[128:143], v[176:179], v[8:11], v[128:143]
    v_mfma_f32_32x32x16_bf16 v[144:159], v[180:183], v[8:11], v[144:159]
    v_mfma_f32_32x32x16_bf16 v[160:175], v[184:187], v[8:11], v[160:175]
    s_waitcnt vmcnt(2) lgkmcnt(0)
    v_mfma_f32_32x32x16_bf16 v[128:143], v[188:191], v[12:15], v[128:143]
    v_mfma_f32_32x32x16_bf16 v[144:159], v[192:195], v[12:15], v[144:159]
    v_mfma_f32_32x32x16_bf16 v[160:175], v[196:199], v[12:15], v[160:175]
    s_waitcnt vmcnt(0)
    v_lshrrev_b32 v253, 1, v244
    v_add_u32 v253, 161792, v253
    s_barrier
    ds_read_b64 v[228:229], v253 offset:0
    ds_read_b64 v[230:231], v253 offset:512
    ds_read_b64 v[232:233], v253 offset:1024
    s_waitcnt lgkmcnt(0)
    v_mfma_f32_32x32x16_bf16 v[128:143], v[228:231], v[212:215], v[128:143]
    v_mfma_f32_32x32x16_bf16 v[144:159], v[230:233], v[212:215], v[144:159]
    v_mfma_f32_32x32x16_bf16 v[160:175], v[232:235], v[212:215], v[160:175]
    v_mul_f32 v253, s80, v251
    v_sub_f32 v253, 0, v253
    v_mov_b32 v252, v251
    s_nop 6
    v_pk_mul_f32 v[236:237], v[128:129], v[252:253] op_sel:[0,1] op_sel_hi:[1,1]
    v_pk_mul_f32 v[238:239], v[130:131], v[252:253] op_sel:[0,1] op_sel_hi:[1,1]
    v_exp_f32 v236, v236
    v_exp_f32 v237, v237
    v_exp_f32 v238, v238
    v_exp_f32 v239, v239
    v_pk_mul_f32 v[128:129], v[128:129], v[252:253] op_sel_hi:[1,0]
    v_pk_add_f32 v[236:237], v[236:237], s[84:85]
    v_pk_add_f32 v[238:239], v[238:239], s[84:85]
    v_rcp_f32 v236, v236
    v_rcp_f32 v237, v237
    v_rcp_f32 v238, v238
    v_rcp_f32 v239, v239
    v_pk_mul_f32 v[130:131], v[130:131], v[252:253] op_sel_hi:[1,0]
    v_pk_mul_f32 v[128:129], v[128:129], v[236:237]
    v_pk_mul_f32 v[130:131], v[130:131], v[238:239]
    v_cvt_pk_bf16_f32 v176, v128, v129
    v_cvt_pk_bf16_f32 v177, v130, v131
    v_pk_mul_f32 v[240:241], v[132:133], v[252:253] op_sel:[0,1] op_sel_hi:[1,1]
    v_pk_mul_f32 v[242:243], v[134:135], v[252:253] op_sel:[0,1] op_sel_hi:[1,1]
    v_exp_f32 v240, v240
    v_exp_f32 v241, v241
    v_exp_f32 v242, v242
    v_exp_f32 v243, v243
    v_pk_mul_f32 v[132:133], v[132:133], v[252:253] op_sel_hi:[1,0]
    v_pk_add_f32 v[240:241], v[240:241], s[84:85]
    v_pk_add_f32 v[242:243], v[242:243], s[84:85]
    v_rcp_f32 v240, v240
    v_rcp_f32 v241, v241
    v_rcp_f32 v242, v242
    v_rcp_f32 v243, v243
    v_pk_mul_f32 v[134:135], v[134:135], v[252:253] op_sel_hi:[1,0]
    v_pk_mul_f32 v[132:133], v[132:133], v[240:241]
    v_pk_mul_f32 v[134:135], v[134:135], v[242:243]
    v_cvt_pk_bf16_f32 v178, v132, v133
    v_cvt_pk_bf16_f32 v179, v134, v135
    s_cmp_eq_u32 s40, 1
    s_cbranch_scc0 Lf_35
    buffer_store_dwordx4 v[176:179], v244, s[28:31], s45 offen offset:0 nt
Le_36:
    v_pk_mul_f32 v[236:237], v[136:137], v[252:253] op_sel:[0,1] op_sel_hi:[1,1]
    v_pk_mul_f32 v[238:239], v[138:139], v[252:253] op_sel:[0,1] op_sel_hi:[1,1]
    v_exp_f32 v236, v236
    v_exp_f32 v237, v237
    v_exp_f32 v238, v238
    v_exp_f32 v239, v239
    v_pk_mul_f32 v[136:137], v[136:137], v[252:253] op_sel_hi:[1,0]
    v_pk_add_f32 v[236:237], v[236:237], s[84:85]
    v_pk_add_f32 v[238:239], v[238:239], s[84:85]
    v_rcp_f32 v236, v236
    v_rcp_f32 v237, v237
    v_rcp_f32 v238, v238
    v_rcp_f32 v239, v239
    v_pk_mul_f32 v[138:139], v[138:139], v[252:253] op_sel_hi:[1,0]
    v_pk_mul_f32 v[136:137], v[136:137], v[236:237]
    v_pk_mul_f32 v[138:139], v[138:139], v[238:239]
    v_cvt_pk_bf16_f32 v180, v136, v137
    v_cvt_pk_bf16_f32 v181, v138, v139
    v_pk_mul_f32 v[240:241], v[140:141], v[252:253] op_sel:[0,1] op_sel_hi:[1,1]
    v_pk_mul_f32 v[242:243], v[142:143], v[252:253] op_sel:[0,1] op_sel_hi:[1,1]
    v_exp_f32 v240, v240
    v_exp_f32 v241, v241
    v_exp_f32 v242, v242
    v_exp_f32 v243, v243
    v_pk_mul_f32 v[140:141], v[140:141], v[252:253] op_sel_hi:[1,0]
    v_pk_add_f32 v[240:241], v[240:241], s[84:85]
    v_pk_add_f32 v[242:243], v[242:243], s[84:85]
    v_rcp_f32 v240, v240
    v_rcp_f32 v241, v241
    v_rcp_f32 v242, v242
    v_rcp_f32 v243, v243
    v_pk_mul_f32 v[142:143], v[142:143], v[252:253] op_sel_hi:[1,0]
    v_pk_mul_f32 v[140:141], v[140:141], v[240:241]
    v_pk_mul_f32 v[142:143], v[142:143], v[242:243]
    v_cvt_pk_bf16_f32 v182, v140, v141
    v_cvt_pk_bf16_f32 v183, v142, v143
    s_cmp_eq_u32 s40, 1
    s_cbranch_scc0 Lf_37
    buffer_store_dwordx4 v[180:183], v244, s[28:31], s45 offen offset:1024 nt
Le_38:
    v_pk_mul_f32 v[236:237], v[144:145], v[252:253] op_sel:[0,1] op_sel_hi:[1,1]
    v_pk_mul_f32 v[238:239], v[146:147], v[252:253] op_sel:[0,1] op_sel_hi:[1,1]
    v_exp_f32 v236, v236
    v_exp_f32 v237, v237
    v_exp_f32 v238, v238
    v_exp_f32 v239, v239
    v_pk_mul_f32 v[144:145], v[144:145], v[252:253] op_sel_hi:[1,0]
    v_pk_add_f32 v[236:237], v[236:237], s[84:85]
    v_pk_add_f32 v[238:239], v[238:239], s[84:85]
    v_rcp_f32 v236, v236
    v_rcp_f32 v237, v237
    v_rcp_f32 v238, v238
    v_rcp_f32 v239, v239
    v_pk_mul_f32 v[146:147], v[146:147], v[252:253] op_sel_hi:[1,0]
    v_pk_mul_f32 v[144:145], v[144:145], v[236:237]
    v_pk_mul_f32 v[146:147], v[146:147], v[238:239]
    v_cvt_pk_bf16_f32 v184, v144, v145
    v_cvt_pk_bf16_f32 v185, v146, v147
    v_pk_mul_f32 v[240:241], v[148:149], v[252:253] op_sel:[0,1] op_sel_hi:[1,1]
    v_pk_mul_f32 v[242:243], v[150:151], v[252:253] op_sel:[0,1] op_sel_hi:[1,1]
    v_exp_f32 v240, v240
    v_exp_f32 v241, v241
    v_exp_f32 v242, v242
    v_exp_f32 v243, v243
    v_pk_mul_f32 v[148:149], v[148:149], v[252:253] op_sel_hi:[1,0]
    v_pk_add_f32 v[240:241], v[240:241], s[84:85]
    v_pk_add_f32 v[242:243], v[242:243], s[84:85]
    v_rcp_f32 v240, v240
    v_rcp_f32 v241, v241
    v_rcp_f32 v242, v242
    v_rcp_f32 v243, v243
    v_pk_mul_f32 v[150:151], v[150:151], v[252:253] op_sel_hi:[1,0]
    v_pk_mul_f32 v[148:149], v[148:149], v[240:241]
    v_pk_mul_f32 v[150:151], v[150:151], v[242:243]
    v_cvt_pk_bf16_f32 v186, v148, v149
    v_cvt_pk_bf16_f32 v187, v150, v151
    s_cmp_eq_u32 s40, 1
    s_cbranch_scc0 Lf_39
    buffer_store_dwordx4 v[184:187], v244, s[28:31], s45 offen offset:2048 nt
Le_40:
    v_pk_mul_f32 v[236:237], v[152:153], v[252:253] op_sel:[0,1] op_sel_hi:[1,1]
    v_pk_mul_f32 v[238:239], v[154:155], v[252:253] op_sel:[0,1] op_sel_hi:[1,1]
    v_exp_f32 v236, v236
    v_exp_f32 v237, v237
    v_exp_f32 v238, v238
    v_exp_f32 v239, v239
    v_pk_mul_f32 v[152:153], v[152:153], v[252:253] op_sel_hi:[1,0]
    v_pk_add_f32 v[236:237], v[236:237], s[84:85]
    v_pk_add_f32 v[238:239], v[238:239], s[84:85]
    v_rcp_f32 v236, v236
    v_rcp_f32 v237, v237
    v_rcp_f32 v238, v238
    v_rcp_f32 v239, v239
    v_pk_mul_f32 v[154:155], v[154:155], v[252:253] op_sel_hi:[1,0]
    v_pk_mul_f32 v[152:153], v[152:153], v[236:237]
    v_pk_mul_f32 v[154:155], v[154:155], v[238:239]
    v_cvt_pk_bf16_f32 v188, v152, v153
    v_cvt_pk_bf16_f32 v189, v154, v155
    v_pk_mul_f32 v[240:241], v[156:157], v[252:253] op_sel:[0,1] op_sel_hi:[1,1]
    v_pk_mul_f32 v[242:243], v[158:159], v[252:253] op_sel:[0,1] op_sel_hi:[1,1]
    v_exp_f32 v240, v240
    v_exp_f32 v241, v241
    v_exp_f32 v242, v242
    v_exp_f32 v243, v243
    v_pk_mul_f32 v[156:157], v[156:157], v[252:253] op_sel_hi:[1,0]
    v_pk_add_f32 v[240:241], v[240:241], s[84:85]
    v_pk_add_f32 v[242:243], v[242:243], s[84:85]
    v_rcp_f32 v240, v240
    v_rcp_f32 v241, v241
    v_rcp_f32 v242, v242
    v_rcp_f32 v243, v243
    v_pk_mul_f32 v[158:159], v[158:159], v[252:253] op_sel_hi:[1,0]
    v_pk_mul_f32 v[156:157], v[156:157], v[240:241]
    v_pk_mul_f32 v[158:159], v[158:159], v[242:243]
    v_cvt_pk_bf16_f32 v190, v156, v157
    v_cvt_pk_bf16_f32 v191, v158, v159
    s_cmp_eq_u32 s40, 1
    s_cbranch_scc0 Lf_41
    buffer_store_dwordx4 v[188:191], v244, s[28:31], s45 offen offset:3072 nt
Le_42:
    s_cmp_eq_u32 s56, 3
    s_cbranch_scc0 Lb1e_34
    v_pk_mul_f32 v[236:237], v[160:161], v[252:253] op_sel:[0,1] op_sel_hi:[1,1]
    v_pk_mul_f32 v[238:239], v[162:163], v[252:253] op_sel:[0,1] op_sel_hi:[1,1]
    v_exp_f32 v236, v236
    v_exp_f32 v237, v237
    v_exp_f32 v238, v238
    v_exp_f32 v239, v239
    v_pk_mul_f32 v[160:161], v[160:161], v[252:253] op_sel_hi:[1,0]
    v_pk_add_f32 v[236:237], v[236:237], s[84:85]
    v_pk_add_f32 v[238:239], v[238:239], s[84:85]
    v_rcp_f32 v236, v236
    v_rcp_f32 v237, v237
    v_rcp_f32 v238, v238
    v_rcp_f32 v239, v239
    v_pk_mul_f32 v[162:163], v[162:163], v[252:253] op_sel_hi:[1,0]
    v_pk_mul_f32 v[160:161], v[160:161], v[236:237]
    v_pk_mul_f32 v[162:163], v[162:163], v[238:239]
    v_cvt_pk_bf16_f32 v192, v160, v161
    v_cvt_pk_bf16_f32 v193, v162, v163
    v_pk_mul_f32 v[240:241], v[164:165], v[252:253] op_sel:[0,1] op_sel_hi:[1,1]
    v_pk_mul_f32 v[242:243], v[166:167], v[252:253] op_sel:[0,1] op_sel_hi:[1,1]
    v_exp_f32 v240, v240
    v_exp_f32 v241, v241
    v_exp_f32 v242, v242
    v_exp_f32 v243, v243
    v_pk_mul_f32 v[164:165], v[164:165], v[252:253] op_sel_hi:[1,0]
    v_pk_add_f32 v[240:241], v[240:241], s[84:85]
    v_pk_add_f32 v[242:243], v[242:243], s[84:85]
    v_rcp_f32 v240, v240
    v_rcp_f32 v241, v241
    v_rcp_f32 v242, v242
    v_rcp_f32 v243, v243
    v_pk_mul_f32 v[166:167], v[166:167], v[252:253] op_sel_hi:[1,0]
    v_pk_mul_f32 v[164:165], v[164:165], v[240:241]
    v_pk_mul_f32 v[166:167], v[166:167], v[242:243]
    v_cvt_pk_bf16_f32 v194, v164, v165
    v_cvt_pk_bf16_f32 v195, v166, v167
    s_cmp_eq_u32 s40, 1
    s_cbranch_scc0 Lf_43
    buffer_store_dwordx4 v[192:195], v244, s[28:31], s49 offen offset:0 nt
Le_44:
    v_pk_mul_f32 v[236:237], v[168:169], v[252:253] op_sel:[0,1] op_sel_hi:[1,1]
    v_pk_mul_f32 v[238:239], v[170:171], v[252:253] op_sel:[0,1] op_sel_hi:[1,1]
    v_exp_f32 v236, v236
    v_exp_f32 v237, v237
    v_exp_f32 v238, v238
    v_exp_f32 v239, v239
    v_pk_mul_f32 v[168:169], v[168:169], v[252:253] op_sel_hi:[1,0]
    v_pk_add_f32 v[236:237], v[236:237], s[84:85]
    v_pk_add_f32 v[238:239], v[238:239], s[84:85]
    v_rcp_f32 v236, v236
    v_rcp_f32 v237, v237
    v_rcp_f32 v238, v238
    v_rcp_f32 v239, v239
    v_pk_mul_f32 v[170:171], v[170:171], v[252:253] op_sel_hi:[1,0]
    v_pk_mul_f32 v[168:169], v[168:169], v[236:237]
    v_pk_mul_f32 v[170:171], v[170:171], v[238:239]
    v_cvt_pk_bf16_f32 v196, v168, v169
    v_cvt_pk_bf16_f32 v197, v170, v171
    s_waitcnt vmcnt(1)
    v_mov_b32 v200, 2
    s_mov_b64 exec, 1
    s_cmp_eq_u32 s40, 1
    s_cbranch_scc0 Lf_45
    buffer_store_dword v200, off, s[28:31], s50
Le_46:
    s_mov_b64 exec, -1
    v_pk_mul_f32 v[240:241], v[172:173], v[252:253] op_sel:[0,1] op_sel_hi:[1,1]
    v_pk_mul_f32 v[242:243], v[174:175], v[252:253] op_sel:[0,1] op_sel_hi:[1,1]
    v_exp_f32 v240, v240
    v_exp_f32 v241, v241
    v_exp_f32 v242, v242
    v_exp_f32 v243, v243
    v_pk_mul_f32 v[172:173], v[172:173], v[252:253] op_sel_hi:[1,0]
    v_pk_add_f32 v[240:241], v[240:241], s[84:85]
    v_pk_add_f32 v[242:243], v[242:243], s[84:85]
    v_rcp_f32 v240, v240
    v_rcp_f32 v241, v241
    v_rcp_f32 v242, v242
    v_rcp_f32 v243, v243
    v_pk_mul_f32 v[174:175], v[174:175], v[252:253] op_sel_hi:[1,0]
    v_pk_mul_f32 v[172:173], v[172:173], v[240:241]
    v_pk_mul_f32 v[174:175], v[174:175], v[242:243]
    v_cvt_pk_bf16_f32 v198, v172, v173
    v_cvt_pk_bf16_f32 v199, v174, v175
    s_cmp_eq_u32 s40, 1
    s_cbranch_scc0 Lf_47
    buffer_store_dwordx4 v[196:199], v244, s[28:31], s54 offen offset:0 nt
Le_48:
Lb1e_34:
    v_lshrrev_b32 v253, 2, v244
    v_and_b32 v252, 0x1c, v253
    v_lshl_add_u32 v252, s63, 5, v252
    v_and_b32 v211, 0x3c, v253
    buffer_load_dword v201, v252, s[28:31], s51 offen sc1
    s_waitcnt vmcnt(0)
    v_mov_b32 v253, 3
    s_mov_b64 exec, 1
    s_cmp_eq_u32 s40, 1
    s_cbranch_scc0 Lf_49
    buffer_store_dword v253, off, s[28:31], s50
Le_50:
    s_mov_b64 exec, -1
    v_cmp_gt_i32 vcc, 2, v201
    s_barrier
    s_nop 2
    s_cbranch_vccnz Lere_52
Lego_51:
    s_add_u32 s59, s47, 0
    buffer_load_dwordx4 v[0:3], v244, s[28:31], s59 offen offset:0 sc1
    buffer_load_dwordx4 v[4:7], v244, s[28:31], s59 offen offset:1024 sc1
    buffer_load_dwordx4 v[8:11], v244, s[28:31], s59 offen offset:2048 sc1
    buffer_load_dwordx4 v[12:15], v244, s[28:31], s59 offen offset:3072 sc1
    s_add_u32 s59, s47, 4096
    buffer_load_dwordx4 v[16:19], v244, s[28:31], s59 offen offset:0 sc1
    buffer_load_dwordx4 v[20:23], v244, s[28:31], s59 offen offset:1024 sc1
    buffer_load_dwordx4 v[24:27], v244, s[28:31], s59 offen offset:2048 sc1
    buffer_load_dwordx4 v[28:31], v244, s[28:31], s59 offen offset:3072 sc1
    s_add_u32 s59, s47, 8192
    buffer_load_dwordx4 v[32:35], v244, s[28:31], s59 offen offset:0 sc1
    s_lshl_b32 s57, s63, 14
    s_sub_u32 s57, s57, 98304
    v_add_u32 v252, s57, v248
    v_add_u32 v253, s57, v249
    ds_read_b64_tr_b16 v[176:177], v248 offset:0
    ds_read_b64_tr_b16 v[178:179], v248 offset:1024
    ds_read_b64_tr_b16 v[180:181], v249 offset:0
    ds_read_b64_tr_b16 v[182:183], v249 offset:1024
    ds_read_b64_tr_b16 v[184:185], v248 offset:2048
    ds_read_b64_tr_b16 v[186:187], v248 offset:3072
    ds_read_b64_tr_b16 v[188:189], v249 offset:2048
    ds_read_b64_tr_b16 v[190:191], v249 offset:3072
    s_waitcnt vmcnt(8) lgkmcnt(6)
    v_mfma_f32_32x32x16_bf16 v[128:143], v[176:179], v[0:3], 0
    ds_read_b64_tr_b16 v[192:193], v248 offset:4096
    ds_read_b64_tr_b16 v[194:195], v248 offset:5120
    buffer_load_dwordx4 v[36:39], v244, s[28:31], s59 offen offset:1024 sc1
    s_waitcnt lgkmcnt(6)
    v_mfma_f32_32x32x16_bf16 v[144:159], v[180:183], v[0:3], 0
    ds_read_b64_tr_b16 v[196:197], v249 offset:4096
    ds_read_b64_tr_b16 v[198:199], v249 offset:5120
    s_waitcnt vmcnt(8) lgkmcnt(4)
    v_mfma_f32_32x32x16_bf16 v[128:143], v[184:187], v[4:7], v[128:143]
    ds_read_b64_tr_b16 v[176:177], v248 offset:6144
    ds_read_b64_tr_b16 v[178:179], v248 offset:7168
    buffer_load_dwordx4 v[40:43], v244, s[28:31], s59 offen offset:2048 sc1
    v_mfma_f32_32x32x16_bf16 v[144:159], v[188:191], v[4:7], v[144:159]
    ds_read_b64_tr_b16 v[180:181], v249 offset:6144
    ds_read_b64_tr_b16 v[182:183], v249 offset:7168
    s_waitcnt vmcnt(8) lgkmcnt(4)
    v_mfma_f32_32x32x16_bf16 v[128:143], v[192:195], v[8:11], v[128:143]
    ds_read_b64_tr_b16 v[184:185], v248 offset:8192
    ds_read_b64_tr_b16 v[186:187], v248 offset:9216
    buffer_load_dwordx4 v[44:47], v244, s[28:31], s59 offen offset:3072 sc1
    v_mfma_f32_32x32x16_bf16 v[144:159], v[196:199], v[8:11], v[144:159]
    ds_read_b64_tr_b16 v[188:189], v249 offset:8192
    ds_read_b64_tr_b16 v[190:191], v249 offset:9216
    s_waitcnt vmcnt(8) lgkmcnt(4)
    v_mfma_f32_32x32x16_bf16 v[128:143], v[176:179], v[12:15], v[128:143]
    ds_read_b64_tr_b16 v[192:193], v248 offset:10240
    ds_read_b64_tr_b16 v[194:195], v248 offset:11264
    s_add_u32 s59, s47, 12288
    buffer_load_dwordx4 v[48:51], v244, s[28:31], s59 offen offset:0 sc1
    v_mfma_f32_32x32x16_bf16 v[144:159], v[180:183], v[12:15], v[144:159]
    ds_read_b64_tr_b16 v[196:197], v249 offset:10240
    ds_read_b64_tr_b16 v[198:199], v249 offset:11264
    s_waitcnt vmcnt(8) lgkmcnt(4)
    v_mfma_f32_32x32x16_bf16 v[128:143], v[184:187], v[16:19], v[128:143]
    ds_read_b64_tr_b16 v[176:177], v248 offset:12288
    ds_read_b64_tr_b16 v[178:179], v248 offset:13312
    buffer_load_dwordx4 v[52:55], v244, s[28:31], s59 offen offset:1024 sc1
    v_mfma_f32_32x32x16_bf16 v[144:159], v[188:191], v[16:19], v[144:159]
    ds_read_b64_tr_b16 v[180:181], v249 offset:12288
    ds_read_b64_tr_b16 v[182:183], v249 offset:13312
    s_waitcnt vmcnt(8) lgkmcnt(4)
    v_mfma_f32_32x32x16_bf16 v[128:143], v[192:195], v[20:23], v[128:143]
    ds_read_b64_tr_b16 v[184:185], v248 offset:14336
    ds_read_b64_tr_b16 v[186:187], v248 offset:15360
    buffer_load_dwordx4 v[56:59], v244, s[28:31], s59 offen offset:2048 sc1
    v_mfma_f32_32x32x16_bf16 v[144:159], v[196:199], v[20:23], v[144:159]
    ds_read_b64_tr_b16 v[188:189], v249 offset:14336
    ds_read_b64_tr_b16 v[190:191], v249 offset:15360
    s_waitcnt vmcnt(8) lgkmcnt(4)
    v_mfma_f32_32x32x16_bf16 v[128:143], v[176:179], v[24:27], v[128:143]
    ds_read_b64_tr_b16 v[192:193], v248 offset:16384
    ds_read_b64_tr_b16 v[194:195], v248 offset:17408
    buffer_load_dwordx4 v[60:63], v244, s[28:31], s59 offen offset:3072 sc1
    v_mfma_f32_32x32x16_bf16 v[144:159], v[180:183], v[24:27], v[144:159]
    ds_read_b64_tr_b16 v[196:197], v249 offset:16384
    ds_read_b64_tr_b16 v[198:199], v249 offset:17408
    s_waitcnt vmcnt(8) lgkmcnt(4)
    v_mfma_f32_32x32x16_bf16 v[128:143], v[184:187], v[28:31], v[128:143]
    ds_read_b64_tr_b16 v[176:177], v248 offset:18432
    ds_read_b64_tr_b16 v[178:179], v248 offset:19456
    s_add_u32 s59, s47, 16384
    buffer_load_dwordx4 v[64:67], v244, s[28:31], s59 offen offset:0 sc1
    v_mfma_f32_32x32x16_bf16 v[144:159], v[188:191], v[28:31], v[144:159]
    ds_read_b64_tr_b16 v[180:181], v249 offset:18432
    ds_read_b64_tr_b16 v[182:183], v249 offset:19456
    s_waitcnt vmcnt(8) lgkmcnt(4)
    v_mfma_f32_32x32x16_bf16 v[128:143], v[192:195], v[32:35], v[128:143]
    ds_read_b64_tr_b16 v[184:185], v248 offset:20480
    ds_read_b64_tr_b16 v[186:187], v248 offset:21504
    buffer_load_dwordx4 v[68:71], v244, s[28:31], s59 offen offset:1024 sc1
    v_mfma_f32_32x32x16_bf16 v[144:159], v[196:199], v[32:35], v[144:159]
    ds_read_b64_tr_b16 v[188:189], v249 offset:20480
    ds_read_b64_tr_b16 v[190:191], v249 offset:21504
    s_waitcnt vmcnt(8) lgkmcnt(4)
    v_mfma_f32_32x32x16_bf16 v[128:143], v[176:179], v[36:39], v[128:143]
    ds_read_b64_tr_b16 v[192:193], v248 offset:22528
    ds_read_b64_tr_b16 v[194:195], v248 offset:23552
    buffer_load_dwordx4 v[72:75], v244, s[28:31], s59 offen offset:2048 sc1
    v_mfma_f32_32x32x16_bf16 v[144:159], v[180:183], v[36:39], v[144:159]
    ds_read_b64_tr_b16 v[196:197], v249 offset:22528
    ds_read_b64_tr_b16 v[198:199], v249 offset:23552
    s_waitcnt vmcnt(8) lgkmcnt(4)
    v_mfma_f32_32x32x16_bf16 v[128:143], v[184:187], v[40:43], v[128:143]
    ds_read_b64_tr_b16 v[176:177], v248 offset:24576
    ds_read_b64_tr_b16 v[178:179], v248 offset:25600
    buffer_load_dwordx4 v[76:79], v244, s[28:31], s59 offen offset:3072 sc1
    v_mfma_f32_32x32x16_bf16 v[144:159], v[188:191], v[40:43], v[144:159]
    ds_read_b64_tr_b16 v[180:181], v249 offset:24576
    ds_read_b64_tr_b16 v[182:183], v249 offset:25600
    s_waitcnt vmcnt(8) lgkmcnt(4)
    v_mfma_f32_32x32x16_bf16 v[128:143], v[192:195], v[44:47], v[128:143]
    ds_read_b64_tr_b16 v[184:185], v248 offset:26624
    ds_read_b64_tr_b16 v[186:187], v248 offset:27648
    buffer_load_dword v210, v211, s[28:31], s51 offen sc1
    s_add_u32 s59, s47, 20480
    buffer_load_dwordx4 v[80:83], v244, s[28:31], s59 offen offset:0 sc1
    v_mfma_f32_32x32x16_bf16 v[144:159], v[196:199], v[44:47], v[144:159]
    ds_read_b64_tr_b16 v[188:189], v249 offset:26624
    ds_read_b64_tr_b16 v[190:191], v249 offset:27648
    s_waitcnt vmcnt(9) lgkmcnt(4)
    v_mfma_f32_32x32x16_bf16 v[128:143], v[176:179], v[48:51], v[128:143]
    ds_read_b64_tr_b16 v[192:193], v248 offset:28672
    ds_read_b64_tr_b16 v[194:195], v248 offset:29696
    buffer_load_dwordx4 v[84:87], v244, s[28:31], s59 offen offset:1024 sc1
    v_mfma_f32_32x32x16_bf16 v[144:159], v[180:183], v[48:51], v[144:159]
    ds_read_b64_tr_b16 v[196:197], v249 offset:28672
    ds_read_b64_tr_b16 v[198:199], v249 offset:29696
    s_waitcnt vmcnt(9) lgkmcnt(4)
    v_mfma_f32_32x32x16_bf16 v[128:143], v[184:187], v[52:55], v[128:143]
    s_barrier
    ds_read_b64_tr_b16 v[176:177], v248 offset:30720
    ds_read_b64_tr_b16 v[178:179], v248 offset:31744
    buffer_load_dwordx4 v[88:91], v244, s[28:31], s59 offen offset:2048 sc1
    v_mfma_f32_32x32x16_bf16 v[144:159], v[188:191], v[52:55], v[144:159]
    ds_read_b64_tr_b16 v[180:181], v249 offset:30720
    ds_read_b64_tr_b16 v[182:183], v249 offset:31744
    s_waitcnt vmcnt(9) lgkmcnt(4)
    v_mfma_f32_32x32x16_bf16 v[128:143], v[192:195], v[56:59], v[128:143]
    ds_read_b64_tr_b16 v[184:185], v252 offset:0
    ds_read_b64_tr_b16 v[186:187], v252 offset:1024
    buffer_load_dwordx4 v[92:95], v244, s[28:31], s59 offen offset:3072 sc1
    v_mfma_f32_32x32x16_bf16 v[144:159], v[196:199], v[56:59], v[144:159]
    ds_read_b64_tr_b16 v[188:189], v253 offset:0
    ds_read_b64_tr_b16 v[190:191], v253 offset:1024
    s_waitcnt vmcnt(9) lgkmcnt(4)
    v_mfma_f32_32x32x16_bf16 v[128:143], v[176:179], v[60:63], v[128:143]
    ds_read_b64_tr_b16 v[192:193], v252 offset:2048
    ds_read_b64_tr_b16 v[194:195], v252 offset:3072
    s_add_u32 s59, s47, 24576
    buffer_load_dwordx4 v[96:99], v244, s[28:31], s59 offen offset:0 sc1
    v_mfma_f32_32x32x16_bf16 v[144:159], v[180:183], v[60:63], v[144:159]
    ds_read_b64_tr_b16 v[196:197], v253 offset:2048
    ds_read_b64_tr_b16 v[198:199], v253 offset:3072
    s_waitcnt vmcnt(9) lgkmcnt(4)
    v_mfma_f32_32x32x16_bf16 v[128:143], v[184:187], v[64:67], v[128:143]
    ds_read_b64_tr_b16 v[176:177], v252 offset:4096
    ds_read_b64_tr_b16 v[178:179], v252 offset:5120
    buffer_load_dwordx4 v[100:103], v244, s[28:31], s59 offen offset:1024 sc1
    v_mfma_f32_32x32x16_bf16 v[144:159], v[188:191], v[64:67], v[144:159]
    ds_read_b64_tr_b16 v[180:181], v253 offset:4096
    ds_read_b64_tr_b16 v[182:183], v253 offset:5120
    s_waitcnt vmcnt(9) lgkmcnt(4)
    v_mfma_f32_32x32x16_bf16 v[128:143], v[192:195], v[68:71], v[128:143]
    ds_read_b64_tr_b16 v[184:185], v252 offset:6144
    ds_read_b64_tr_b16 v[186:187], v252 offset:7168
    buffer_load_dwordx4 v[104:107], v244, s[28:31], s59 offen offset:2048 sc1
    v_mfma_f32_32x32x16_bf16 v[144:159], v[196:199], v[68:71], v[144:159]
    ds_read_b64_tr_b16 v[188:189], v253 offset:6144
    ds_read_b64_tr_b16 v[190:191], v253 offset:7168
    s_waitcnt vmcnt(9) lgkmcnt(4)
    v_mfma_f32_32x32x16_bf16 v[128:143], v[176:179], v[72:75], v[128:143]
    ds_read_b64_tr_b16 v[192:193], v252 offset:8192
    ds_read_b64_tr_b16 v[194:195], v252 offset:9216
    buffer_load_dwordx4 v[108:111], v244, s[28:31], s59 offen offset:3072 sc1
    v_mfma_f32_32x32x16_bf16 v[144:159], v[180:183], v[72:75], v[144:159]
    ds_read_b64_tr_b16 v[196:197], v253 offset:8192
    ds_read_b64_tr_b16 v[198:199], v253 offset:9216
    s_waitcnt vmcnt(9) lgkmcnt(4)
    v_mfma_f32_32x32x16_bf16 v[128:143], v[184:187], v[76:79], v[128:143]
    ds_read_b64_tr_b16 v[176:177], v252 offset:10240
    ds_read_b64_tr_b16 v[178:179], v252 offset:11264
    s_add_u32 s59, s47, 28672
    buffer_load_dwordx4 v[112:115], v244, s[28:31], s59 offen offset:0 sc1
    v_mfma_f32_32x32x16_bf16 v[144:159], v[188:191], v[76:79], v[144:159]
    ds_read_b64_tr_b16 v[180:181], v253 offset:10240
    ds_read_b64_tr_b16 v[182:183], v253 offset:11264
    s_waitcnt vmcnt(8) lgkmcnt(4)
    v_mfma_f32_32x32x16_bf16 v[128:143], v[192:195], v[80:83], v[128:143]
    ds_read_b64_tr_b16 v[184:185], v252 offset:12288
    ds_read_b64_tr_b16 v[186:187], v252 offset:13312
    buffer_load_dwordx4 v[116:119], v244, s[28:31], s59 offen offset:1024 sc1
    v_mfma_f32_32x32x16_bf16 v[144:159], v[196:199], v[80:83], v[144:159]
    ds_read_b64_tr_b16 v[188:189], v253 offset:12288
    ds_read_b64_tr_b16 v[190:191], v253 offset:13312
    s_waitcnt vmcnt(8) lgkmcnt(4)
    v_mfma_f32_32x32x16_bf16 v[128:143], v[176:179], v[84:87], v[128:143]
    ds_read_b64_tr_b16 v[192:193], v252 offset:14336
    ds_read_b64_tr_b16 v[194:195], v252 offset:15360
    buffer_load_dwordx4 v[0:3], v244, s[28:31], s59 offen offset:2048 sc1
    v_mfma_f32_32x32x16_bf16 v[144:159], v[180:183], v[84:87], v[144:159]
    ds_read_b64_tr_b16 v[196:197], v253 offset:14336
    ds_read_b64_tr_b16 v[198:199], v253 offset:15360
    s_waitcnt vmcnt(8) lgkmcnt(4)
    v_mfma_f32_32x32x16_bf16 v[128:143], v[184:187], v[88:91], v[128:143]
    ds_read_b64_tr_b16 v[176:177], v252 offset:16384
    ds_read_b64_tr_b16 v[178:179], v252 offset:17408
    buffer_load_dwordx4 v[4:7], v244, s[28:31], s59 offen offset:3072 sc1
    v_mfma_f32_32x32x16_bf16 v[144:159], v[188:191], v[88:91], v[144:159]
    ds_read_b64_tr_b16 v[180:181], v253 offset:16384
    ds_read_b64_tr_b16 v[182:183], v253 offset:17408
    s_waitcnt vmcnt(8) lgkmcnt(4)
    v_mfma_f32_32x32x16_bf16 v[128:143], v[192:195], v[92:95], v[128:143]
    ds_read_b64_tr_b16 v[184:185], v252 offset:18432
    ds_read_b64_tr_b16 v[186:187], v252 offset:19456
    v_cmp_gt_i32 vcc, 3, v210
    s_nop 3
    s_cbranch_vccnz Llre_56
Llgo_55:
    s_add_u32 s59, s47, 32768
    buffer_load_dwordx4 v[8:11], v244, s[28:31], s59 offen offset:0 sc1
    v_mfma_f32_32x32x16_bf16 v[144:159], v[196:199], v[92:95], v[144:159]
    ds_read_b64_tr_b16 v[188:189], v253 offset:18432
    ds_read_b64_tr_b16 v[190:191], v253 offset:19456
    s_waitcnt vmcnt(8) lgkmcnt(4)
    v_mfma_f32_32x32x16_bf16 v[128:143], v[176:179], v[96:99], v[128:143]
    ds_read_b64_tr_b16 v[192:193], v252 offset:20480
    ds_read_b64_tr_b16 v[194:195], v252 offset:21504
    buffer_load_dwordx4 v[12:15], v244, s[28:31], s59 offen offset:1024 sc1
    v_mfma_f32_32x32x16_bf16 v[144:159], v[180:183], v[96:99], v[144:159]
    ds_read_b64_tr_b16 v[196:197], v253 offset:20480
    ds_read_b64_tr_b16 v[198:199], v253 offset:21504
    s_waitcnt vmcnt(8) lgkmcnt(4)
    v_mfma_f32_32x32x16_bf16 v[128:143], v[184:187], v[100:103], v[128:143]
    ds_read_b64_tr_b16 v[176:177], v252 offset:22528
    ds_read_b64_tr_b16 v[178:179], v252 offset:23552
    buffer_load_dwordx4 v[16:19], v244, s[28:31], s59 offen offset:2048 sc1
    v_mfma_f32_32x32x16_bf16 v[144:159], v[188:191], v[100:103], v[144:159]
    ds_read_b64_tr_b16 v[180:181], v253 offset:22528
    ds_read_b64_tr_b16 v[182:183], v253 offset:23552
    s_waitcnt vmcnt(8) lgkmcnt(4)
    v_mfma_f32_32x32x16_bf16 v[128:143], v[192:195], v[104:107], v[128:143]
    ds_read_b64_tr_b16 v[184:185], v252 offset:24576
    ds_read_b64_tr_b16 v[186:187], v252 offset:25600
    buffer_load_dwordx4 v[20:23], v244, s[28:31], s59 offen offset:3072 sc1
    v_mfma_f32_32x32x16_bf16 v[144:159], v[196:199], v[104:107], v[144:159]
    ds_read_b64_tr_b16 v[188:189], v253 offset:24576
    ds_read_b64_tr_b16 v[190:191], v253 offset:25600
    s_waitcnt vmcnt(8) lgkmcnt(4)
    v_mfma_f32_32x32x16_bf16 v[128:143], v[176:179], v[108:111], v[128:143]
    ds_read_b64_tr_b16 v[192:193], v252 offset:26624
    ds_read_b64_tr_b16 v[194:195], v252 offset:27648
    s_add_u32 s59, s47, 36864
    buffer_load_dwordx4 v[24:27], v244, s[28:31], s59 offen offset:0 sc1
    v_mfma_f32_32x32x16_bf16 v[144:159], v[180:183], v[108:111], v[144:159]
    ds_read_b64_tr_b16 v[196:197], v253 offset:26624
    ds_read_b64_tr_b16 v[198:199], v253 offset:27648
    s_waitcnt vmcnt(8) lgkmcnt(4)
    v_mfma_f32_32x32x16_bf16 v[128:143], v[184:187], v[112:115], v[128:143]
    ds_read_b64_tr_b16 v[176:177], v252 offset:28672
    ds_read_b64_tr_b16 v[178:179], v252 offset:29696
    buffer_load_dwordx4 v[28:31], v244, s[28:31], s59 offen offset:1024 sc1
    v_mfma_f32_32x32x16_bf16 v[144:159], v[188:191], v[112:115], v[144:159]
    ds_read_b64_tr_b16 v[180:181], v253 offset:28672
    ds_read_b64_tr_b16 v[182:183], v253 offset:29696
    s_waitcnt vmcnt(8) lgkmcnt(4)
    v_mfma_f32_32x32x16_bf16 v[128:143], v[192:195], v[116:119], v[128:143]
    ds_read_b64_tr_b16 v[184:185], v252 offset:30720
    ds_read_b64_tr_b16 v[186:187], v252 offset:31744
    buffer_load_dwordx4 v[32:35], v244, s[28:31], s59 offen offset:2048 sc1
    v_mfma_f32_32x32x16_bf16 v[144:159], v[196:199], v[116:119], v[144:159]
    ds_read_b64_tr_b16 v[188:189], v253 offset:30720
    ds_read_b64_tr_b16 v[190:191], v253 offset:31744
    s_waitcnt vmcnt(8) lgkmcnt(4)
    v_mfma_f32_32x32x16_bf16 v[128:143], v[176:179], v[0:3], v[128:143]
    ds_read_b64_tr_b16 v[192:193], v252 offset:32768
    ds_read_b64_tr_b16 v[194:195], v252 offset:33792
    buffer_load_dwordx4 v[36:39], v244, s[28:31], s59 offen offset:3072 sc1
    v_mfma_f32_32x32x16_bf16 v[144:159], v[180:183], v[0:3], v[144:159]
    ds_read_b64_tr_b16 v[196:197], v253 offset:32768
    ds_read_b64_tr_b16 v[198:199], v253 offset:33792
    s_waitcnt vmcnt(8) lgkmcnt(4)
    v_mfma_f32_32x32x16_bf16 v[128:143], v[184:187], v[4:7], v[128:143]
    ds_read_b64_tr_b16 v[176:177], v252 offset:34816
    ds_read_b64_tr_b16 v[178:179], v252 offset:35840
    s_add_u32 s59, s47, 40960
    buffer_load_dwordx4 v[40:43], v244, s[28:31], s59 offen offset:0 sc1
    v_mfma_f32_32x32x16_bf16 v[144:159], v[188:191], v[4:7], v[144:159]
    ds_read_b64_tr_b16 v[180:181], v253 offset:34816
    ds_read_b64_tr_b16 v[182:183], v253 offset:35840
    s_waitcnt vmcnt(8) lgkmcnt(4)
    v_mfma_f32_32x32x16_bf16 v[128:143], v[192:195], v[8:11], v[128:143]
    ds_read_b64_tr_b16 v[184:185], v252 offset:36864
    ds_read_b64_tr_b16 v[186:187], v252 offset:37888
    buffer_load_dwordx4 v[44:47], v244, s[28:31], s59 offen offset:1024 sc1
    v_mfma_f32_32x32x16_bf16 v[144:159], v[196:199], v[8:11], v[144:159]
    ds_read_b64_tr_b16 v[188:189], v253 offset:36864
    ds_read_b64_tr_b16 v[190:191], v253 offset:37888
    s_waitcnt vmcnt(8) lgkmcnt(4)
    v_mfma_f32_32x32x16_bf16 v[128:143], v[176:179], v[12:15], v[128:143]
    ds_read_b64_tr_b16 v[192:193], v252 offset:38912
    ds_read_b64_tr_b16 v[194:195], v252 offset:39936
    buffer_load_dwordx4 v[48:51], v244, s[28:31], s59 offen offset:2048 sc1
    v_mfma_f32_32x32x16_bf16 v[144:159], v[180:183], v[12:15], v[144:159]
    ds_read_b64_tr_b16 v[196:197], v253 offset:38912
    ds_read_b64_tr_b16 v[198:199], v253 offset:39936
    s_waitcnt vmcnt(8) lgkmcnt(4)
    v_mfma_f32_32x32x16_bf16 v[128:143], v[184:187], v[16:19], v[128:143]
    ds_read_b64_tr_b16 v[176:177], v252 offset:40960
    ds_read_b64_tr_b16 v[178:179], v252 offset:41984
    v_mfma_f32_32x32x16_bf16 v[144:159], v[188:191], v[16:19], v[144:159]
    ds_read_b64_tr_b16 v[180:181], v253 offset:40960
    ds_read_b64_tr_b16 v[182:183], v253 offset:41984
    s_waitcnt vmcnt(7) lgkmcnt(4)
    v_mfma_f32_32x32x16_bf16 v[128:143], v[192:195], v[20:23], v[128:143]
    ds_read_b64_tr_b16 v[184:185], v252 offset:43008
    ds_read_b64_tr_b16 v[186:187], v252 offset:44032
    v_mfma_f32_32x32x16_bf16 v[144:159], v[196:199], v[20:23], v[144:159]
    ds_read_b64_tr_b16 v[188:189], v253 offset:43008
    ds_read_b64_tr_b16 v[190:191], v253 offset:44032
    s_waitcnt vmcnt(6) lgkmcnt(4)
    v_mfma_f32_32x32x16_bf16 v[128:143], v[176:179], v[24:27], v[128:143]
    ds_read_b64_tr_b16 v[192:193], v252 offset:45056
    ds_read_b64_tr_b16 v[194:195], v252 offset:46080
    v_mfma_f32_32x32x16_bf16 v[144:159], v[180:183], v[24:27], v[144:159]
    ds_read_b64_tr_b16 v[196:197], v253 offset:45056
    ds_read_b64_tr_b16 v[198:199], v253 offset:46080
    s_waitcnt vmcnt(5) lgkmcnt(4)
    v_mfma_f32_32x32x16_bf16 v[128:143], v[184:187], v[28:31], v[128:143]
    ds_read_b64_tr_b16 v[176:177], v252 offset:47104
    ds_read_b64_tr_b16 v[178:179], v252 offset:48128
    v_mfma_f32_32x32x16_bf16 v[144:159], v[188:191], v[28:31], v[144:159]
    ds_read_b64_tr_b16 v[180:181], v253 offset:47104
    ds_read_b64_tr_b16 v[182:183], v253 offset:48128
    s_waitcnt vmcnt(4) lgkmcnt(4)
    v_mfma_f32_32x32x16_bf16 v[128:143], v[192:195], v[32:35], v[128:143]
    s_barrier
    ds_read_b64_tr_b16 v[184:185], v248 offset:0
    ds_read_b64_tr_b16 v[186:187], v248 offset:1024
    v_mfma_f32_32x32x16_bf16 v[144:159], v[196:199], v[32:35], v[144:159]
    ds_read_b64_tr_b16 v[188:189], v249 offset:0
    ds_read_b64_tr_b16 v[190:191], v249 offset:1024
    s_waitcnt vmcnt(3) lgkmcnt(4)
    v_mfma_f32_32x32x16_bf16 v[128:143], v[176:179], v[36:39], v[128:143]
    ds_read_b64_tr_b16 v[192:193], v248 offset:2048
    ds_read_b64_tr_b16 v[194:195], v248 offset:3072
    v_mfma_f32_32x32x16_bf16 v[144:159], v[180:183], v[36:39], v[144:159]
    ds_read_b64_tr_b16 v[196:197], v249 offset:2048
    ds_read_b64_tr_b16 v[198:199], v249 offset:3072
    s_waitcnt vmcnt(2) lgkmcnt(4)
    v_mfma_f32_32x32x16_bf16 v[128:143], v[184:187], v[40:43], v[128:143]
    ds_read_b64_tr_b16 v[176:177], v248 offset:4096
    ds_read_b64_tr_b16 v[178:179], v248 offset:5120
    v_mfma_f32_32x32x16_bf16 v[144:159], v[188:191], v[40:43], v[144:159]
    ds_read_b64_tr_b16 v[180:181], v249 offset:4096
    ds_read_b64_tr_b16 v[182:183], v249 offset:5120
    s_waitcnt vmcnt(1) lgkmcnt(4)
    v_mfma_f32_32x32x16_bf16 v[128:143], v[192:195], v[44:47], v[128:143]
    v_mfma_f32_32x32x16_bf16 v[144:159], v[196:199], v[44:47], v[144:159]
    s_waitcnt vmcnt(0) lgkmcnt(0)
    v_mfma_f32_32x32x16_bf16 v[128:143], v[176:179], v[48:51], v[128:143]
    v_mfma_f32_32x32x16_bf16 v[144:159], v[180:183], v[48:51], v[144:159]
    s_lshl_b32 s59, s36, 12
    s_add_u32 s59, s59, 106496
    v_add_u32 v252, s59, v244
    s_xor_b32 s59, s36, 2
    s_lshl_b32 s59, s59, 12
    s_add_u32 s59, s59, 106496
    v_add_u32 v253, s59, v244
    s_nop 4
    ds_write_b128 v252, v[144:147] offset:0
    ds_write_b128 v252, v[148:151] offset:1024
    ds_write_b128 v252, v[152:155] offset:2048
    ds_write_b128 v252, v[156:159] offset:3072
    v_lshlrev_b32 v160, 16, v120
    v_and_b32 v161, 0xffff0000, v120
    v_lshlrev_b32 v162, 16, v121
    v_and_b32 v163, 0xffff0000, v121
    v_lshlrev_b32 v164, 16, v122
    v_and_b32 v165, 0xffff0000, v122
    v_lshlrev_b32 v166, 16, v123
    v_and_b32 v167, 0xffff0000, v123
    v_lshlrev_b32 v168, 16, v124
    v_and_b32 v169, 0xffff0000, v124
    v_lshlrev_b32 v170, 16, v125
    v_and_b32 v171, 0xffff0000, v125
    v_lshlrev_b32 v172, 16, v126
    v_and_b32 v173, 0xffff0000, v126
    v_lshlrev_b32 v174, 16, v127
    v_and_b32 v175, 0xffff0000, v127
    v_pk_add_f32 v[128:129], v[128:129], v[160:161]
    v_pk_add_f32 v[130:131], v[130:131], v[162:163]
    v_pk_add_f32 v[132:133], v[132:133], v[164:165]
    v_pk_add_f32 v[134:135], v[134:135], v[166:167]
    v_pk_add_f32 v[136:137], v[136:137], v[168:169]
    v_pk_add_f32 v[138:139], v[138:139], v[170:171]
    v_pk_add_f32 v[140:141], v[140:141], v[172:173]
    v_pk_add_f32 v[142:143], v[142:143], v[174:175]
    s_waitcnt lgkmcnt(0)
    s_barrier
    ds_read_b128 v[144:147], v253 offset:0
    ds_read_b128 v[148:151], v253 offset:1024
    ds_read_b128 v[152:155], v253 offset:2048
    ds_read_b128 v[156:159], v253 offset:3072
    s_waitcnt lgkmcnt(3)
    v_pk_add_f32 v[128:129], v[128:129], v[144:145]
    v_cvt_pk_bf16_f32 v176, v128, v129
    v_pk_add_f32 v[130:131], v[130:131], v[146:147]
    v_cvt_pk_bf16_f32 v177, v130, v131
    v_dot2_f32_bf16 v184, v176, s86, 0
    v_dot2_f32_bf16 v185, v176, v176, 0
    v_dot2_f32_bf16 v184, v177, s86, v184
    v_dot2_f32_bf16 v185, v177, v177, v185
    s_waitcnt lgkmcnt(2)
    v_pk_add_f32 v[132:133], v[132:133], v[148:149]
    v_cvt_pk_bf16_f32 v178, v132, v133
    v_pk_add_f32 v[134:135], v[134:135], v[150:151]
    v_cvt_pk_bf16_f32 v179, v134, v135
    v_dot2_f32_bf16 v184, v178, s86, v184
    v_dot2_f32_bf16 v185, v178, v178, v185
    v_dot2_f32_bf16 v184, v179, s86, v184
    v_dot2_f32_bf16 v185, v179, v179, v185
    s_cmp_eq_u32 s40, 1
    s_cbranch_scc0 Lf_59
    buffer_store_dwordx4 v[176:179], v244, s[24:27], s48 offen offset:0 nt
Le_60:
    s_waitcnt lgkmcnt(1)
    v_pk_add_f32 v[136:137], v[136:137], v[152:153]
    v_cvt_pk_bf16_f32 v180, v136, v137
    v_pk_add_f32 v[138:139], v[138:139], v[154:155]
    v_cvt_pk_bf16_f32 v181, v138, v139
    v_dot2_f32_bf16 v184, v180, s86, v184
    v_dot2_f32_bf16 v185, v180, v180, v185
    v_dot2_f32_bf16 v184, v181, s86, v184
    v_dot2_f32_bf16 v185, v181, v181, v185
    s_waitcnt lgkmcnt(0)
    v_pk_add_f32 v[140:141], v[140:141], v[156:157]
    v_cvt_pk_bf16_f32 v182, v140, v141
    v_pk_add_f32 v[142:143], v[142:143], v[158:159]
    v_cvt_pk_bf16_f32 v183, v142, v143
    s_cmp_eq_u32 s40, 1
    s_cbranch_scc0 Lf_61
    buffer_store_dwordx4 v[180:183], v244, s[24:27], s48 offen offset:1024 nt
Le_62:
    v_dot2_f32_bf16 v184, v182, s86, v184
    v_dot2_f32_bf16 v185, v182, v182, v185
    v_dot2_f32_bf16 v184, v183, s86, v184
    v_dot2_f32_bf16 v185, v183, v183, v185
    s_nop 2
    v_permlane32_swap_b32 v184, v185
    v_add_f32 v184, v184, v185
    s_cmp_eq_u32 s40, 1
    s_cbranch_scc0 Lf_63
    buffer_store_dword v184, v250, s[28:31], s55 offen nt
Le_64:
    s_waitcnt vmcnt(0)
    v_mov_b32 v252, 2
    s_mov_b64 exec, 1
    s_cmp_eq_u32 s40, 1
    s_cbranch_scc0 Lf_65
    buffer_store_dword v252, off, s[28:31], s52
Le_66:
    s_mov_b64 exec, -1
    v_lshrrev_b32 v252, 9, v244
    v_lshlrev_b32 v252, 8, v252
    v_sub_u32 v245, v245, v252
    v_add_u32 v246, 512, v245
    s_barrier
    v_lshrrev_b32 v253, 2, v244
    v_and_b32 v253, 60, v253
    s_mov_b32 s61, 0
Lpoll_67:
    buffer_load_dword v252, v253, s[28:31], s53 offen sc1
    s_add_u32 s61, s61, 1
    s_cmp_gt_u32 s61, 262144
    s_cbranch_scc1 L_end
    s_waitcnt vmcnt(0)
    v_cmp_gt_i32 vcc, 2, v252
    s_nop 3
    s_cbranch_vccnz Lpoll_67
    s_add_u32 s59, s64, 0
    s_and_b32 s59, s59, 7
    s_lshl_b32 s59, s59, 12
    s_add_u32 s59, s59, s42
    buffer_load_dwordx4 v[0:3], v244, s[24:27], s59 offen offset:0 sc1
    buffer_load_dwordx4 v[4:7], v244, s[24:27], s59 offen offset:1024 sc1
    buffer_load_dwordx4 v[8:11], v244, s[24:27], s59 offen offset:2048 sc1
    buffer_load_dwordx4 v[12:15], v244, s[24:27], s59 offen offset:3072 sc1
    s_add_u32 s59, s64, 1
    s_and_b32 s59, s59, 7
    s_lshl_b32 s59, s59, 12
    s_add_u32 s59, s59, s42
    buffer_load_dwordx4 v[16:19], v244, s[24:27], s59 offen offset:0 sc1
    buffer_load_dwordx4 v[20:23], v244, s[24:27], s59 offen offset:1024 sc1
    buffer_load_dwordx4 v[24:27], v244, s[24:27], s59 offen offset:2048 sc1
    buffer_load_dwordx4 v[28:31], v244, s[24:27], s59 offen offset:3072 sc1
    ds_read_b64_tr_b16 v[176:177], v245 offset:0
    ds_read_b64_tr_b16 v[178:179], v246 offset:0
    ds_read_b64_tr_b16 v[180:181], v245 offset:32768
    ds_read_b64_tr_b16 v[182:183], v246 offset:32768
    ds_read_b64_tr_b16 v[184:185], v245 offset:1024
    ds_read_b64_tr_b16 v[186:187], v246 offset:1024
    ds_read_b64_tr_b16 v[188:189], v245 offset:33792
    ds_read_b64_tr_b16 v[190:191], v246 offset:33792
    s_waitcnt vmcnt(7) lgkmcnt(6)
    v_mfma_f32_32x32x16_bf16 v[128:143], v[0:3], v[176:179], 0
    ds_read_b64_tr_b16 v[192:193], v245 offset:2048
    ds_read_b64_tr_b16 v[194:195], v246 offset:2048
    buffer_load_dwordx4 v[160:163], v244, s[28:31], s43 offen offset:0 sc1
    buffer_load_dwordx4 v[164:167], v244, s[28:31], s43 offen offset:1024 sc1
    buffer_load_dwordx4 v[168:171], v244, s[28:31], s43 offen offset:2048 sc1
    buffer_load_dwordx4 v[172:175], v244, s[28:31], s43 offen offset:3072 sc1
    s_waitcnt lgkmcnt(6)
    v_mfma_f32_32x32x16_bf16 v[144:159], v[0:3], v[180:183], 0
    ds_read_b64_tr_b16 v[196:197], v245 offset:34816
    ds_read_b64_tr_b16 v[198:199], v246 offset:34816
    s_waitcnt vmcnt(10) lgkmcnt(4)
    v_mfma_f32_32x32x16_bf16 v[128:143], v[4:7], v[184:187], v[128:143]
    ds_read_b64_tr_b16 v[176:177], v245 offset:3072
    ds_read_b64_tr_b16 v[178:179], v246 offset:3072
    s_add_u32 s59, s64, 2
    s_and_b32 s59, s59, 7
    s_lshl_b32 s59, s59, 12
    s_add_u32 s59, s59, s42
    buffer_load_dwordx4 v[32:35], v244, s[24:27], s59 offen offset:0 sc1
    v_mfma_f32_32x32x16_bf16 v[144:159], v[4:7], v[188:191], v[144:159]
    ds_read_b64_tr_b16 v[180:181], v245 offset:35840
    ds_read_b64_tr_b16 v[182:183], v246 offset:35840
    s_waitcnt vmcnt(10) lgkmcnt(4)
    v_mfma_f32_32x32x16_bf16 v[128:143], v[8:11], v[192:195], v[128:143]
    ds_read_b64_tr_b16 v[184:185], v245 offset:4096
    ds_read_b64_tr_b16 v[186:187], v246 offset:4096
    buffer_load_dwordx4 v[36:39], v244, s[24:27], s59 offen offset:1024 sc1
    v_mfma_f32_32x32x16_bf16 v[144:159], v[8:11], v[196:199], v[144:159]
    ds_read_b64_tr_b16 v[188:189], v245 offset:36864
    ds_read_b64_tr_b16 v[190:191], v246 offset:36864
    s_waitcnt vmcnt(10) lgkmcnt(4)
    v_mfma_f32_32x32x16_bf16 v[128:143], v[12:15], v[176:179], v[128:143]
    ds_read_b64_tr_b16 v[192:193], v245 offset:5120
    ds_read_b64_tr_b16 v[194:195], v246 offset:5120
    buffer_load_dwordx4 v[40:43], v244, s[24:27], s59 offen offset:2048 sc1
    v_mfma_f32_32x32x16_bf16 v[144:159], v[12:15], v[180:183], v[144:159]
    ds_read_b64_tr_b16 v[196:197], v245 offset:37888
    ds_read_b64_tr_b16 v[198:199], v246 offset:37888
    s_waitcnt vmcnt(10) lgkmcnt(4)
    v_mfma_f32_32x32x16_bf16 v[128:143], v[16:19], v[184:187], v[128:143]
    ds_read_b64_tr_b16 v[176:177], v245 offset:6144
    ds_read_b64_tr_b16 v[178:179], v246 offset:6144
    buffer_load_dwordx4 v[44:47], v244, s[24:27], s59 offen offset:3072 sc1
    v_mfma_f32_32x32x16_bf16 v[144:159], v[16:19], v[188:191], v[144:159]
    ds_read_b64_tr_b16 v[180:181], v245 offset:38912
    ds_read_b64_tr_b16 v[182:183], v246 offset:38912
    s_waitcnt vmcnt(10) lgkmcnt(4)
    v_mfma_f32_32x32x16_bf16 v[128:143], v[20:23], v[192:195], v[128:143]
    ds_read_b64_tr_b16 v[184:185], v245 offset:7168
    ds_read_b64_tr_b16 v[186:187], v246 offset:7168
    s_add_u32 s59, s64, 3
    s_and_b32 s59, s59, 7
    s_lshl_b32 s59, s59, 12
    s_add_u32 s59, s59, s42
    buffer_load_dwordx4 v[48:51], v244, s[24:27], s59 offen offset:0 sc1
    v_mfma_f32_32x32x16_bf16 v[144:159], v[20:23], v[196:199], v[144:159]
    ds_read_b64_tr_b16 v[188:189], v245 offset:39936
    ds_read_b64_tr_b16 v[190:191], v246 offset:39936
    s_waitcnt vmcnt(10) lgkmcnt(4)
    v_mfma_f32_32x32x16_bf16 v[128:143], v[24:27], v[176:179], v[128:143]
    ds_read_b64_tr_b16 v[192:193], v245 offset:8192
    ds_read_b64_tr_b16 v[194:195], v246 offset:8192
    buffer_load_dwordx4 v[52:55], v244, s[24:27], s59 offen offset:1024 sc1
    v_mfma_f32_32x32x16_bf16 v[144:159], v[24:27], v[180:183], v[144:159]
    ds_read_b64_tr_b16 v[196:197], v245 offset:40960
    ds_read_b64_tr_b16 v[198:199], v246 offset:40960
    s_waitcnt vmcnt(10) lgkmcnt(4)
    v_mfma_f32_32x32x16_bf16 v[128:143], v[28:31], v[184:187], v[128:143]
    ds_read_b64_tr_b16 v[176:177], v245 offset:9216
    ds_read_b64_tr_b16 v[178:179], v246 offset:9216
    buffer_load_dwordx4 v[56:59], v244, s[24:27], s59 offen offset:2048 sc1
    v_mfma_f32_32x32x16_bf16 v[144:159], v[28:31], v[188:191], v[144:159]
    ds_read_b64_tr_b16 v[180:181], v245 offset:41984
    ds_read_b64_tr_b16 v[182:183], v246 offset:41984
    s_waitcnt vmcnt(6) lgkmcnt(4)
    v_mfma_f32_32x32x16_bf16 v[128:143], v[32:35], v[192:195], v[128:143]
    ds_read_b64_tr_b16 v[184:185], v245 offset:10240
    ds_read_b64_tr_b16 v[186:187], v246 offset:10240
    buffer_load_dwordx4 v[60:63], v244, s[24:27], s59 offen offset:3072 sc1
    v_mfma_f32_32x32x16_bf16 v[144:159], v[32:35], v[196:199], v[144:159]
    ds_read_b64_tr_b16 v[188:189], v245 offset:43008
    ds_read_b64_tr_b16 v[190:191], v246 offset:43008
    s_waitcnt vmcnt(6) lgkmcnt(4)
    v_mfma_f32_32x32x16_bf16 v[128:143], v[36:39], v[176:179], v[128:143]
    ds_read_b64_tr_b16 v[192:193], v245 offset:11264
    ds_read_b64_tr_b16 v[194:195], v246 offset:11264
    s_add_u32 s59, s64, 4
    s_and_b32 s59, s59, 7
    s_lshl_b32 s59, s59, 12
    s_add_u32 s59, s59, s42
    buffer_load_dwordx4 v[64:67], v244, s[24:27], s59 offen offset:0 sc1
    v_add_f32 v160, v160, v162
    v_add_f32 v161, v161, v163
    v_mfma_f32_32x32x16_bf16 v[144:159], v[36:39], v[180:183], v[144:159]
    ds_read_b64_tr_b16 v[196:197], v245 offset:44032
    ds_read_b64_tr_b16 v[198:199], v246 offset:44032
    v_add_f32 v160, v160, v164
    v_add_f32 v161, v161, v165
    s_waitcnt vmcnt(6) lgkmcnt(4)
    v_mfma_f32_32x32x16_bf16 v[128:143], v[40:43], v[184:187], v[128:143]
    ds_read_b64_tr_b16 v[176:177], v245 offset:12288
    ds_read_b64_tr_b16 v[178:179], v246 offset:12288
    buffer_load_dwordx4 v[68:71], v244, s[24:27], s59 offen offset:1024 sc1
    v_add_f32 v160, v160, v166
    v_add_f32 v161, v161, v167
    v_mfma_f32_32x32x16_bf16 v[144:159], v[40:43], v[188:191], v[144:159]
    ds_read_b64_tr_b16 v[180:181], v245 offset:45056
    ds_read_b64_tr_b16 v[182:183], v246 offset:45056
    v_add_f32 v160, v160, v168
    v_add_f32 v161, v161, v169
    s_waitcnt vmcnt(6) lgkmcnt(4)
    v_mfma_f32_32x32x16_bf16 v[128:143], v[44:47], v[192:195], v[128:143]
    ds_read_b64_tr_b16 v[184:185], v245 offset:13312
    ds_read_b64_tr_b16 v[186:187], v246 offset:13312
    buffer_load_dwordx4 v[72:75], v244, s[24:27], s59 offen offset:2048 sc1
    v_add_f32 v160, v160, v170
    v_add_f32 v161, v161, v171
    v_mfma_f32_32x32x16_bf16 v[144:159], v[44:47], v[196:199], v[144:159]
    ds_read_b64_tr_b16 v[188:189], v245 offset:46080
    ds_read_b64_tr_b16 v[190:191], v246 offset:46080
    v_add_f32 v160, v160, v172
    v_add_f32 v161, v161, v173
    s_waitcnt vmcnt(6) lgkmcnt(4)
    v_mfma_f32_32x32x16_bf16 v[128:143], v[48:51], v[176:179], v[128:143]
    ds_read_b64_tr_b16 v[192:193], v245 offset:14336
    ds_read_b64_tr_b16 v[194:195], v246 offset:14336
    buffer_load_dwordx4 v[76:79], v244, s[24:27], s59 offen offset:3072 sc1
    v_add_f32 v160, v160, v174
    v_add_f32 v161, v161, v175
    v_mfma_f32_32x32x16_bf16 v[144:159], v[48:51], v[180:183], v[144:159]
    ds_read_b64_tr_b16 v[196:197], v245 offset:47104
    ds_read_b64_tr_b16 v[198:199], v246 offset:47104
    v_permlane32_swap_b32 v160, v161
    v_add_f32 v160, v160, v161
    s_waitcnt vmcnt(6) lgkmcnt(4)
    v_mfma_f32_32x32x16_bf16 v[128:143], v[52:55], v[184:187], v[128:143]
    ds_read_b64_tr_b16 v[176:177], v245 offset:15360
    ds_read_b64_tr_b16 v[178:179], v246 offset:15360
    s_add_u32 s59, s64, 5
    s_and_b32 s59, s59, 7
    s_lshl_b32 s59, s59, 12
    s_add_u32 s59, s59, s42
    buffer_load_dwordx4 v[80:83], v244, s[24:27], s59 offen offset:0 sc1
    v_mov_b32 v161, v160
    s_nop 1
    v_permlane32_swap_b32 v160, v161
    v_mfma_f32_32x32x16_bf16 v[144:159], v[52:55], v[188:191], v[144:159]
    ds_read_b64_tr_b16 v[180:181], v245 offset:48128
    ds_read_b64_tr_b16 v[182:183], v246 offset:48128
    v_mul_f32 v238, 0xbb000000, v160
    v_mul_f32 v161, 0x3b000000, v161
    s_waitcnt vmcnt(6) lgkmcnt(4)
    v_mfma_f32_32x32x16_bf16 v[128:143], v[56:59], v[192:195], v[128:143]
    ds_read_b64_tr_b16 v[184:185], v245 offset:16384
    ds_read_b64_tr_b16 v[186:187], v246 offset:16384
    buffer_load_dwordx4 v[84:87], v244, s[24:27], s59 offen offset:1024 sc1
    v_fma_f32 v161, -v238, v238, v161
    v_max_f32 v161, 0, v161
    v_mfma_f32_32x32x16_bf16 v[144:159], v[56:59], v[196:199], v[144:159]
    ds_read_b64_tr_b16 v[188:189], v245 offset:49152
    ds_read_b64_tr_b16 v[190:191], v246 offset:49152
    v_add_f32 v161, 0x3727c5ac, v161
    v_rsq_f32 v251, v161
    s_waitcnt vmcnt(6) lgkmcnt(4)
    v_mfma_f32_32x32x16_bf16 v[128:143], v[60:63], v[176:179], v[128:143]
    ds_read_b64_tr_b16 v[192:193], v245 offset:17408
    ds_read_b64_tr_b16 v[194:195], v246 offset:17408
    buffer_load_dwordx4 v[88:91], v244, s[24:27], s59 offen offset:2048 sc1
    v_cvt_pk_bf16_f32 v236, v238, v238
    v_and_b32 v236, 0xffff0000, v236
    v_mfma_f32_32x32x16_bf16 v[144:159], v[60:63], v[180:183], v[144:159]
    ds_read_b64_tr_b16 v[196:197], v245 offset:50176
    ds_read_b64_tr_b16 v[198:199], v246 offset:50176
    v_sub_f32 v237, v238, v236
    v_cvt_pk_bf16_f32 v212, v236, v236
    s_waitcnt vmcnt(6) lgkmcnt(4)
    v_mfma_f32_32x32x16_bf16 v[128:143], v[64:67], v[184:187], v[128:143]
    ds_read_b64_tr_b16 v[176:177], v245 offset:18432
    ds_read_b64_tr_b16 v[178:179], v246 offset:18432
    buffer_load_dwordx4 v[92:95], v244, s[24:27], s59 offen offset:3072 sc1
    v_cvt_pk_bf16_f32 v213, v237, 0
    v_cndmask_b32 v212, 0, v212, s[74:75]
    v_mfma_f32_32x32x16_bf16 v[144:159], v[64:67], v[188:191], v[144:159]
    ds_read_b64_tr_b16 v[180:181], v245 offset:51200
    ds_read_b64_tr_b16 v[182:183], v246 offset:51200
    v_cndmask_b32 v213, 0, v213, s[74:75]
    v_cvt_pk_bf16_f32 v236, v251, v251
    s_waitcnt vmcnt(6) lgkmcnt(4)
    v_mfma_f32_32x32x16_bf16 v[128:143], v[68:71], v[192:195], v[128:143]
    ds_read_b64_tr_b16 v[184:185], v245 offset:19456
    ds_read_b64_tr_b16 v[186:187], v246 offset:19456
    s_add_u32 s59, s64, 6
    s_and_b32 s59, s59, 7
    s_lshl_b32 s59, s59, 12
    s_add_u32 s59, s59, s42
    buffer_load_dwordx4 v[96:99], v244, s[24:27], s59 offen offset:0 sc1
    v_and_b32 v236, 0xffff0000, v236
    v_sub_f32 v237, v251, v236
    v_mfma_f32_32x32x16_bf16 v[144:159], v[68:71], v[196:199], v[144:159]
    ds_read_b64_tr_b16 v[188:189], v245 offset:52224
    ds_read_b64_tr_b16 v[190:191], v246 offset:52224
    v_cvt_pk_bf16_f32 v216, v236, v237
    v_cndmask_b32 v216, 0, v216, s[74:75]
    s_waitcnt vmcnt(6) lgkmcnt(4)
    v_mfma_f32_32x32x16_bf16 v[128:143], v[72:75], v[176:179], v[128:143]
    ds_read_b64_tr_b16 v[192:193], v245 offset:20480
    ds_read_b64_tr_b16 v[194:195], v246 offset:20480
    buffer_load_dwordx4 v[100:103], v244, s[24:27], s59 offen offset:1024 sc1
    v_mfma_f32_32x32x16_bf16 v[144:159], v[72:75], v[180:183], v[144:159]
    ds_read_b64_tr_b16 v[196:197], v245 offset:53248
    ds_read_b64_tr_b16 v[198:199], v246 offset:53248
    s_waitcnt vmcnt(6) lgkmcnt(4)
    v_mfma_f32_32x32x16_bf16 v[128:143], v[76:79], v[184:187], v[128:143]
    ds_read_b64_tr_b16 v[176:177], v245 offset:21504
    ds_read_b64_tr_b16 v[178:179], v246 offset:21504
    buffer_load_dwordx4 v[104:107], v244, s[24:27], s59 offen offset:2048 sc1
    v_mfma_f32_32x32x16_bf16 v[144:159], v[76:79], v[188:191], v[144:159]
    ds_read_b64_tr_b16 v[180:181], v245 offset:54272
    ds_read_b64_tr_b16 v[182:183], v246 offset:54272
    s_waitcnt vmcnt(6) lgkmcnt(4)
    v_mfma_f32_32x32x16_bf16 v[128:143], v[80:83], v[192:195], v[128:143]
    ds_read_b64_tr_b16 v[184:185], v245 offset:22528
    ds_read_b64_tr_b16 v[186:187], v246 offset:22528
    buffer_load_dwordx4 v[108:111], v244, s[24:27], s59 offen offset:3072 sc1
    v_mfma_f32_32x32x16_bf16 v[144:159], v[80:83], v[196:199], v[144:159]
    ds_read_b64_tr_b16 v[188:189], v245 offset:55296
    ds_read_b64_tr_b16 v[190:191], v246 offset:55296
    s_waitcnt vmcnt(6) lgkmcnt(4)
    v_mfma_f32_32x32x16_bf16 v[128:143], v[84:87], v[176:179], v[128:143]
    ds_read_b64_tr_b16 v[192:193], v245 offset:23552
    ds_read_b64_tr_b16 v[194:195], v246 offset:23552
    s_add_u32 s59, s64, 7
    s_and_b32 s59, s59, 7
    s_lshl_b32 s59, s59, 12
    s_add_u32 s59, s59, s42
    buffer_load_dwordx4 v[112:115], v244, s[24:27], s59 offen offset:0 sc1
    v_mfma_f32_32x32x16_bf16 v[144:159], v[84:87], v[180:183], v[144:159]
    ds_read_b64_tr_b16 v[196:197], v245 offset:56320
    ds_read_b64_tr_b16 v[198:199], v246 offset:56320
    s_waitcnt vmcnt(6) lgkmcnt(4)
    v_mfma_f32_32x32x16_bf16 v[128:143], v[88:91], v[184:187], v[128:143]
    ds_read_b64_tr_b16 v[176:177], v245 offset:24576
    ds_read_b64_tr_b16 v[178:179], v246 offset:24576
    buffer_load_dwordx4 v[116:119], v244, s[24:27], s59 offen offset:1024 sc1
    v_mfma_f32_32x32x16_bf16 v[144:159], v[88:91], v[188:191], v[144:159]
    ds_read_b64_tr_b16 v[180:181], v245 offset:57344
    ds_read_b64_tr_b16 v[182:183], v246 offset:57344
    s_waitcnt vmcnt(6) lgkmcnt(4)
    v_mfma_f32_32x32x16_bf16 v[128:143], v[92:95], v[192:195], v[128:143]
    ds_read_b64_tr_b16 v[184:185], v245 offset:25600
    ds_read_b64_tr_b16 v[186:187], v246 offset:25600
    buffer_load_dwordx4 v[120:123], v244, s[24:27], s59 offen offset:2048 sc1
    v_mfma_f32_32x32x16_bf16 v[144:159], v[92:95], v[196:199], v[144:159]
    ds_read_b64_tr_b16 v[188:189], v245 offset:58368
    ds_read_b64_tr_b16 v[190:191], v246 offset:58368
    s_waitcnt vmcnt(6) lgkmcnt(4)
    v_mfma_f32_32x32x16_bf16 v[128:143], v[96:99], v[176:179], v[128:143]
    ds_read_b64_tr_b16 v[192:193], v245 offset:26624
    ds_read_b64_tr_b16 v[194:195], v246 offset:26624
    buffer_load_dwordx4 v[124:127], v244, s[24:27], s59 offen offset:3072 sc1
    v_mfma_f32_32x32x16_bf16 v[144:159], v[96:99], v[180:183], v[144:159]
    ds_read_b64_tr_b16 v[196:197], v245 offset:59392
    ds_read_b64_tr_b16 v[198:199], v246 offset:59392
    s_waitcnt vmcnt(6) lgkmcnt(4)
    v_mfma_f32_32x32x16_bf16 v[128:143], v[100:103], v[184:187], v[128:143]
    ds_read_b64_tr_b16 v[176:177], v245 offset:27648
    ds_read_b64_tr_b16 v[178:179], v246 offset:27648
    v_mfma_f32_32x32x16_bf16 v[144:159], v[100:103], v[188:191], v[144:159]
    ds_read_b64_tr_b16 v[180:181], v245 offset:60416
    ds_read_b64_tr_b16 v[182:183], v246 offset:60416
    s_waitcnt vmcnt(5) lgkmcnt(4)
    v_mfma_f32_32x32x16_bf16 v[128:143], v[104:107], v[192:195], v[128:143]
    ds_read_b64_tr_b16 v[184:185], v245 offset:28672
    ds_read_b64_tr_b16 v[186:187], v246 offset:28672
    v_mfma_f32_32x32x16_bf16 v[144:159], v[104:107], v[196:199], v[144:159]
    ds_read_b64_tr_b16 v[188:189], v245 offset:61440
    ds_read_b64_tr_b16 v[190:191], v246 offset:61440
    s_waitcnt vmcnt(4) lgkmcnt(4)
    v_mfma_f32_32x32x16_bf16 v[128:143], v[108:111], v[176:179], v[128:143]
    ds_read_b64_tr_b16 v[192:193], v245 offset:29696
    ds_read_b64_tr_b16 v[194:195], v246 offset:29696
    v_mfma_f32_32x32x16_bf16 v[144:159], v[108:111], v[180:183], v[144:159]
    ds_read_b64_tr_b16 v[196:197], v245 offset:62464
    ds_read_b64_tr_b16 v[198:199], v246 offset:62464
    s_waitcnt vmcnt(3) lgkmcnt(4)
    v_mfma_f32_32x32x16_bf16 v[128:143], v[112:115], v[184:187], v[128:143]
    ds_read_b64_tr_b16 v[176:177], v245 offset:30720
    ds_read_b64_tr_b16 v[178:179], v246 offset:30720
    v_mfma_f32_32x32x16_bf16 v[144:159], v[112:115], v[188:191], v[144:159]
    ds_read_b64_tr_b16 v[180:181], v245 offset:63488
    ds_read_b64_tr_b16 v[182:183], v246 offset:63488
    s_waitcnt vmcnt(2) lgkmcnt(4)
    v_mfma_f32_32x32x16_bf16 v[128:143], v[116:119], v[192:195], v[128:143]
    ds_read_b64_tr_b16 v[184:185], v245 offset:31744
    ds_read_b64_tr_b16 v[186:187], v246 offset:31744
    v_mfma_f32_32x32x16_bf16 v[144:159], v[116:119], v[196:199], v[144:159]
    ds_read_b64_tr_b16 v[188:189], v245 offset:64512
    ds_read_b64_tr_b16 v[190:191], v246 offset:64512
    s_waitcnt vmcnt(1) lgkmcnt(4)
    v_mfma_f32_32x32x16_bf16 v[128:143], v[120:123], v[176:179], v[128:143]
    v_mfma_f32_32x32x16_bf16 v[144:159], v[120:123], v[180:183], v[144:159]
    v_mfma_f32_32x32x16_bf16 v[160:175], v[214:217], v[218:221], 0
    s_waitcnt vmcnt(0) lgkmcnt(0)
    v_mfma_f32_32x32x16_bf16 v[128:143], v[124:127], v[184:187], v[128:143]
    v_mfma_f32_32x32x16_bf16 v[144:159], v[124:127], v[188:191], v[144:159]
    v_mfma_f32_32x32x16_bf16 v[128:143], v[212:215], v[222:225], v[128:143]
    v_mfma_f32_32x32x16_bf16 v[144:159], v[212:215], v[224:227], v[144:159]
    s_barrier
    s_nop 9
    v_pk_fma_f32 v[128:129], v[128:129], v[160:161], s[82:83]
    v_pk_fma_f32 v[130:131], v[130:131], v[162:163], s[82:83]
    v_pk_mul_f32 v[236:237], v[128:129], s[80:81]
    v_pk_mul_f32 v[238:239], v[130:131], s[80:81]
    v_exp_f32_e64 v236, v236 clamp
    v_exp_f32_e64 v237, v237 clamp
    v_exp_f32_e64 v238, v238 clamp
    v_exp_f32_e64 v239, v239 clamp
    v_max_f32 v128, s82, v128
    v_max_f32 v129, s82, v129
    v_max_f32 v130, s82, v130
    v_max_f32 v131, s82, v131
    v_pk_mul_f32 v[144:145], v[144:145], v[160:161]
    v_pk_mul_f32 v[146:147], v[146:147], v[162:163]
    v_pk_add_f32 v[128:129], v[128:129], v[236:237]
    v_pk_add_f32 v[130:131], v[130:131], v[238:239]
    v_cvt_pk_bf16_f32 v184, v144, v145
    v_cvt_pk_bf16_f32 v185, v146, v147
    v_cvt_pk_bf16_f32 v176, v128, v129
    v_cvt_pk_bf16_f32 v177, v130, v131
    v_pk_fma_f32 v[132:133], v[132:133], v[164:165], s[82:83]
    v_pk_fma_f32 v[134:135], v[134:135], v[166:167], s[82:83]
    v_pk_mul_f32 v[240:241], v[132:133], s[80:81]
    v_pk_mul_f32 v[242:243], v[134:135], s[80:81]
    v_exp_f32_e64 v240, v240 clamp
    v_exp_f32_e64 v241, v241 clamp
    v_exp_f32_e64 v242, v242 clamp
    v_exp_f32_e64 v243, v243 clamp
    v_max_f32 v132, s82, v132
    v_max_f32 v133, s82, v133
    v_max_f32 v134, s82, v134
    v_max_f32 v135, s82, v135
    v_pk_mul_f32 v[148:149], v[148:149], v[164:165]
    v_pk_mul_f32 v[150:151], v[150:151], v[166:167]
    v_pk_add_f32 v[132:133], v[132:133], v[240:241]
    v_pk_add_f32 v[134:135], v[134:135], v[242:243]
    v_cvt_pk_bf16_f32 v186, v148, v149
    v_cvt_pk_bf16_f32 v187, v150, v151
    v_cvt_pk_bf16_f32 v178, v132, v133
    v_cvt_pk_bf16_f32 v179, v134, v135
    s_nop 1
    v_mfma_f32_32x32x16_bf16 v[192:207], v[176:179], v[184:187], 0
    v_pk_fma_f32 v[136:137], v[136:137], v[168:169], s[82:83]
    v_pk_fma_f32 v[138:139], v[138:139], v[170:171], s[82:83]
    v_pk_mul_f32 v[236:237], v[136:137], s[80:81]
    v_pk_mul_f32 v[238:239], v[138:139], s[80:81]
    v_exp_f32_e64 v236, v236 clamp
    v_exp_f32_e64 v237, v237 clamp
    v_exp_f32_e64 v238, v238 clamp
    v_exp_f32_e64 v239, v239 clamp
    v_max_f32 v136, s82, v136
    v_max_f32 v137, s82, v137
    v_max_f32 v138, s82, v138
    v_max_f32 v139, s82, v139
    v_pk_mul_f32 v[152:153], v[152:153], v[168:169]
    v_pk_mul_f32 v[154:155], v[154:155], v[170:171]
    v_pk_add_f32 v[136:137], v[136:137], v[236:237]
    v_pk_add_f32 v[138:139], v[138:139], v[238:239]
    v_cvt_pk_bf16_f32 v188, v152, v153
    v_cvt_pk_bf16_f32 v189, v154, v155
    v_cvt_pk_bf16_f32 v180, v136, v137
    v_cvt_pk_bf16_f32 v181, v138, v139
    v_pk_fma_f32 v[140:141], v[140:141], v[172:173], s[82:83]
    v_pk_fma_f32 v[142:143], v[142:143], v[174:175], s[82:83]
    v_pk_mul_f32 v[240:241], v[140:141], s[80:81]
    v_pk_mul_f32 v[242:243], v[142:143], s[80:81]
    v_exp_f32_e64 v240, v240 clamp
    v_exp_f32_e64 v241, v241 clamp
    v_exp_f32_e64 v242, v242 clamp
    v_exp_f32_e64 v243, v243 clamp
    v_max_f32 v140, s82, v140
    v_max_f32 v141, s82, v141
    v_max_f32 v142, s82, v142
    v_max_f32 v143, s82, v143
    v_pk_mul_f32 v[156:157], v[156:157], v[172:173]
    v_pk_mul_f32 v[158:159], v[158:159], v[174:175]
    v_pk_add_f32 v[140:141], v[140:141], v[240:241]
    v_pk_add_f32 v[142:143], v[142:143], v[242:243]
    v_cvt_pk_bf16_f32 v190, v156, v157
    v_cvt_pk_bf16_f32 v191, v158, v159
    v_cvt_pk_bf16_f32 v182, v140, v141
    v_cvt_pk_bf16_f32 v183, v142, v143
    v_mfma_f32_32x32x16_bf16 v[144:159], v[176:179], v[218:221], 0
    s_nop 0
    v_mfma_f32_32x32x16_bf16 v[192:207], v[180:183], v[188:191], v[192:207]
    v_mfma_f32_32x32x16_bf16 v[144:159], v[180:183], v[218:221], v[144:159]
    s_lshl_b32 s59, s36, 12
    v_add_u32 v252, s59, v244
    v_add_u32 v236, 65536, v245
    v_add_u32 v237, 65536, v246
    s_nop 7
    v_cndmask_b32 v192, v144, v192, s[76:77]
    v_cndmask_b32 v193, v145, v193, s[76:77]
    v_cndmask_b32 v194, v146, v194, s[76:77]
    v_cndmask_b32 v195, v147, v195, s[76:77]
    ds_write_b128 v252, v[192:195] offset:49152
    v_cndmask_b32 v196, v148, v196, s[76:77]
    v_cndmask_b32 v197, v149, v197, s[76:77]
    v_cndmask_b32 v198, v150, v198, s[76:77]
    v_cndmask_b32 v199, v151, v199, s[76:77]
    ds_write_b128 v252, v[196:199] offset:50176
    v_cndmask_b32 v200, v200, v152, s[76:77]
    v_cndmask_b32 v201, v201, v153, s[76:77]
    v_cndmask_b32 v202, v202, v154, s[76:77]
    v_cndmask_b32 v203, v203, v155, s[76:77]
    ds_write_b128 v252, v[200:203] offset:51200
    v_cndmask_b32 v204, v204, v156, s[76:77]
    v_cndmask_b32 v205, v205, v157, s[76:77]
    v_cndmask_b32 v206, v206, v158, s[76:77]
    v_cndmask_b32 v207, v207, v159, s[76:77]
    ds_write_b128 v252, v[204:207] offset:52224
    s_waitcnt lgkmcnt(0)
    s_barrier
    ds_read_b64_tr_b16 v[176:177], v236 offset:0
    ds_read_b64_tr_b16 v[178:179], v237 offset:0
    ds_read_b64_tr_b16 v[180:181], v236 offset:1024
    ds_read_b64_tr_b16 v[182:183], v237 offset:1024
    ds_read_b64_tr_b16 v[184:185], v236 offset:2048
    ds_read_b64_tr_b16 v[186:187], v237 offset:2048
    ds_read_b64_tr_b16 v[188:189], v236 offset:3072
    ds_read_b64_tr_b16 v[190:191], v237 offset:3072
    s_waitcnt lgkmcnt(6)
    v_mfma_f32_32x32x16_bf16 v[160:175], v[176:179], v[0:3], 0
    ds_read_b64_tr_b16 v[192:193], v236 offset:4096
    ds_read_b64_tr_b16 v[194:195], v237 offset:4096
    s_waitcnt lgkmcnt(6)
    v_mfma_f32_32x32x16_bf16 v[160:175], v[180:183], v[4:7], v[160:175]
    ds_read_b64_tr_b16 v[176:177], v236 offset:5120
    ds_read_b64_tr_b16 v[178:179], v237 offset:5120
    s_waitcnt lgkmcnt(6)
    v_mfma_f32_32x32x16_bf16 v[160:175], v[184:187], v[8:11], v[160:175]
    ds_read_b64_tr_b16 v[180:181], v236 offset:6144
    ds_read_b64_tr_b16 v[182:183], v237 offset:6144
    s_waitcnt lgkmcnt(6)
    v_mfma_f32_32x32x16_bf16 v[160:175], v[188:191], v[12:15], v[160:175]
    ds_read_b64_tr_b16 v[184:185], v236 offset:7168
    ds_read_b64_tr_b16 v[186:187], v237 offset:7168
    s_waitcnt lgkmcnt(6)
    v_mfma_f32_32x32x16_bf16 v[160:175], v[192:195], v[16:19], v[160:175]
    ds_read_b64_tr_b16 v[188:189], v236 offset:8192
    ds_read_b64_tr_b16 v[190:191], v237 offset:8192
    s_waitcnt lgkmcnt(6)
    v_mfma_f32_32x32x16_bf16 v[160:175], v[176:179], v[20:23], v[160:175]
    ds_read_b64_tr_b16 v[192:193], v236 offset:9216
    ds_read_b64_tr_b16 v[194:195], v237 offset:9216
    s_waitcnt lgkmcnt(6)
    v_mfma_f32_32x32x16_bf16 v[160:175], v[180:183], v[24:27], v[160:175]
    ds_read_b64_tr_b16 v[176:177], v236 offset:10240
    ds_read_b64_tr_b16 v[178:179], v237 offset:10240
    s_waitcnt lgkmcnt(6)
    v_mfma_f32_32x32x16_bf16 v[160:175], v[184:187], v[28:31], v[160:175]
    ds_read_b64_tr_b16 v[180:181], v236 offset:11264
    ds_read_b64_tr_b16 v[182:183], v237 offset:11264
    s_waitcnt lgkmcnt(6)
    v_mfma_f32_32x32x16_bf16 v[160:175], v[188:191], v[32:35], v[160:175]
    ds_read_b64_tr_b16 v[184:185], v236 offset:12288
    ds_read_b64_tr_b16 v[186:187], v237 offset:12288
    s_waitcnt lgkmcnt(6)
    v_mfma_f32_32x32x16_bf16 v[160:175], v[192:195], v[36:39], v[160:175]
    ds_read_b64_tr_b16 v[188:189], v236 offset:13312
    ds_read_b64_tr_b16 v[190:191], v237 offset:13312
    s_waitcnt lgkmcnt(6)
    v_mfma_f32_32x32x16_bf16 v[160:175], v[176:179], v[40:43], v[160:175]
    s_barrier
    ds_read_b64_tr_b16 v[192:193], v236 offset:14336
    ds_read_b64_tr_b16 v[194:195], v237 offset:14336
    s_waitcnt lgkmcnt(6)
    v_mfma_f32_32x32x16_bf16 v[160:175], v[180:183], v[44:47], v[160:175]
    ds_read_b64_tr_b16 v[176:177], v236 offset:15360
    ds_read_b64_tr_b16 v[178:179], v237 offset:15360
    s_waitcnt lgkmcnt(6)
    v_mfma_f32_32x32x16_bf16 v[160:175], v[184:187], v[48:51], v[160:175]
    ds_read_b64_tr_b16 v[180:181], v236 offset:16384
    ds_read_b64_tr_b16 v[182:183], v237 offset:16384
    s_waitcnt lgkmcnt(6)
    v_mfma_f32_32x32x16_bf16 v[160:175], v[188:191], v[52:55], v[160:175]
    ds_read_b64_tr_b16 v[184:185], v236 offset:17408
    ds_read_b64_tr_b16 v[186:187], v237 offset:17408
    s_waitcnt lgkmcnt(6)
    v_mfma_f32_32x32x16_bf16 v[160:175], v[192:195], v[56:59], v[160:175]
    ds_read_b64_tr_b16 v[188:189], v236 offset:18432
    ds_read_b64_tr_b16 v[190:191], v237 offset:18432
    s_waitcnt lgkmcnt(6)
    v_mfma_f32_32x32x16_bf16 v[160:175], v[176:179], v[60:63], v[160:175]
    ds_read_b64_tr_b16 v[192:193], v236 offset:19456
    ds_read_b64_tr_b16 v[194:195], v237 offset:19456
    s_waitcnt lgkmcnt(6)
    v_mfma_f32_32x32x16_bf16 v[160:175], v[180:183], v[64:67], v[160:175]
    ds_read_b64_tr_b16 v[176:177], v236 offset:20480
    ds_read_b64_tr_b16 v[178:179], v237 offset:20480
    s_waitcnt lgkmcnt(6)
    v_mfma_f32_32x32x16_bf16 v[160:175], v[184:187], v[68:71], v[160:175]
    ds_read_b64_tr_b16 v[180:181], v236 offset:21504
    ds_read_b64_tr_b16 v[182:183], v237 offset:21504
    s_waitcnt lgkmcnt(6)
    v_mfma_f32_32x32x16_bf16 v[160:175], v[188:191], v[72:75], v[160:175]
    ds_read_b64_tr_b16 v[184:185], v236 offset:22528
    ds_read_b64_tr_b16 v[186:187], v237 offset:22528
    s_waitcnt lgkmcnt(6)
    v_mfma_f32_32x32x16_bf16 v[160:175], v[192:195], v[76:79], v[160:175]
    ds_read_b64_tr_b16 v[188:189], v236 offset:23552
    ds_read_b64_tr_b16 v[190:191], v237 offset:23552
    s_waitcnt lgkmcnt(6)
    v_mfma_f32_32x32x16_bf16 v[160:175], v[176:179], v[80:83], v[160:175]
    ds_read_b64_tr_b16 v[192:193], v236 offset:24576
    ds_read_b64_tr_b16 v[194:195], v237 offset:24576
    s_waitcnt lgkmcnt(6)
    v_mfma_f32_32x32x16_bf16 v[160:175], v[180:183], v[84:87], v[160:175]
    ds_read_b64_tr_b16 v[176:177], v236 offset:25600
    ds_read_b64_tr_b16 v[178:179], v237 offset:25600
    s_waitcnt lgkmcnt(6)
    v_mfma_f32_32x32x16_bf16 v[160:175], v[184:187], v[88:91], v[160:175]
    ds_read_b64_tr_b16 v[180:181], v236 offset:26624
    ds_read_b64_tr_b16 v[182:183], v237 offset:26624
    s_waitcnt lgkmcnt(6)
    v_mfma_f32_32x32x16_bf16 v[160:175], v[188:191], v[92:95], v[160:175]
    ds_read_b64_tr_b16 v[184:185], v236 offset:27648
    ds_read_b64_tr_b16 v[186:187], v237 offset:27648
    s_waitcnt lgkmcnt(6)
    v_mfma_f32_32x32x16_bf16 v[160:175], v[192:195], v[96:99], v[160:175]
    ds_read_b64_tr_b16 v[188:189], v236 offset:28672
    ds_read_b64_tr_b16 v[190:191], v237 offset:28672
    s_waitcnt lgkmcnt(6)
    v_mfma_f32_32x32x16_bf16 v[160:175], v[176:179], v[100:103], v[160:175]
    ds_read_b64_tr_b16 v[192:193], v236 offset:29696
    ds_read_b64_tr_b16 v[194:195], v237 offset:29696
    s_waitcnt lgkmcnt(6)
    v_mfma_f32_32x32x16_bf16 v[160:175], v[180:183], v[104:107], v[160:175]
    ds_read_b64_tr_b16 v[176:177], v236 offset:30720
    ds_read_b64_tr_b16 v[178:179], v237 offset:30720
    s_waitcnt lgkmcnt(6)
    v_mfma_f32_32x32x16_bf16 v[160:175], v[184:187], v[108:111], v[160:175]
    ds_read_b64_tr_b16 v[180:181], v236 offset:31744
    ds_read_b64_tr_b16 v[182:183], v237 offset:31744
    s_waitcnt lgkmcnt(6)
    v_mfma_f32_32x32x16_bf16 v[160:175], v[188:191], v[112:115], v[160:175]
    s_waitcnt lgkmcnt(4)
    v_mfma_f32_32x32x16_bf16 v[160:175], v[192:195], v[116:119], v[160:175]
    s_waitcnt lgkmcnt(2)
    v_mfma_f32_32x32x16_bf16 v[160:175], v[176:179], v[120:123], v[160:175]
    s_waitcnt lgkmcnt(0)
    v_mfma_f32_32x32x16_bf16 v[160:175], v[180:183], v[124:127], v[160:175]
    v_mfma_f32_32x32x16_bf16 v[160:175], v[226:229], v[212:215], v[160:175]
    v_mul_f32 v253, s80, v251
    v_mov_b32 v252, v251
    s_nop 9
    v_pk_mul_f32 v[236:237], v[160:161], v[252:253] op_sel:[0,1] op_sel_hi:[1,1]
    v_pk_mul_f32 v[238:239], v[162:163], v[252:253] op_sel:[0,1] op_sel_hi:[1,1]
    v_max_f32 v160, 0, v160
    v_max_f32 v161, 0, v161
    v_max_f32 v162, 0, v162
    v_max_f32 v163, 0, v163
    v_exp_f32_e64 v236, v236 clamp
    v_exp_f32_e64 v237, v237 clamp
    v_exp_f32_e64 v238, v238 clamp
    v_exp_f32_e64 v239, v239 clamp
    v_pk_fma_f32 v[160:161], v[160:161], v[252:253], s[82:83] op_sel_hi:[1,0,1]
    v_pk_fma_f32 v[162:163], v[162:163], v[252:253], s[82:83] op_sel_hi:[1,0,1]
    v_pk_add_f32 v[160:161], v[160:161], v[236:237]
    v_pk_add_f32 v[162:163], v[162:163], v[238:239]
    v_cvt_pk_bf16_f32 v176, v160, v161
    v_cvt_pk_bf16_f32 v177, v162, v163
    v_pk_mul_f32 v[240:241], v[164:165], v[252:253] op_sel:[0,1] op_sel_hi:[1,1]
    v_pk_mul_f32 v[242:243], v[166:167], v[252:253] op_sel:[0,1] op_sel_hi:[1,1]
    v_max_f32 v164, 0, v164
    v_max_f32 v165, 0, v165
    v_max_f32 v166, 0, v166
    v_max_f32 v167, 0, v167
    v_exp_f32_e64 v240, v240 clamp
    v_exp_f32_e64 v241, v241 clamp
    v_exp_f32_e64 v242, v242 clamp
    v_exp_f32_e64 v243, v243 clamp
    v_pk_fma_f32 v[164:165], v[164:165], v[252:253], s[82:83] op_sel_hi:[1,0,1]
    v_pk_fma_f32 v[166:167], v[166:167], v[252:253], s[82:83] op_sel_hi:[1,0,1]
    v_pk_add_f32 v[164:165], v[164:165], v[240:241]
    v_pk_add_f32 v[166:167], v[166:167], v[242:243]
    v_cvt_pk_bf16_f32 v178, v164, v165
    v_cvt_pk_bf16_f32 v179, v166, v167
    v_pk_mul_f32 v[236:237], v[168:169], v[252:253] op_sel:[0,1] op_sel_hi:[1,1]
    v_pk_mul_f32 v[238:239], v[170:171], v[252:253] op_sel:[0,1] op_sel_hi:[1,1]
    v_max_f32 v168, 0, v168
    v_max_f32 v169, 0, v169
    v_max_f32 v170, 0, v170
    v_max_f32 v171, 0, v171
    v_exp_f32_e64 v236, v236 clamp
    v_exp_f32_e64 v237, v237 clamp
    v_exp_f32_e64 v238, v238 clamp
    v_exp_f32_e64 v239, v239 clamp
    v_pk_fma_f32 v[168:169], v[168:169], v[252:253], s[82:83] op_sel_hi:[1,0,1]
    v_pk_fma_f32 v[170:171], v[170:171], v[252:253], s[82:83] op_sel_hi:[1,0,1]
    v_pk_add_f32 v[168:169], v[168:169], v[236:237]
    v_pk_add_f32 v[170:171], v[170:171], v[238:239]
    v_cvt_pk_bf16_f32 v180, v168, v169
    v_cvt_pk_bf16_f32 v181, v170, v171
    v_pk_mul_f32 v[240:241], v[172:173], v[252:253] op_sel:[0,1] op_sel_hi:[1,1]
    v_pk_mul_f32 v[242:243], v[174:175], v[252:253] op_sel:[0,1] op_sel_hi:[1,1]
    v_max_f32 v172, 0, v172
    v_max_f32 v173, 0, v173
    v_max_f32 v174, 0, v174
    v_max_f32 v175, 0, v175
    v_exp_f32_e64 v240, v240 clamp
    v_exp_f32_e64 v241, v241 clamp
    v_exp_f32_e64 v242, v242 clamp
    v_exp_f32_e64 v243, v243 clamp
    v_pk_fma_f32 v[172:173], v[172:173], v[252:253], s[82:83] op_sel_hi:[1,0,1]
    v_pk_fma_f32 v[174:175], v[174:175], v[252:253], s[82:83] op_sel_hi:[1,0,1]
    v_pk_add_f32 v[172:173], v[172:173], v[240:241]
    v_pk_add_f32 v[174:175], v[174:175], v[242:243]
    v_cvt_pk_bf16_f32 v182, v172, v173
    v_cvt_pk_bf16_f32 v183, v174, v175
    v_add_u32 v0, 49152, v244
    s_barrier
    ds_read_b128 v[184:187], v0 offset:0
    ds_read_b128 v[188:191], v0 offset:2048
    s_waitcnt lgkmcnt(1)
    v_mfma_f32_32x32x16_bf16 v[128:143], v[184:187], v[176:179], 0
    s_waitcnt lgkmcnt(0)
    v_mfma_f32_32x32x16_bf16 v[144:159], v[188:191], v[180:183], 0
    s_nop 9
    v_add_f32 v252, s82, v136
    v_rcp_f32 v252, v252
    s_nop 0
    v_pk_mul_f32 v[128:129], v[128:129], v[252:253] op_sel_hi:[1,0]
    v_pk_mul_f32 v[130:131], v[130:131], v[252:253] op_sel_hi:[1,0]
    v_pk_mul_f32 v[132:133], v[132:133], v[252:253] op_sel_hi:[1,0]
    v_pk_mul_f32 v[134:135], v[134:135], v[252:253] op_sel_hi:[1,0]
    v_cvt_pk_bf16_f32 v192, v128, v129
    v_cvt_pk_bf16_f32 v193, v130, v131
    v_cvt_pk_bf16_f32 v194, v132, v133
    v_cvt_pk_bf16_f32 v195, v134, v135
    s_cmp_eq_u32 s40, 1
    s_cbranch_scc0 Lf_69
    buffer_store_dwordx4 v[192:195], v244, s[28:31], s44 offen offset:0 nt
Le_70:
    v_add_f32 v252, s82, v144
    v_rcp_f32 v252, v252
    s_nop 0
    v_pk_mul_f32 v[152:153], v[152:153], v[252:253] op_sel_hi:[1,0]
    v_pk_mul_f32 v[154:155], v[154:155], v[252:253] op_sel_hi:[1,0]
    v_pk_mul_f32 v[156:157], v[156:157], v[252:253] op_sel_hi:[1,0]
    v_pk_mul_f32 v[158:159], v[158:159], v[252:253] op_sel_hi:[1,0]
    v_cvt_pk_bf16_f32 v196, v152, v153
    v_cvt_pk_bf16_f32 v197, v154, v155
    v_cvt_pk_bf16_f32 v198, v156, v157
    v_cvt_pk_bf16_f32 v199, v158, v159
    s_cmp_eq_u32 s40, 1
    s_cbranch_scc0 Lf_71
    buffer_store_dwordx4 v[196:199], v244, s[28:31], s44 offen offset:1024 nt
Le_72:
    s_barrier
    s_waitcnt vmcnt(0)
    v_mov_b32 v252, 4
    s_mov_b64 exec, 1
    s_cmp_eq_u32 s40, 1
    s_cbranch_scc0 Lf_73
    buffer_store_dword v252, off, s[28:31], s50
Le_74:
    s_mov_b64 exec, -1
    v_lshrrev_b32 v253, 2, v244
    v_and_b32 v253, 60, v253
    s_mov_b32 s61, 0
Lpoll_75:
    buffer_load_dword v252, v253, s[28:31], s51 offen sc1
    s_add_u32 s61, s61, 1
    s_cmp_gt_u32 s61, 262144
    s_cbranch_scc1 L_end
    s_waitcnt vmcnt(0)
    v_cmp_gt_i32 vcc, 4, v252
    s_nop 3
    s_cbranch_vccnz Lpoll_75
    s_add_u32 s59, s46, 0
    buffer_load_dwordx4 v[0:3], v244, s[28:31], s59 offen offset:0 sc1
    buffer_load_dwordx4 v[4:7], v244, s[28:31], s59 offen offset:1024 sc1
    buffer_load_dwordx4 v[8:11], v244, s[28:31], s59 offen offset:2048 sc1
    buffer_load_dwordx4 v[12:15], v244, s[28:31], s59 offen offset:3072 sc1
    s_add_u32 s59, s46, 4096
    buffer_load_dwordx4 v[16:19], v244, s[28:31], s59 offen offset:0 sc1
    buffer_load_dwordx4 v[20:23], v244, s[28:31], s59 offen offset:1024 sc1
    buffer_load_dwordx4 v[24:27], v244, s[28:31], s59 offen offset:2048 sc1
    buffer_load_dwordx4 v[28:31], v244, s[28:31], s59 offen offset:3072 sc1
    s_add_u32 s59, s46, 8192
    buffer_load_dwordx4 v[32:35], v244, s[28:31], s59 offen offset:0 sc1
    ds_read_b64_tr_b16 v[176:177], v248 offset:0
    ds_read_b64_tr_b16 v[178:179], v248 offset:1024
    ds_read_b64_tr_b16 v[180:181], v249 offset:0
    ds_read_b64_tr_b16 v[182:183], v249 offset:1024
    ds_read_b64_tr_b16 v[184:185], v248 offset:2048
    ds_read_b64_tr_b16 v[186:187], v248 offset:3072
    ds_read_b64_tr_b16 v[188:189], v249 offset:2048
    ds_read_b64_tr_b16 v[190:191], v249 offset:3072
    s_waitcnt vmcnt(8) lgkmcnt(6)
    v_mfma_f32_32x32x16_bf16 v[128:143], v[176:179], v[0:3], 0
    ds_read_b64_tr_b16 v[192:193], v248 offset:4096
    ds_read_b64_tr_b16 v[194:195], v248 offset:5120
    buffer_load_dwordx4 v[36:39], v244, s[28:31], s59 offen offset:1024 sc1
    s_waitcnt lgkmcnt(6)
    v_mfma_f32_32x32x16_bf16 v[144:159], v[180:183], v[0:3], 0
    ds_read_b64_tr_b16 v[196:197], v249 offset:4096
    ds_read_b64_tr_b16 v[198:199], v249 offset:5120
    s_waitcnt vmcnt(8) lgkmcnt(4)
    v_mfma_f32_32x32x16_bf16 v[128:143], v[184:187], v[4:7], v[128:143]
    ds_read_b64_tr_b16 v[176:177], v248 offset:6144
    ds_read_b64_tr_b16 v[178:179], v248 offset:7168
    buffer_load_dwordx4 v[40:43], v244, s[28:31], s59 offen offset:2048 sc1
    v_mfma_f32_32x32x16_bf16 v[144:159], v[188:191], v[4:7], v[144:159]
    ds_read_b64_tr_b16 v[180:181], v249 offset:6144
    ds_read_b64_tr_b16 v[182:183], v249 offset:7168
    s_waitcnt vmcnt(8) lgkmcnt(4)
    v_mfma_f32_32x32x16_bf16 v[128:143], v[192:195], v[8:11], v[128:143]
    ds_read_b64_tr_b16 v[184:185], v248 offset:8192
    ds_read_b64_tr_b16 v[186:187], v248 offset:9216
    buffer_load_dwordx4 v[44:47], v244, s[28:31], s59 offen offset:3072 sc1
    v_mfma_f32_32x32x16_bf16 v[144:159], v[196:199], v[8:11], v[144:159]
    ds_read_b64_tr_b16 v[188:189], v249 offset:8192
    ds_read_b64_tr_b16 v[190:191], v249 offset:9216
    s_waitcnt vmcnt(8) lgkmcnt(4)
    v_mfma_f32_32x32x16_bf16 v[128:143], v[176:179], v[12:15], v[128:143]
    ds_read_b64_tr_b16 v[192:193], v248 offset:10240
    ds_read_b64_tr_b16 v[194:195], v248 offset:11264
    s_add_u32 s59, s46, 12288
    buffer_load_dwordx4 v[48:51], v244, s[28:31], s59 offen offset:0 sc1
    v_mfma_f32_32x32x16_bf16 v[144:159], v[180:183], v[12:15], v[144:159]
    ds_read_b64_tr_b16 v[196:197], v249 offset:10240
    ds_read_b64_tr_b16 v[198:199], v249 offset:11264
    s_waitcnt vmcnt(8) lgkmcnt(4)
    v_mfma_f32_32x32x16_bf16 v[128:143], v[184:187], v[16:19], v[128:143]
    ds_read_b64_tr_b16 v[176:177], v248 offset:12288
    ds_read_b64_tr_b16 v[178:179], v248 offset:13312
    buffer_load_dwordx4 v[52:55], v244, s[28:31], s59 offen offset:1024 sc1
    v_mfma_f32_32x32x16_bf16 v[144:159], v[188:191], v[16:19], v[144:159]
    ds_read_b64_tr_b16 v[180:181], v249 offset:12288
    ds_read_b64_tr_b16 v[182:183], v249 offset:13312
    s_waitcnt vmcnt(8) lgkmcnt(4)
    v_mfma_f32_32x32x16_bf16 v[128:143], v[192:195], v[20:23], v[128:143]
    ds_read_b64_tr_b16 v[184:185], v248 offset:14336
    ds_read_b64_tr_b16 v[186:187], v248 offset:15360
    buffer_load_dwordx4 v[56:59], v244, s[28:31], s59 offen offset:2048 sc1
    v_mfma_f32_32x32x16_bf16 v[144:159], v[196:199], v[20:23], v[144:159]
    ds_read_b64_tr_b16 v[188:189], v249 offset:14336
    ds_read_b64_tr_b16 v[190:191], v249 offset:15360
    s_waitcnt vmcnt(8) lgkmcnt(4)
    v_mfma_f32_32x32x16_bf16 v[128:143], v[176:179], v[24:27], v[128:143]
    ds_read_b64_tr_b16 v[192:193], v248 offset:16384
    ds_read_b64_tr_b16 v[194:195], v248 offset:17408
    buffer_load_dwordx4 v[60:63], v244, s[28:31], s59 offen offset:3072 sc1
    v_mfma_f32_32x32x16_bf16 v[144:159], v[180:183], v[24:27], v[144:159]
    ds_read_b64_tr_b16 v[196:197], v249 offset:16384
    ds_read_b64_tr_b16 v[198:199], v249 offset:17408
    s_waitcnt vmcnt(8) lgkmcnt(4)
    v_mfma_f32_32x32x16_bf16 v[128:143], v[184:187], v[28:31], v[128:143]
    ds_read_b64_tr_b16 v[176:177], v248 offset:18432
    ds_read_b64_tr_b16 v[178:179], v248 offset:19456
    buffer_load_dwordx4 v[236:239], v244, s[24:27], s48 offen sc1
    buffer_load_dwordx4 v[240:243], v244, s[24:27], s48 offen offset:1024 sc1
    v_mfma_f32_32x32x16_bf16 v[144:159], v[188:191], v[28:31], v[144:159]
    ds_read_b64_tr_b16 v[180:181], v249 offset:18432
    ds_read_b64_tr_b16 v[182:183], v249 offset:19456
    s_waitcnt vmcnt(9) lgkmcnt(4)
    v_mfma_f32_32x32x16_bf16 v[128:143], v[192:195], v[32:35], v[128:143]
    ds_read_b64_tr_b16 v[184:185], v248 offset:20480
    ds_read_b64_tr_b16 v[186:187], v248 offset:21504
    v_mfma_f32_32x32x16_bf16 v[144:159], v[196:199], v[32:35], v[144:159]
    ds_read_b64_tr_b16 v[188:189], v249 offset:20480
    ds_read_b64_tr_b16 v[190:191], v249 offset:21504
    s_waitcnt vmcnt(8) lgkmcnt(4)
    v_mfma_f32_32x32x16_bf16 v[128:143], v[176:179], v[36:39], v[128:143]
    ds_read_b64_tr_b16 v[192:193], v248 offset:22528
    ds_read_b64_tr_b16 v[194:195], v248 offset:23552
    v_mfma_f32_32x32x16_bf16 v[144:159], v[180:183], v[36:39], v[144:159]
    ds_read_b64_tr_b16 v[196:197], v249 offset:22528
    ds_read_b64_tr_b16 v[198:199], v249 offset:23552
    s_waitcnt vmcnt(7) lgkmcnt(4)
    v_mfma_f32_32x32x16_bf16 v[128:143], v[184:187], v[40:43], v[128:143]
    ds_read_b64_tr_b16 v[176:177], v248 offset:24576
    ds_read_b64_tr_b16 v[178:179], v248 offset:25600
    v_mfma_f32_32x32x16_bf16 v[144:159], v[188:191], v[40:43], v[144:159]
    ds_read_b64_tr_b16 v[180:181], v249 offset:24576
    ds_read_b64_tr_b16 v[182:183], v249 offset:25600
    s_waitcnt vmcnt(6) lgkmcnt(4)
    v_mfma_f32_32x32x16_bf16 v[128:143], v[192:195], v[44:47], v[128:143]
    ds_read_b64_tr_b16 v[184:185], v248 offset:26624
    ds_read_b64_tr_b16 v[186:187], v248 offset:27648
    v_mfma_f32_32x32x16_bf16 v[144:159], v[196:199], v[44:47], v[144:159]
    ds_read_b64_tr_b16 v[188:189], v249 offset:26624
    ds_read_b64_tr_b16 v[190:191], v249 offset:27648
    s_waitcnt vmcnt(5) lgkmcnt(4)
    v_mfma_f32_32x32x16_bf16 v[128:143], v[176:179], v[48:51], v[128:143]
    ds_read_b64_tr_b16 v[192:193], v248 offset:28672
    ds_read_b64_tr_b16 v[194:195], v248 offset:29696
    v_mfma_f32_32x32x16_bf16 v[144:159], v[180:183], v[48:51], v[144:159]
    ds_read_b64_tr_b16 v[196:197], v249 offset:28672
    ds_read_b64_tr_b16 v[198:199], v249 offset:29696
    s_waitcnt vmcnt(4) lgkmcnt(4)
    v_mfma_f32_32x32x16_bf16 v[128:143], v[184:187], v[52:55], v[128:143]
    s_barrier
    ds_read_b64_tr_b16 v[176:177], v248 offset:30720
    ds_read_b64_tr_b16 v[178:179], v248 offset:31744
    v_mfma_f32_32x32x16_bf16 v[144:159], v[188:191], v[52:55], v[144:159]
    ds_read_b64_tr_b16 v[180:181], v249 offset:30720
    ds_read_b64_tr_b16 v[182:183], v249 offset:31744
    s_waitcnt vmcnt(3) lgkmcnt(4)
    v_mfma_f32_32x32x16_bf16 v[128:143], v[192:195], v[56:59], v[128:143]
    v_mfma_f32_32x32x16_bf16 v[144:159], v[196:199], v[56:59], v[144:159]
    s_waitcnt vmcnt(2) lgkmcnt(0)
    v_mfma_f32_32x32x16_bf16 v[128:143], v[176:179], v[60:63], v[128:143]
    v_mfma_f32_32x32x16_bf16 v[144:159], v[180:183], v[60:63], v[144:159]
    s_lshl_b32 s59, s36, 12
    s_add_u32 s59, s59, 106496
    v_add_u32 v252, s59, v244
    s_xor_b32 s59, s36, 2
    s_lshl_b32 s59, s59, 12
    s_add_u32 s59, s59, 106496
    v_add_u32 v253, s59, v244
    s_nop 4
    ds_write_b128 v252, v[144:147] offset:0
    ds_write_b128 v252, v[148:151] offset:1024
    ds_write_b128 v252, v[152:155] offset:2048
    ds_write_b128 v252, v[156:159] offset:3072
    s_waitcnt vmcnt(0)
    v_lshlrev_b32 v160, 16, v236
    v_and_b32 v161, 0xffff0000, v236
    v_lshlrev_b32 v162, 16, v237
    v_and_b32 v163, 0xffff0000, v237
    v_lshlrev_b32 v164, 16, v238
    v_and_b32 v165, 0xffff0000, v238
    v_lshlrev_b32 v166, 16, v239
    v_and_b32 v167, 0xffff0000, v239
    v_lshlrev_b32 v168, 16, v240
    v_and_b32 v169, 0xffff0000, v240
    v_lshlrev_b32 v170, 16, v241
    v_and_b32 v171, 0xffff0000, v241
    v_lshlrev_b32 v172, 16, v242
    v_and_b32 v173, 0xffff0000, v242
    v_lshlrev_b32 v174, 16, v243
    v_and_b32 v175, 0xffff0000, v243
    v_pk_add_f32 v[128:129], v[128:129], v[160:161]
    v_pk_add_f32 v[130:131], v[130:131], v[162:163]
    v_pk_add_f32 v[132:133], v[132:133], v[164:165]
    v_pk_add_f32 v[134:135], v[134:135], v[166:167]
    v_pk_add_f32 v[136:137], v[136:137], v[168:169]
    v_pk_add_f32 v[138:139], v[138:139], v[170:171]
    v_pk_add_f32 v[140:141], v[140:141], v[172:173]
    v_pk_add_f32 v[142:143], v[142:143], v[174:175]
    s_waitcnt lgkmcnt(0)
    s_barrier
    ds_read_b128 v[144:147], v253 offset:0
    ds_read_b128 v[148:151], v253 offset:1024
    ds_read_b128 v[152:155], v253 offset:2048
    ds_read_b128 v[156:159], v253 offset:3072
    s_waitcnt lgkmcnt(3)
    v_pk_add_f32 v[128:129], v[128:129], v[144:145]
    v_cvt_pk_bf16_f32 v176, v128, v129
    v_pk_add_f32 v[130:131], v[130:131], v[146:147]
    v_cvt_pk_bf16_f32 v177, v130, v131
    v_dot2_f32_bf16 v184, v176, s86, 0
    v_dot2_f32_bf16 v185, v176, v176, 0
    v_dot2_f32_bf16 v184, v177, s86, v184
    v_dot2_f32_bf16 v185, v177, v177, v185
    s_waitcnt lgkmcnt(2)
    v_pk_add_f32 v[132:133], v[132:133], v[148:149]
    v_cvt_pk_bf16_f32 v178, v132, v133
    v_pk_add_f32 v[134:135], v[134:135], v[150:151]
    v_cvt_pk_bf16_f32 v179, v134, v135
    v_dot2_f32_bf16 v184, v178, s86, v184
    v_dot2_f32_bf16 v185, v178, v178, v185
    v_dot2_f32_bf16 v184, v179, s86, v184
    v_dot2_f32_bf16 v185, v179, v179, v185
    s_cmp_eq_u32 s40, 1
    s_cbranch_scc0 Lf_77
    buffer_store_dwordx4 v[176:179], v244, s[24:27], s48 offen offset:0 nt
Le_78:
    s_waitcnt lgkmcnt(1)
    v_pk_add_f32 v[136:137], v[136:137], v[152:153]
    v_cvt_pk_bf16_f32 v180, v136, v137
    v_pk_add_f32 v[138:139], v[138:139], v[154:155]
    v_cvt_pk_bf16_f32 v181, v138, v139
    v_dot2_f32_bf16 v184, v180, s86, v184
    v_dot2_f32_bf16 v185, v180, v180, v185
    v_dot2_f32_bf16 v184, v181, s86, v184
    v_dot2_f32_bf16 v185, v181, v181, v185
    s_waitcnt lgkmcnt(0)
    v_pk_add_f32 v[140:141], v[140:141], v[156:157]
    v_cvt_pk_bf16_f32 v182, v140, v141
    v_pk_add_f32 v[142:143], v[142:143], v[158:159]
    v_cvt_pk_bf16_f32 v183, v142, v143
    s_cmp_eq_u32 s40, 1
    s_cbranch_scc0 Lf_79
    buffer_store_dwordx4 v[180:183], v244, s[24:27], s48 offen offset:1024 nt
Le_80:
    v_dot2_f32_bf16 v184, v182, s86, v184
    v_dot2_f32_bf16 v185, v182, v182, v185
    v_dot2_f32_bf16 v184, v183, s86, v184
    v_dot2_f32_bf16 v185, v183, v183, v185
    s_nop 2
    v_permlane32_swap_b32 v184, v185
    v_add_f32 v184, v184, v185
    s_cmp_eq_u32 s40, 1
    s_cbranch_scc0 Lf_81
    buffer_store_dword v184, v250, s[28:31], s55 offen nt
Le_82:
    s_waitcnt vmcnt(0)
    v_mov_b32 v252, 3
    s_mov_b64 exec, 1
    s_cmp_eq_u32 s40, 1
    s_cbranch_scc0 Lf_83
    buffer_store_dword v252, off, s[28:31], s52
Le_84:
    s_mov_b64 exec, -1
    s_barrier
    v_lshrrev_b32 v253, 2, v244
    v_and_b32 v253, 60, v253
    s_mov_b32 s61, 0
Lpoll_85:
    buffer_load_dword v252, v253, s[28:31], s53 offen sc1
    s_add_u32 s61, s61, 1
    s_cmp_gt_u32 s61, 262144
    s_cbranch_scc1 L_end
    s_waitcnt vmcnt(0)
    v_cmp_gt_i32 vcc, 3, v252
    s_nop 3
    s_cbranch_vccnz Lpoll_85
    s_add_u32 s59, s42, 0
    buffer_load_dwordx4 v[0:3], v244, s[24:27], s59 offen offset:0 sc1
    buffer_load_dwordx4 v[4:7], v244, s[24:27], s59 offen offset:1024 sc1
    buffer_load_dwordx4 v[8:11], v244, s[24:27], s59 offen offset:2048 sc1
    buffer_load_dwordx4 v[12:15], v244, s[24:27], s59 offen offset:3072 sc1
    s_add_u32 s59, s42, 4096
    buffer_load_dwordx4 v[16:19], v244, s[24:27], s59 offen offset:0 sc1
    buffer_load_dwordx4 v[20:23], v244, s[24:27], s59 offen offset:1024 sc1
    v_add_u32 v239, 49152, v244
    ds_read_b128 v[176:179], v244 offset:0
    ds_read_b128 v[180:183], v244 offset:1024
    ds_read_b128 v[184:187], v244 offset:2048
    ds_read_b128 v[188:191], v244 offset:3072
    ds_read_b128 v[192:195], v244 offset:4096
    ds_read_b128 v[196:199], v244 offset:5120
    s_waitcnt vmcnt(5) lgkmcnt(5)
    v_mfma_f32_32x32x16_bf16 v[128:143], v[176:179], v[0:3], 0
    ds_read_b128 v[200:203], v244 offset:6144
    buffer_load_dwordx4 v[24:27], v244, s[24:27], s59 offen offset:2048 sc1
    s_waitcnt lgkmcnt(5)
    v_mfma_f32_32x32x16_bf16 v[144:159], v[180:183], v[0:3], 0
    ds_read_b128 v[204:207], v244 offset:7168
    s_waitcnt lgkmcnt(5)
    v_mfma_f32_32x32x16_bf16 v[160:175], v[184:187], v[0:3], 0
    ds_read_b128 v[208:211], v244 offset:8192
    s_waitcnt vmcnt(5) lgkmcnt(3)
    v_mfma_f32_32x32x16_bf16 v[128:143], v[188:191], v[4:7], v[128:143]
    ds_read_b128 v[176:179], v244 offset:9216
    buffer_load_dwordx4 v[28:31], v244, s[24:27], s59 offen offset:3072 sc1
    v_mfma_f32_32x32x16_bf16 v[144:159], v[192:195], v[4:7], v[144:159]
    ds_read_b128 v[180:183], v244 offset:10240
    v_mfma_f32_32x32x16_bf16 v[160:175], v[196:199], v[4:7], v[160:175]
    ds_read_b128 v[184:187], v244 offset:11264
    buffer_load_dwordx4 v[112:115], v244, s[28:31], s43 offen offset:0 sc1
    buffer_load_dwordx4 v[116:119], v244, s[28:31], s43 offen offset:1024 sc1
    buffer_load_dwordx4 v[120:123], v244, s[28:31], s43 offen offset:2048 sc1
    buffer_load_dwordx4 v[124:127], v244, s[28:31], s43 offen offset:3072 sc1
    s_waitcnt vmcnt(9) lgkmcnt(3)
    v_mfma_f32_32x32x16_bf16 v[128:143], v[200:203], v[8:11], v[128:143]
    ds_read_b128 v[188:191], v244 offset:12288
    s_add_u32 s59, s42, 8192
    buffer_load_dwordx4 v[32:35], v244, s[24:27], s59 offen offset:0 sc1
    v_mfma_f32_32x32x16_bf16 v[144:159], v[204:207], v[8:11], v[144:159]
    ds_read_b128 v[192:195], v244 offset:13312
    v_mfma_f32_32x32x16_bf16 v[160:175], v[208:211], v[8:11], v[160:175]
    ds_read_b128 v[196:199], v244 offset:14336
    s_waitcnt vmcnt(9) lgkmcnt(3)
    v_mfma_f32_32x32x16_bf16 v[128:143], v[176:179], v[12:15], v[128:143]
    ds_read_b128 v[200:203], v244 offset:15360
    buffer_load_dwordx4 v[36:39], v244, s[24:27], s59 offen offset:1024 sc1
    v_mfma_f32_32x32x16_bf16 v[144:159], v[180:183], v[12:15], v[144:159]
    ds_read_b128 v[204:207], v244 offset:16384
    v_mfma_f32_32x32x16_bf16 v[160:175], v[184:187], v[12:15], v[160:175]
    ds_read_b128 v[208:211], v244 offset:17408
    buffer_load_dwordx4 v[40:43], v244, s[24:27], s59 offen offset:2048 sc1
    s_waitcnt vmcnt(10) lgkmcnt(3)
    v_mfma_f32_32x32x16_bf16 v[128:143], v[188:191], v[16:19], v[128:143]
    ds_read_b128 v[176:179], v244 offset:18432
    buffer_load_dwordx4 v[44:47], v244, s[24:27], s59 offen offset:3072 sc1
    v_mfma_f32_32x32x16_bf16 v[144:159], v[192:195], v[16:19], v[144:159]
    ds_read_b128 v[180:183], v244 offset:19456
    v_mfma_f32_32x32x16_bf16 v[160:175], v[196:199], v[16:19], v[160:175]
    ds_read_b128 v[184:187], v244 offset:20480
    s_waitcnt vmcnt(10) lgkmcnt(3)
    v_mfma_f32_32x32x16_bf16 v[128:143], v[200:203], v[20:23], v[128:143]
    ds_read_b128 v[188:191], v244 offset:21504
    s_add_u32 s59, s42, 12288
    buffer_load_dwordx4 v[48:51], v244, s[24:27], s59 offen offset:0 sc1
    v_mfma_f32_32x32x16_bf16 v[144:159], v[204:207], v[20:23], v[144:159]
    ds_read_b128 v[192:195], v244 offset:22528
    v_mfma_f32_32x32x16_bf16 v[160:175], v[208:211], v[20:23], v[160:175]
    ds_read_b128 v[196:199], v244 offset:23552
    buffer_load_dwordx4 v[52:55], v244, s[24:27], s59 offen offset:1024 sc1
    s_waitcnt vmcnt(11) lgkmcnt(3)
    v_mfma_f32_32x32x16_bf16 v[128:143], v[176:179], v[24:27], v[128:143]
    ds_read_b128 v[200:203], v244 offset:24576
    buffer_load_dwordx4 v[56:59], v244, s[24:27], s59 offen offset:2048 sc1
    v_mfma_f32_32x32x16_bf16 v[144:159], v[180:183], v[24:27], v[144:159]
    ds_read_b128 v[204:207], v244 offset:25600
    v_mfma_f32_32x32x16_bf16 v[160:175], v[184:187], v[24:27], v[160:175]
    ds_read_b128 v[208:211], v244 offset:26624
    s_waitcnt vmcnt(11) lgkmcnt(3)
    v_mfma_f32_32x32x16_bf16 v[128:143], v[188:191], v[28:31], v[128:143]
    ds_read_b128 v[176:179], v244 offset:27648
    buffer_load_dwordx4 v[60:63], v244, s[24:27], s59 offen offset:3072 sc1
    v_mfma_f32_32x32x16_bf16 v[144:159], v[192:195], v[28:31], v[144:159]
    ds_read_b128 v[180:183], v244 offset:28672
    v_mfma_f32_32x32x16_bf16 v[160:175], v[196:199], v[28:31], v[160:175]
    ds_read_b128 v[184:187], v244 offset:29696
    s_add_u32 s59, s42, 16384
    buffer_load_dwordx4 v[64:67], v244, s[24:27], s59 offen offset:0 sc1
    s_waitcnt vmcnt(8) lgkmcnt(3)
    v_mfma_f32_32x32x16_bf16 v[128:143], v[200:203], v[32:35], v[128:143]
    ds_read_b128 v[188:191], v244 offset:30720
    buffer_load_dwordx4 v[68:71], v244, s[24:27], s59 offen offset:1024 sc1
    v_mfma_f32_32x32x16_bf16 v[144:159], v[204:207], v[32:35], v[144:159]
    ds_read_b128 v[192:195], v244 offset:31744
    v_mfma_f32_32x32x16_bf16 v[160:175], v[208:211], v[32:35], v[160:175]
    ds_read_b128 v[196:199], v244 offset:32768
    s_waitcnt vmcnt(8) lgkmcnt(3)
    v_mfma_f32_32x32x16_bf16 v[128:143], v[176:179], v[36:39], v[128:143]
    ds_read_b128 v[200:203], v244 offset:33792
    buffer_load_dwordx4 v[72:75], v244, s[24:27], s59 offen offset:2048 sc1
    v_mfma_f32_32x32x16_bf16 v[144:159], v[180:183], v[36:39], v[144:159]
    ds_read_b128 v[204:207], v244 offset:34816
    v_add_f32 v112, v112, v114
    v_mfma_f32_32x32x16_bf16 v[160:175], v[184:187], v[36:39], v[160:175]
    ds_read_b128 v[208:211], v244 offset:35840
    buffer_load_dwordx4 v[76:79], v244, s[24:27], s59 offen offset:3072 sc1
    v_add_f32 v113, v113, v115
    s_waitcnt vmcnt(9) lgkmcnt(3)
    v_mfma_f32_32x32x16_bf16 v[128:143], v[188:191], v[40:43], v[128:143]
    ds_read_b128 v[176:179], v244 offset:36864
    s_add_u32 s59, s42, 20480
    buffer_load_dwordx4 v[80:83], v244, s[24:27], s59 offen offset:0 sc1
    v_mfma_f32_32x32x16_bf16 v[144:159], v[192:195], v[40:43], v[144:159]
    ds_read_b128 v[180:183], v244 offset:37888
    v_add_f32 v112, v112, v116
    v_mfma_f32_32x32x16_bf16 v[160:175], v[196:199], v[40:43], v[160:175]
    ds_read_b128 v[184:187], v244 offset:38912
    v_add_f32 v113, v113, v117
    s_waitcnt vmcnt(9) lgkmcnt(3)
    v_mfma_f32_32x32x16_bf16 v[128:143], v[200:203], v[44:47], v[128:143]
    ds_read_b128 v[188:191], v244 offset:39936
    buffer_load_dwordx4 v[84:87], v244, s[24:27], s59 offen offset:1024 sc1
    v_mfma_f32_32x32x16_bf16 v[144:159], v[204:207], v[44:47], v[144:159]
    ds_read_b128 v[192:195], v244 offset:40960
    v_add_f32 v112, v112, v118
    v_mfma_f32_32x32x16_bf16 v[160:175], v[208:211], v[44:47], v[160:175]
    ds_read_b128 v[196:199], v244 offset:41984
    buffer_load_dwordx4 v[88:91], v244, s[24:27], s59 offen offset:2048 sc1
    v_add_f32 v113, v113, v119
    s_waitcnt vmcnt(10) lgkmcnt(3)
    v_mfma_f32_32x32x16_bf16 v[128:143], v[176:179], v[48:51], v[128:143]
    ds_read_b128 v[200:203], v244 offset:43008
    buffer_load_dwordx4 v[92:95], v244, s[24:27], s59 offen offset:3072 sc1
    v_mfma_f32_32x32x16_bf16 v[144:159], v[180:183], v[48:51], v[144:159]
    ds_read_b128 v[204:207], v244 offset:44032
    v_add_f32 v112, v112, v120
    v_mfma_f32_32x32x16_bf16 v[160:175], v[184:187], v[48:51], v[160:175]
    ds_read_b128 v[208:211], v244 offset:45056
    v_add_f32 v113, v113, v121
    s_waitcnt vmcnt(10) lgkmcnt(3)
    v_mfma_f32_32x32x16_bf16 v[128:143], v[188:191], v[52:55], v[128:143]
    ds_read_b128 v[176:179], v244 offset:46080
    s_add_u32 s59, s42, 24576
    buffer_load_dwordx4 v[96:99], v244, s[24:27], s59 offen offset:0 sc1
    v_mfma_f32_32x32x16_bf16 v[144:159], v[192:195], v[52:55], v[144:159]
    ds_read_b128 v[180:183], v244 offset:47104
    v_add_f32 v112, v112, v122
    v_mfma_f32_32x32x16_bf16 v[160:175], v[196:199], v[52:55], v[160:175]
    ds_read_b128 v[184:187], v244 offset:48128
    buffer_load_dwordx4 v[100:103], v244, s[24:27], s59 offen offset:1024 sc1
    v_add_f32 v113, v113, v123
    s_waitcnt vmcnt(11) lgkmcnt(3)
    v_mfma_f32_32x32x16_bf16 v[128:143], v[200:203], v[56:59], v[128:143]
    ds_read_b128 v[188:191], v239 offset:0
    buffer_load_dwordx4 v[104:107], v244, s[24:27], s59 offen offset:2048 sc1
    v_mfma_f32_32x32x16_bf16 v[144:159], v[204:207], v[56:59], v[144:159]
    ds_read_b128 v[192:195], v239 offset:1024
    v_add_f32 v112, v112, v124
    v_mfma_f32_32x32x16_bf16 v[160:175], v[208:211], v[56:59], v[160:175]
    ds_read_b128 v[196:199], v239 offset:2048
    v_add_f32 v113, v113, v125
    s_waitcnt vmcnt(11) lgkmcnt(3)
    v_mfma_f32_32x32x16_bf16 v[128:143], v[176:179], v[60:63], v[128:143]
    ds_read_b128 v[200:203], v239 offset:3072
    buffer_load_dwordx4 v[108:111], v244, s[24:27], s59 offen offset:3072 sc1
    v_mfma_f32_32x32x16_bf16 v[144:159], v[180:183], v[60:63], v[144:159]
    ds_read_b128 v[204:207], v239 offset:4096
    v_add_f32 v112, v112, v126
    v_mfma_f32_32x32x16_bf16 v[160:175], v[184:187], v[60:63], v[160:175]
    ds_read_b128 v[208:211], v239 offset:5120
    s_add_u32 s59, s42, 28672
    buffer_load_dwordx4 v[0:3], v244, s[24:27], s59 offen offset:0 sc1
    v_add_f32 v113, v113, v127
    s_waitcnt vmcnt(12) lgkmcnt(3)
    v_mfma_f32_32x32x16_bf16 v[128:143], v[188:191], v[64:67], v[128:143]
    ds_read_b128 v[176:179], v239 offset:6144
    buffer_load_dwordx4 v[4:7], v244, s[24:27], s59 offen offset:1024 sc1
    v_mfma_f32_32x32x16_bf16 v[144:159], v[192:195], v[64:67], v[144:159]
    ds_read_b128 v[180:183], v239 offset:7168
    v_permlane32_swap_b32 v112, v113
    v_mfma_f32_32x32x16_bf16 v[160:175], v[196:199], v[64:67], v[160:175]
    ds_read_b128 v[184:187], v239 offset:8192
    v_add_f32 v112, v112, v113
    s_waitcnt vmcnt(12) lgkmcnt(3)
    v_mfma_f32_32x32x16_bf16 v[128:143], v[200:203], v[68:71], v[128:143]
    ds_read_b128 v[188:191], v239 offset:9216
    buffer_load_dwordx4 v[8:11], v244, s[24:27], s59 offen offset:2048 sc1
    v_mfma_f32_32x32x16_bf16 v[144:159], v[204:207], v[68:71], v[144:159]
    ds_read_b128 v[192:195], v239 offset:10240
    v_mov_b32 v113, v112
    v_mfma_f32_32x32x16_bf16 v[160:175], v[208:211], v[68:71], v[160:175]
    ds_read_b128 v[196:199], v239 offset:11264
    buffer_load_dwordx4 v[12:15], v244, s[24:27], s59 offen offset:3072 sc1
    v_permlane32_swap_b32 v112, v113
    s_waitcnt vmcnt(13) lgkmcnt(3)
    v_mfma_f32_32x32x16_bf16 v[128:143], v[176:179], v[72:75], v[128:143]
    ds_read_b128 v[200:203], v239 offset:12288
    v_mfma_f32_32x32x16_bf16 v[144:159], v[180:183], v[72:75], v[144:159]
    ds_read_b128 v[204:207], v239 offset:13312
    v_mul_f32 v238, 0xbb000000, v112
    buffer_load_dwordx4 v[120:123], v244, s[24:27], s48 offen sc1
    buffer_load_dwordx4 v[124:127], v244, s[24:27], s48 offen offset:1024 sc1
    v_mfma_f32_32x32x16_bf16 v[160:175], v[184:187], v[72:75], v[160:175]
    ds_read_b128 v[208:211], v239 offset:14336
    v_mul_f32 v113, 0x3b000000, v113
    s_waitcnt vmcnt(14) lgkmcnt(3)
    v_mfma_f32_32x32x16_bf16 v[128:143], v[188:191], v[76:79], v[128:143]
    ds_read_b128 v[176:179], v239 offset:15360
    v_mfma_f32_32x32x16_bf16 v[144:159], v[192:195], v[76:79], v[144:159]
    ds_read_b128 v[180:183], v239 offset:16384
    v_fma_f32 v113, -v238, v238, v113
    v_mfma_f32_32x32x16_bf16 v[160:175], v[196:199], v[76:79], v[160:175]
    ds_read_b128 v[184:187], v239 offset:17408
    v_max_f32 v113, 0, v113
    s_waitcnt vmcnt(13) lgkmcnt(3)
    v_mfma_f32_32x32x16_bf16 v[128:143], v[200:203], v[80:83], v[128:143]
    ds_read_b128 v[188:191], v239 offset:18432
    v_mfma_f32_32x32x16_bf16 v[144:159], v[204:207], v[80:83], v[144:159]
    ds_read_b128 v[192:195], v239 offset:19456
    v_add_f32 v113, 0x3727c5ac, v113
    v_mfma_f32_32x32x16_bf16 v[160:175], v[208:211], v[80:83], v[160:175]
    ds_read_b128 v[196:199], v239 offset:20480
    v_rsq_f32 v251, v113
    s_waitcnt vmcnt(12) lgkmcnt(3)
    v_mfma_f32_32x32x16_bf16 v[128:143], v[176:179], v[84:87], v[128:143]
    ds_read_b128 v[200:203], v239 offset:21504
    v_mfma_f32_32x32x16_bf16 v[144:159], v[180:183], v[84:87], v[144:159]
    ds_read_b128 v[204:207], v239 offset:22528
    v_cvt_pk_bf16_f32 v236, v238, v238
    v_mfma_f32_32x32x16_bf16 v[160:175], v[184:187], v[84:87], v[160:175]
    ds_read_b128 v[208:211], v239 offset:23552
    v_and_b32 v236, 0xffff0000, v236
    s_waitcnt vmcnt(11) lgkmcnt(3)
    v_mfma_f32_32x32x16_bf16 v[128:143], v[188:191], v[88:91], v[128:143]
    ds_read_b128 v[176:179], v239 offset:24576
    v_mfma_f32_32x32x16_bf16 v[144:159], v[192:195], v[88:91], v[144:159]
    ds_read_b128 v[180:183], v239 offset:25600
    v_sub_f32 v237, v238, v236
    v_mfma_f32_32x32x16_bf16 v[160:175], v[196:199], v[88:91], v[160:175]
    ds_read_b128 v[184:187], v239 offset:26624
    v_cvt_pk_bf16_f32 v212, v236, v236
    s_waitcnt vmcnt(10) lgkmcnt(3)
    v_mfma_f32_32x32x16_bf16 v[128:143], v[200:203], v[92:95], v[128:143]
    ds_read_b128 v[188:191], v239 offset:27648
    v_mfma_f32_32x32x16_bf16 v[144:159], v[204:207], v[92:95], v[144:159]
    ds_read_b128 v[192:195], v239 offset:28672
    v_cvt_pk_bf16_f32 v213, v237, 0
    v_mfma_f32_32x32x16_bf16 v[160:175], v[208:211], v[92:95], v[160:175]
    ds_read_b128 v[196:199], v239 offset:29696
    v_cndmask_b32 v212, 0, v212, s[74:75]
    s_waitcnt vmcnt(9) lgkmcnt(3)
    v_mfma_f32_32x32x16_bf16 v[128:143], v[176:179], v[96:99], v[128:143]
    s_barrier
    ds_read_b128 v[200:203], v239 offset:30720
    v_mfma_f32_32x32x16_bf16 v[144:159], v[180:183], v[96:99], v[144:159]
    ds_read_b128 v[204:207], v239 offset:31744
    v_cndmask_b32 v213, 0, v213, s[74:75]
    v_mfma_f32_32x32x16_bf16 v[160:175], v[184:187], v[96:99], v[160:175]
    ds_read_b128 v[208:211], v239 offset:32768
    v_cvt_pk_bf16_f32 v236, v251, v251
    s_waitcnt vmcnt(8) lgkmcnt(3)
    v_mfma_f32_32x32x16_bf16 v[128:143], v[188:191], v[100:103], v[128:143]
    ds_read_b128 v[176:179], v239 offset:33792
    v_mfma_f32_32x32x16_bf16 v[144:159], v[192:195], v[100:103], v[144:159]
    ds_read_b128 v[180:183], v239 offset:34816
    v_and_b32 v236, 0xffff0000, v236
    v_mfma_f32_32x32x16_bf16 v[160:175], v[196:199], v[100:103], v[160:175]
    ds_read_b128 v[184:187], v239 offset:35840
    v_sub_f32 v237, v251, v236
    s_waitcnt vmcnt(7) lgkmcnt(3)
    v_mfma_f32_32x32x16_bf16 v[128:143], v[200:203], v[104:107], v[128:143]
    ds_read_b128 v[188:191], v239 offset:36864
    v_mfma_f32_32x32x16_bf16 v[144:159], v[204:207], v[104:107], v[144:159]
    ds_read_b128 v[192:195], v239 offset:37888
    v_cvt_pk_bf16_f32 v216, v236, v237
    v_mfma_f32_32x32x16_bf16 v[160:175], v[208:211], v[104:107], v[160:175]
    ds_read_b128 v[196:199], v239 offset:38912
    v_cndmask_b32 v216, 0, v216, s[74:75]
    s_waitcnt vmcnt(6) lgkmcnt(3)
    v_mfma_f32_32x32x16_bf16 v[128:143], v[176:179], v[108:111], v[128:143]
    ds_read_b128 v[200:203], v239 offset:39936
    v_mfma_f32_32x32x16_bf16 v[144:159], v[180:183], v[108:111], v[144:159]
    ds_read_b128 v[204:207], v239 offset:40960
    v_mfma_f32_32x32x16_bf16 v[160:175], v[184:187], v[108:111], v[160:175]
    ds_read_b128 v[208:211], v239 offset:41984
    s_waitcnt vmcnt(5) lgkmcnt(3)
    v_mfma_f32_32x32x16_bf16 v[128:143], v[188:191], v[0:3], v[128:143]
    ds_read_b128 v[176:179], v239 offset:43008
    v_mfma_f32_32x32x16_bf16 v[144:159], v[192:195], v[0:3], v[144:159]
    ds_read_b128 v[180:183], v239 offset:44032
    v_mfma_f32_32x32x16_bf16 v[160:175], v[196:199], v[0:3], v[160:175]
    ds_read_b128 v[184:187], v239 offset:45056
    s_waitcnt vmcnt(4) lgkmcnt(3)
    v_mfma_f32_32x32x16_bf16 v[128:143], v[200:203], v[4:7], v[128:143]
    ds_read_b128 v[188:191], v239 offset:46080
    v_mfma_f32_32x32x16_bf16 v[144:159], v[204:207], v[4:7], v[144:159]
    ds_read_b128 v[192:195], v239 offset:47104
    v_mfma_f32_32x32x16_bf16 v[160:175], v[208:211], v[4:7], v[160:175]
    ds_read_b128 v[196:199], v239 offset:48128
    s_waitcnt vmcnt(3) lgkmcnt(3)
    v_mfma_f32_32x32x16_bf16 v[128:143], v[176:179], v[8:11], v[128:143]
    v_mfma_f32_32x32x16_bf16 v[144:159], v[180:183], v[8:11], v[144:159]
    v_mfma_f32_32x32x16_bf16 v[160:175], v[184:187], v[8:11], v[160:175]
    s_waitcnt vmcnt(2) lgkmcnt(0)
    v_mfma_f32_32x32x16_bf16 v[128:143], v[188:191], v[12:15], v[128:143]
    v_mfma_f32_32x32x16_bf16 v[144:159], v[192:195], v[12:15], v[144:159]
    v_mfma_f32_32x32x16_bf16 v[160:175], v[196:199], v[12:15], v[160:175]
    s_waitcnt vmcnt(0)
    v_mfma_f32_32x32x16_bf16 v[128:143], v[228:231], v[212:215], v[128:143]
    v_mfma_f32_32x32x16_bf16 v[144:159], v[230:233], v[212:215], v[144:159]
    v_mfma_f32_32x32x16_bf16 v[160:175], v[232:235], v[212:215], v[160:175]
    s_barrier
    v_mul_f32 v253, s80, v251
    v_sub_f32 v253, 0, v253
    v_mov_b32 v252, v251
    s_nop 5
    v_pk_mul_f32 v[236:237], v[128:129], v[252:253] op_sel:[0,1] op_sel_hi:[1,1]
    v_pk_mul_f32 v[238:239], v[130:131], v[252:253] op_sel:[0,1] op_sel_hi:[1,1]
    v_exp_f32 v236, v236
    v_exp_f32 v237, v237
    v_exp_f32 v238, v238
    v_exp_f32 v239, v239
    v_pk_mul_f32 v[128:129], v[128:129], v[252:253] op_sel_hi:[1,0]
    v_pk_add_f32 v[236:237], v[236:237], s[84:85]
    v_pk_add_f32 v[238:239], v[238:239], s[84:85]
    v_rcp_f32 v236, v236
    v_rcp_f32 v237, v237
    v_rcp_f32 v238, v238
    v_rcp_f32 v239, v239
    v_pk_mul_f32 v[130:131], v[130:131], v[252:253] op_sel_hi:[1,0]
    v_pk_mul_f32 v[128:129], v[128:129], v[236:237]
    v_pk_mul_f32 v[130:131], v[130:131], v[238:239]
    v_cvt_pk_bf16_f32 v176, v128, v129
    v_cvt_pk_bf16_f32 v177, v130, v131
    v_pk_mul_f32 v[240:241], v[132:133], v[252:253] op_sel:[0,1] op_sel_hi:[1,1]
    v_pk_mul_f32 v[242:243], v[134:135], v[252:253] op_sel:[0,1] op_sel_hi:[1,1]
    v_exp_f32 v240, v240
    v_exp_f32 v241, v241
    v_exp_f32 v242, v242
    v_exp_f32 v243, v243
    v_pk_mul_f32 v[132:133], v[132:133], v[252:253] op_sel_hi:[1,0]
    v_pk_add_f32 v[240:241], v[240:241], s[84:85]
    v_pk_add_f32 v[242:243], v[242:243], s[84:85]
    v_rcp_f32 v240, v240
    v_rcp_f32 v241, v241
    v_rcp_f32 v242, v242
    v_rcp_f32 v243, v243
    v_pk_mul_f32 v[134:135], v[134:135], v[252:253] op_sel_hi:[1,0]
    v_pk_mul_f32 v[132:133], v[132:133], v[240:241]
    v_pk_mul_f32 v[134:135], v[134:135], v[242:243]
    v_cvt_pk_bf16_f32 v178, v132, v133
    v_cvt_pk_bf16_f32 v179, v134, v135
    s_cmp_eq_u32 s40, 1
    s_cbranch_scc0 Lf_88
    buffer_store_dwordx4 v[176:179], v244, s[28:31], s45 offen offset:0 nt
Le_89:
    v_pk_mul_f32 v[236:237], v[136:137], v[252:253] op_sel:[0,1] op_sel_hi:[1,1]
    v_pk_mul_f32 v[238:239], v[138:139], v[252:253] op_sel:[0,1] op_sel_hi:[1,1]
    v_exp_f32 v236, v236
    v_exp_f32 v237, v237
    v_exp_f32 v238, v238
    v_exp_f32 v239, v239
    v_pk_mul_f32 v[136:137], v[136:137], v[252:253] op_sel_hi:[1,0]
    v_pk_add_f32 v[236:237], v[236:237], s[84:85]
    v_pk_add_f32 v[238:239], v[238:239], s[84:85]
    v_rcp_f32 v236, v236
    v_rcp_f32 v237, v237
    v_rcp_f32 v238, v238
    v_rcp_f32 v239, v239
    v_pk_mul_f32 v[138:139], v[138:139], v[252:253] op_sel_hi:[1,0]
    v_pk_mul_f32 v[136:137], v[136:137], v[236:237]
    v_pk_mul_f32 v[138:139], v[138:139], v[238:239]
    v_cvt_pk_bf16_f32 v180, v136, v137
    v_cvt_pk_bf16_f32 v181, v138, v139
    v_pk_mul_f32 v[240:241], v[140:141], v[252:253] op_sel:[0,1] op_sel_hi:[1,1]
    v_pk_mul_f32 v[242:243], v[142:143], v[252:253] op_sel:[0,1] op_sel_hi:[1,1]
    v_exp_f32 v240, v240
    v_exp_f32 v241, v241
    v_exp_f32 v242, v242
    v_exp_f32 v243, v243
    v_pk_mul_f32 v[140:141], v[140:141], v[252:253] op_sel_hi:[1,0]
    v_pk_add_f32 v[240:241], v[240:241], s[84:85]
    v_pk_add_f32 v[242:243], v[242:243], s[84:85]
    v_rcp_f32 v240, v240
    v_rcp_f32 v241, v241
    v_rcp_f32 v242, v242
    v_rcp_f32 v243, v243
    v_pk_mul_f32 v[142:143], v[142:143], v[252:253] op_sel_hi:[1,0]
    v_pk_mul_f32 v[140:141], v[140:141], v[240:241]
    v_pk_mul_f32 v[142:143], v[142:143], v[242:243]
    v_cvt_pk_bf16_f32 v182, v140, v141
    v_cvt_pk_bf16_f32 v183, v142, v143
    s_cmp_eq_u32 s40, 1
    s_cbranch_scc0 Lf_90
    buffer_store_dwordx4 v[180:183], v244, s[28:31], s45 offen offset:1024 nt
Le_91:
    v_pk_mul_f32 v[236:237], v[144:145], v[252:253] op_sel:[0,1] op_sel_hi:[1,1]
    v_pk_mul_f32 v[238:239], v[146:147], v[252:253] op_sel:[0,1] op_sel_hi:[1,1]
    v_exp_f32 v236, v236
    v_exp_f32 v237, v237
    v_exp_f32 v238, v238
    v_exp_f32 v239, v239
    v_pk_mul_f32 v[144:145], v[144:145], v[252:253] op_sel_hi:[1,0]
    v_pk_add_f32 v[236:237], v[236:237], s[84:85]
    v_pk_add_f32 v[238:239], v[238:239], s[84:85]
    v_rcp_f32 v236, v236
    v_rcp_f32 v237, v237
    v_rcp_f32 v238, v238
    v_rcp_f32 v239, v239
    v_pk_mul_f32 v[146:147], v[146:147], v[252:253] op_sel_hi:[1,0]
    v_pk_mul_f32 v[144:145], v[144:145], v[236:237]
    v_pk_mul_f32 v[146:147], v[146:147], v[238:239]
    v_cvt_pk_bf16_f32 v184, v144, v145
    v_cvt_pk_bf16_f32 v185, v146, v147
    v_pk_mul_f32 v[240:241], v[148:149], v[252:253] op_sel:[0,1] op_sel_hi:[1,1]
    v_pk_mul_f32 v[242:243], v[150:151], v[252:253] op_sel:[0,1] op_sel_hi:[1,1]
    v_exp_f32 v240, v240
    v_exp_f32 v241, v241
    v_exp_f32 v242, v242
    v_exp_f32 v243, v243
    v_pk_mul_f32 v[148:149], v[148:149], v[252:253] op_sel_hi:[1,0]
    v_pk_add_f32 v[240:241], v[240:241], s[84:85]
    v_pk_add_f32 v[242:243], v[242:243], s[84:85]
    v_rcp_f32 v240, v240
    v_rcp_f32 v241, v241
    v_rcp_f32 v242, v242
    v_rcp_f32 v243, v243
    v_pk_mul_f32 v[150:151], v[150:151], v[252:253] op_sel_hi:[1,0]
    v_pk_mul_f32 v[148:149], v[148:149], v[240:241]
    v_pk_mul_f32 v[150:151], v[150:151], v[242:243]
    v_cvt_pk_bf16_f32 v186, v148, v149
    v_cvt_pk_bf16_f32 v187, v150, v151
    s_cmp_eq_u32 s40, 1
    s_cbranch_scc0 Lf_92
    buffer_store_dwordx4 v[184:187], v244, s[28:31], s45 offen offset:2048 nt
Le_93:
    v_pk_mul_f32 v[236:237], v[152:153], v[252:253] op_sel:[0,1] op_sel_hi:[1,1]
    v_pk_mul_f32 v[238:239], v[154:155], v[252:253] op_sel:[0,1] op_sel_hi:[1,1]
    v_exp_f32 v236, v236
    v_exp_f32 v237, v237
    v_exp_f32 v238, v238
    v_exp_f32 v239, v239
    v_pk_mul_f32 v[152:153], v[152:153], v[252:253] op_sel_hi:[1,0]
    v_pk_add_f32 v[236:237], v[236:237], s[84:85]
    v_pk_add_f32 v[238:239], v[238:239], s[84:85]
    v_rcp_f32 v236, v236
    v_rcp_f32 v237, v237
    v_rcp_f32 v238, v238
    v_rcp_f32 v239, v239
    v_pk_mul_f32 v[154:155], v[154:155], v[252:253] op_sel_hi:[1,0]
    v_pk_mul_f32 v[152:153], v[152:153], v[236:237]
    v_pk_mul_f32 v[154:155], v[154:155], v[238:239]
    v_cvt_pk_bf16_f32 v188, v152, v153
    v_cvt_pk_bf16_f32 v189, v154, v155
    v_pk_mul_f32 v[240:241], v[156:157], v[252:253] op_sel:[0,1] op_sel_hi:[1,1]
    v_pk_mul_f32 v[242:243], v[158:159], v[252:253] op_sel:[0,1] op_sel_hi:[1,1]
    v_exp_f32 v240, v240
    v_exp_f32 v241, v241
    v_exp_f32 v242, v242
    v_exp_f32 v243, v243
    v_pk_mul_f32 v[156:157], v[156:157], v[252:253] op_sel_hi:[1,0]
    v_pk_add_f32 v[240:241], v[240:241], s[84:85]
    v_pk_add_f32 v[242:243], v[242:243], s[84:85]
    v_rcp_f32 v240, v240
    v_rcp_f32 v241, v241
    v_rcp_f32 v242, v242
    v_rcp_f32 v243, v243
    v_pk_mul_f32 v[158:159], v[158:159], v[252:253] op_sel_hi:[1,0]
    v_pk_mul_f32 v[156:157], v[156:157], v[240:241]
    v_pk_mul_f32 v[158:159], v[158:159], v[242:243]
    v_cvt_pk_bf16_f32 v190, v156, v157
    v_cvt_pk_bf16_f32 v191, v158, v159
    s_cmp_eq_u32 s40, 1
    s_cbranch_scc0 Lf_94
    buffer_store_dwordx4 v[188:191], v244, s[28:31], s45 offen offset:3072 nt
Le_95:
    s_cmp_eq_u32 s56, 3
    s_cbranch_scc0 Lb1e_87
    v_pk_mul_f32 v[236:237], v[160:161], v[252:253] op_sel:[0,1] op_sel_hi:[1,1]
    v_pk_mul_f32 v[238:239], v[162:163], v[252:253] op_sel:[0,1] op_sel_hi:[1,1]
    v_exp_f32 v236, v236
    v_exp_f32 v237, v237
    v_exp_f32 v238, v238
    v_exp_f32 v239, v239
    v_pk_mul_f32 v[160:161], v[160:161], v[252:253] op_sel_hi:[1,0]
    v_pk_add_f32 v[236:237], v[236:237], s[84:85]
    v_pk_add_f32 v[238:239], v[238:239], s[84:85]
    v_rcp_f32 v236, v236
    v_rcp_f32 v237, v237
    v_rcp_f32 v238, v238
    v_rcp_f32 v239, v239
    v_pk_mul_f32 v[162:163], v[162:163], v[252:253] op_sel_hi:[1,0]
    v_pk_mul_f32 v[160:161], v[160:161], v[236:237]
    v_pk_mul_f32 v[162:163], v[162:163], v[238:239]
    v_cvt_pk_bf16_f32 v192, v160, v161
    v_cvt_pk_bf16_f32 v193, v162, v163
    v_pk_mul_f32 v[240:241], v[164:165], v[252:253] op_sel:[0,1] op_sel_hi:[1,1]
    v_pk_mul_f32 v[242:243], v[166:167], v[252:253] op_sel:[0,1] op_sel_hi:[1,1]
    v_exp_f32 v240, v240
    v_exp_f32 v241, v241
    v_exp_f32 v242, v242
    v_exp_f32 v243, v243
    v_pk_mul_f32 v[164:165], v[164:165], v[252:253] op_sel_hi:[1,0]
    v_pk_add_f32 v[240:241], v[240:241], s[84:85]
    v_pk_add_f32 v[242:243], v[242:243], s[84:85]
    v_rcp_f32 v240, v240
    v_rcp_f32 v241, v241
    v_rcp_f32 v242, v242
    v_rcp_f32 v243, v243
    v_pk_mul_f32 v[166:167], v[166:167], v[252:253] op_sel_hi:[1,0]
    v_pk_mul_f32 v[164:165], v[164:165], v[240:241]
    v_pk_mul_f32 v[166:167], v[166:167], v[242:243]
    v_cvt_pk_bf16_f32 v194, v164, v165
    v_cvt_pk_bf16_f32 v195, v166, v167
    s_cmp_eq_u32 s40, 1
    s_cbranch_scc0 Lf_96
    buffer_store_dwordx4 v[192:195], v244, s[28:31], s49 offen offset:0 nt
Le_97:
    v_pk_mul_f32 v[236:237], v[168:169], v[252:253] op_sel:[0,1] op_sel_hi:[1,1]
    v_pk_mul_f32 v[238:239], v[170:171], v[252:253] op_sel:[0,1] op_sel_hi:[1,1]
    v_exp_f32 v236, v236
    v_exp_f32 v237, v237
    v_exp_f32 v238, v238
    v_exp_f32 v239, v239
    v_pk_mul_f32 v[168:169], v[168:169], v[252:253] op_sel_hi:[1,0]
    v_pk_add_f32 v[236:237], v[236:237], s[84:85]
    v_pk_add_f32 v[238:239], v[238:239], s[84:85]
    v_rcp_f32 v236, v236
    v_rcp_f32 v237, v237
    v_rcp_f32 v238, v238
    v_rcp_f32 v239, v239
    v_pk_mul_f32 v[170:171], v[170:171], v[252:253] op_sel_hi:[1,0]
    v_pk_mul_f32 v[168:169], v[168:169], v[236:237]
    v_pk_mul_f32 v[170:171], v[170:171], v[238:239]
    v_cvt_pk_bf16_f32 v196, v168, v169
    v_cvt_pk_bf16_f32 v197, v170, v171
    s_waitcnt vmcnt(1)
    v_mov_b32 v200, 5
    s_mov_b64 exec, 1
    s_cmp_eq_u32 s40, 1
    s_cbranch_scc0 Lf_98
    buffer_store_dword v200, off, s[28:31], s50
Le_99:
    s_mov_b64 exec, -1
    v_pk_mul_f32 v[240:241], v[172:173], v[252:253] op_sel:[0,1] op_sel_hi:[1,1]
    v_pk_mul_f32 v[242:243], v[174:175], v[252:253] op_sel:[0,1] op_sel_hi:[1,1]
    v_exp_f32 v240, v240
    v_exp_f32 v241, v241
    v_exp_f32 v242, v242
    v_exp_f32 v243, v243
    v_pk_mul_f32 v[172:173], v[172:173], v[252:253] op_sel_hi:[1,0]
    v_pk_add_f32 v[240:241], v[240:241], s[84:85]
    v_pk_add_f32 v[242:243], v[242:243], s[84:85]
    v_rcp_f32 v240, v240
    v_rcp_f32 v241, v241
    v_rcp_f32 v242, v242
    v_rcp_f32 v243, v243
    v_pk_mul_f32 v[174:175], v[174:175], v[252:253] op_sel_hi:[1,0]
    v_pk_mul_f32 v[172:173], v[172:173], v[240:241]
    v_pk_mul_f32 v[174:175], v[174:175], v[242:243]
    v_cvt_pk_bf16_f32 v198, v172, v173
    v_cvt_pk_bf16_f32 v199, v174, v175
    s_cmp_eq_u32 s40, 1
    s_cbranch_scc0 Lf_100
    buffer_store_dwordx4 v[196:199], v244, s[28:31], s54 offen offset:0 nt
Le_101:
Lb1e_87:
    v_lshrrev_b32 v253, 2, v244
    v_and_b32 v252, 0x1c, v253
    v_lshl_add_u32 v252, s63, 5, v252
    v_and_b32 v211, 0x3c, v253
    buffer_load_dword v201, v252, s[28:31], s51 offen sc1
    s_waitcnt vmcnt(0)
    v_mov_b32 v253, 6
    s_mov_b64 exec, 1
    s_cmp_eq_u32 s40, 1
    s_cbranch_scc0 Lf_102
    buffer_store_dword v253, off, s[28:31], s50
Le_103:
    s_mov_b64 exec, -1
    v_cmp_gt_i32 vcc, 5, v201
    s_barrier
    s_nop 2
    s_cbranch_vccnz Lere_105
Lego_104:
    s_add_u32 s59, s47, 0
    buffer_load_dwordx4 v[0:3], v244, s[28:31], s59 offen offset:0 sc1
    buffer_load_dwordx4 v[4:7], v244, s[28:31], s59 offen offset:1024 sc1
    buffer_load_dwordx4 v[8:11], v244, s[28:31], s59 offen offset:2048 sc1
    buffer_load_dwordx4 v[12:15], v244, s[28:31], s59 offen offset:3072 sc1
    s_add_u32 s59, s47, 4096
    buffer_load_dwordx4 v[16:19], v244, s[28:31], s59 offen offset:0 sc1
    buffer_load_dwordx4 v[20:23], v244, s[28:31], s59 offen offset:1024 sc1
    buffer_load_dwordx4 v[24:27], v244, s[28:31], s59 offen offset:2048 sc1
    buffer_load_dwordx4 v[28:31], v244, s[28:31], s59 offen offset:3072 sc1
    s_add_u32 s59, s47, 8192
    buffer_load_dwordx4 v[32:35], v244, s[28:31], s59 offen offset:0 sc1
    s_lshl_b32 s57, s63, 14
    s_sub_u32 s57, s57, 98304
    v_add_u32 v252, s57, v248
    v_add_u32 v253, s57, v249
    ds_read_b64_tr_b16 v[176:177], v248 offset:0
    ds_read_b64_tr_b16 v[178:179], v248 offset:1024
    ds_read_b64_tr_b16 v[180:181], v249 offset:0
    ds_read_b64_tr_b16 v[182:183], v249 offset:1024
    ds_read_b64_tr_b16 v[184:185], v248 offset:2048
    ds_read_b64_tr_b16 v[186:187], v248 offset:3072
    ds_read_b64_tr_b16 v[188:189], v249 offset:2048
    ds_read_b64_tr_b16 v[190:191], v249 offset:3072
    s_waitcnt vmcnt(8) lgkmcnt(6)
    v_mfma_f32_32x32x16_bf16 v[128:143], v[176:179], v[0:3], 0
    ds_read_b64_tr_b16 v[192:193], v248 offset:4096
    ds_read_b64_tr_b16 v[194:195], v248 offset:5120
    buffer_load_dwordx4 v[36:39], v244, s[28:31], s59 offen offset:1024 sc1
    s_waitcnt lgkmcnt(6)
    v_mfma_f32_32x32x16_bf16 v[144:159], v[180:183], v[0:3], 0
    ds_read_b64_tr_b16 v[196:197], v249 offset:4096
    ds_read_b64_tr_b16 v[198:199], v249 offset:5120
    s_waitcnt vmcnt(8) lgkmcnt(4)
    v_mfma_f32_32x32x16_bf16 v[128:143], v[184:187], v[4:7], v[128:143]
    ds_read_b64_tr_b16 v[176:177], v248 offset:6144
    ds_read_b64_tr_b16 v[178:179], v248 offset:7168
    buffer_load_dwordx4 v[40:43], v244, s[28:31], s59 offen offset:2048 sc1
    v_mfma_f32_32x32x16_bf16 v[144:159], v[188:191], v[4:7], v[144:159]
    ds_read_b64_tr_b16 v[180:181], v249 offset:6144
    ds_read_b64_tr_b16 v[182:183], v249 offset:7168
    s_waitcnt vmcnt(8) lgkmcnt(4)
    v_mfma_f32_32x32x16_bf16 v[128:143], v[192:195], v[8:11], v[128:143]
    ds_read_b64_tr_b16 v[184:185], v248 offset:8192
    ds_read_b64_tr_b16 v[186:187], v248 offset:9216
    buffer_load_dwordx4 v[44:47], v244, s[28:31], s59 offen offset:3072 sc1
    v_mfma_f32_32x32x16_bf16 v[144:159], v[196:199], v[8:11], v[144:159]
    ds_read_b64_tr_b16 v[188:189], v249 offset:8192
    ds_read_b64_tr_b16 v[190:191], v249 offset:9216
    s_waitcnt vmcnt(8) lgkmcnt(4)
    v_mfma_f32_32x32x16_bf16 v[128:143], v[176:179], v[12:15], v[128:143]
    ds_read_b64_tr_b16 v[192:193], v248 offset:10240
    ds_read_b64_tr_b16 v[194:195], v248 offset:11264
    s_add_u32 s59, s47, 12288
    buffer_load_dwordx4 v[48:51], v244, s[28:31], s59 offen offset:0 sc1
    v_mfma_f32_32x32x16_bf16 v[144:159], v[180:183], v[12:15], v[144:159]
    ds_read_b64_tr_b16 v[196:197], v249 offset:10240
    ds_read_b64_tr_b16 v[198:199], v249 offset:11264
    s_waitcnt vmcnt(8) lgkmcnt(4)
    v_mfma_f32_32x32x16_bf16 v[128:143], v[184:187], v[16:19], v[128:143]
    ds_read_b64_tr_b16 v[176:177], v248 offset:12288
    ds_read_b64_tr_b16 v[178:179], v248 offset:13312
    buffer_load_dwordx4 v[52:55], v244, s[28:31], s59 offen offset:1024 sc1
    v_mfma_f32_32x32x16_bf16 v[144:159], v[188:191], v[16:19], v[144:159]
    ds_read_b64_tr_b16 v[180:181], v249 offset:12288
    ds_read_b64_tr_b16 v[182:183], v249 offset:13312
    s_waitcnt vmcnt(8) lgkmcnt(4)
    v_mfma_f32_32x32x16_bf16 v[128:143], v[192:195], v[20:23], v[128:143]
    ds_read_b64_tr_b16 v[184:185], v248 offset:14336
    ds_read_b64_tr_b16 v[186:187], v248 offset:15360
    buffer_load_dwordx4 v[56:59], v244, s[28:31], s59 offen offset:2048 sc1
    v_mfma_f32_32x32x16_bf16 v[144:159], v[196:199], v[20:23], v[144:159]
    ds_read_b64_tr_b16 v[188:189], v249 offset:14336
    ds_read_b64_tr_b16 v[190:191], v249 offset:15360
    s_waitcnt vmcnt(8) lgkmcnt(4)
    v_mfma_f32_32x32x16_bf16 v[128:143], v[176:179], v[24:27], v[128:143]
    ds_read_b64_tr_b16 v[192:193], v248 offset:16384
    ds_read_b64_tr_b16 v[194:195], v248 offset:17408
    buffer_load_dwordx4 v[60:63], v244, s[28:31], s59 offen offset:3072 sc1
    v_mfma_f32_32x32x16_bf16 v[144:159], v[180:183], v[24:27], v[144:159]
    ds_read_b64_tr_b16 v[196:197], v249 offset:16384
    ds_read_b64_tr_b16 v[198:199], v249 offset:17408
    s_waitcnt vmcnt(8) lgkmcnt(4)
    v_mfma_f32_32x32x16_bf16 v[128:143], v[184:187], v[28:31], v[128:143]
    ds_read_b64_tr_b16 v[176:177], v248 offset:18432
    ds_read_b64_tr_b16 v[178:179], v248 offset:19456
    s_add_u32 s59, s47, 16384
    buffer_load_dwordx4 v[64:67], v244, s[28:31], s59 offen offset:0 sc1
    v_mfma_f32_32x32x16_bf16 v[144:159], v[188:191], v[28:31], v[144:159]
    ds_read_b64_tr_b16 v[180:181], v249 offset:18432
    ds_read_b64_tr_b16 v[182:183], v249 offset:19456
    s_waitcnt vmcnt(8) lgkmcnt(4)
    v_mfma_f32_32x32x16_bf16 v[128:143], v[192:195], v[32:35], v[128:143]
    ds_read_b64_tr_b16 v[184:185], v248 offset:20480
    ds_read_b64_tr_b16 v[186:187], v248 offset:21504
    buffer_load_dwordx4 v[68:71], v244, s[28:31], s59 offen offset:1024 sc1
    v_mfma_f32_32x32x16_bf16 v[144:159], v[196:199], v[32:35], v[144:159]
    ds_read_b64_tr_b16 v[188:189], v249 offset:20480
    ds_read_b64_tr_b16 v[190:191], v249 offset:21504
    s_waitcnt vmcnt(8) lgkmcnt(4)
    v_mfma_f32_32x32x16_bf16 v[128:143], v[176:179], v[36:39], v[128:143]
    ds_read_b64_tr_b16 v[192:193], v248 offset:22528
    ds_read_b64_tr_b16 v[194:195], v248 offset:23552
    buffer_load_dwordx4 v[72:75], v244, s[28:31], s59 offen offset:2048 sc1
    v_mfma_f32_32x32x16_bf16 v[144:159], v[180:183], v[36:39], v[144:159]
    ds_read_b64_tr_b16 v[196:197], v249 offset:22528
    ds_read_b64_tr_b16 v[198:199], v249 offset:23552
    s_waitcnt vmcnt(8) lgkmcnt(4)
    v_mfma_f32_32x32x16_bf16 v[128:143], v[184:187], v[40:43], v[128:143]
    ds_read_b64_tr_b16 v[176:177], v248 offset:24576
    ds_read_b64_tr_b16 v[178:179], v248 offset:25600
    buffer_load_dwordx4 v[76:79], v244, s[28:31], s59 offen offset:3072 sc1
    v_mfma_f32_32x32x16_bf16 v[144:159], v[188:191], v[40:43], v[144:159]
    ds_read_b64_tr_b16 v[180:181], v249 offset:24576
    ds_read_b64_tr_b16 v[182:183], v249 offset:25600
    s_waitcnt vmcnt(8) lgkmcnt(4)
    v_mfma_f32_32x32x16_bf16 v[128:143], v[192:195], v[44:47], v[128:143]
    ds_read_b64_tr_b16 v[184:185], v248 offset:26624
    ds_read_b64_tr_b16 v[186:187], v248 offset:27648
    buffer_load_dword v210, v211, s[28:31], s51 offen sc1
    s_add_u32 s59, s47, 20480
    buffer_load_dwordx4 v[80:83], v244, s[28:31], s59 offen offset:0 sc1
    v_mfma_f32_32x32x16_bf16 v[144:159], v[196:199], v[44:47], v[144:159]
    ds_read_b64_tr_b16 v[188:189], v249 offset:26624
    ds_read_b64_tr_b16 v[190:191], v249 offset:27648
    s_waitcnt vmcnt(9) lgkmcnt(4)
    v_mfma_f32_32x32x16_bf16 v[128:143], v[176:179], v[48:51], v[128:143]
    ds_read_b64_tr_b16 v[192:193], v248 offset:28672
    ds_read_b64_tr_b16 v[194:195], v248 offset:29696
    buffer_load_dwordx4 v[84:87], v244, s[28:31], s59 offen offset:1024 sc1
    v_mfma_f32_32x32x16_bf16 v[144:159], v[180:183], v[48:51], v[144:159]
    ds_read_b64_tr_b16 v[196:197], v249 offset:28672
    ds_read_b64_tr_b16 v[198:199], v249 offset:29696
    s_waitcnt vmcnt(9) lgkmcnt(4)
    v_mfma_f32_32x32x16_bf16 v[128:143], v[184:187], v[52:55], v[128:143]
    s_barrier
    ds_read_b64_tr_b16 v[176:177], v248 offset:30720
    ds_read_b64_tr_b16 v[178:179], v248 offset:31744
    buffer_load_dwordx4 v[88:91], v244, s[28:31], s59 offen offset:2048 sc1
    v_mfma_f32_32x32x16_bf16 v[144:159], v[188:191], v[52:55], v[144:159]
    ds_read_b64_tr_b16 v[180:181], v249 offset:30720
    ds_read_b64_tr_b16 v[182:183], v249 offset:31744
    s_waitcnt vmcnt(9) lgkmcnt(4)
    v_mfma_f32_32x32x16_bf16 v[128:143], v[192:195], v[56:59], v[128:143]
    ds_read_b64_tr_b16 v[184:185], v252 offset:0
    ds_read_b64_tr_b16 v[186:187], v252 offset:1024
    buffer_load_dwordx4 v[92:95], v244, s[28:31], s59 offen offset:3072 sc1
    v_mfma_f32_32x32x16_bf16 v[144:159], v[196:199], v[56:59], v[144:159]
    ds_read_b64_tr_b16 v[188:189], v253 offset:0
    ds_read_b64_tr_b16 v[190:191], v253 offset:1024
    s_waitcnt vmcnt(9) lgkmcnt(4)
    v_mfma_f32_32x32x16_bf16 v[128:143], v[176:179], v[60:63], v[128:143]
    ds_read_b64_tr_b16 v[192:193], v252 offset:2048
    ds_read_b64_tr_b16 v[194:195], v252 offset:3072
    s_add_u32 s59, s47, 24576
    buffer_load_dwordx4 v[96:99], v244, s[28:31], s59 offen offset:0 sc1
    v_mfma_f32_32x32x16_bf16 v[144:159], v[180:183], v[60:63], v[144:159]
    ds_read_b64_tr_b16 v[196:197], v253 offset:2048
    ds_read_b64_tr_b16 v[198:199], v253 offset:3072
    s_waitcnt vmcnt(9) lgkmcnt(4)
    v_mfma_f32_32x32x16_bf16 v[128:143], v[184:187], v[64:67], v[128:143]
    ds_read_b64_tr_b16 v[176:177], v252 offset:4096
    ds_read_b64_tr_b16 v[178:179], v252 offset:5120
    buffer_load_dwordx4 v[100:103], v244, s[28:31], s59 offen offset:1024 sc1
    v_mfma_f32_32x32x16_bf16 v[144:159], v[188:191], v[64:67], v[144:159]
    ds_read_b64_tr_b16 v[180:181], v253 offset:4096
    ds_read_b64_tr_b16 v[182:183], v253 offset:5120
    s_waitcnt vmcnt(9) lgkmcnt(4)
    v_mfma_f32_32x32x16_bf16 v[128:143], v[192:195], v[68:71], v[128:143]
    ds_read_b64_tr_b16 v[184:185], v252 offset:6144
    ds_read_b64_tr_b16 v[186:187], v252 offset:7168
    buffer_load_dwordx4 v[104:107], v244, s[28:31], s59 offen offset:2048 sc1
    v_mfma_f32_32x32x16_bf16 v[144:159], v[196:199], v[68:71], v[144:159]
    ds_read_b64_tr_b16 v[188:189], v253 offset:6144
    ds_read_b64_tr_b16 v[190:191], v253 offset:7168
    s_waitcnt vmcnt(9) lgkmcnt(4)
    v_mfma_f32_32x32x16_bf16 v[128:143], v[176:179], v[72:75], v[128:143]
    ds_read_b64_tr_b16 v[192:193], v252 offset:8192
    ds_read_b64_tr_b16 v[194:195], v252 offset:9216
    buffer_load_dwordx4 v[108:111], v244, s[28:31], s59 offen offset:3072 sc1
    v_mfma_f32_32x32x16_bf16 v[144:159], v[180:183], v[72:75], v[144:159]
    ds_read_b64_tr_b16 v[196:197], v253 offset:8192
    ds_read_b64_tr_b16 v[198:199], v253 offset:9216
    s_waitcnt vmcnt(9) lgkmcnt(4)
    v_mfma_f32_32x32x16_bf16 v[128:143], v[184:187], v[76:79], v[128:143]
    ds_read_b64_tr_b16 v[176:177], v252 offset:10240
    ds_read_b64_tr_b16 v[178:179], v252 offset:11264
    s_add_u32 s59, s47, 28672
    buffer_load_dwordx4 v[112:115], v244, s[28:31], s59 offen offset:0 sc1
    v_mfma_f32_32x32x16_bf16 v[144:159], v[188:191], v[76:79], v[144:159]
    ds_read_b64_tr_b16 v[180:181], v253 offset:10240
    ds_read_b64_tr_b16 v[182:183], v253 offset:11264
    s_waitcnt vmcnt(8) lgkmcnt(4)
    v_mfma_f32_32x32x16_bf16 v[128:143], v[192:195], v[80:83], v[128:143]
    ds_read_b64_tr_b16 v[184:185], v252 offset:12288
    ds_read_b64_tr_b16 v[186:187], v252 offset:13312
    buffer_load_dwordx4 v[116:119], v244, s[28:31], s59 offen offset:1024 sc1
    v_mfma_f32_32x32x16_bf16 v[144:159], v[196:199], v[80:83], v[144:159]
    ds_read_b64_tr_b16 v[188:189], v253 offset:12288
    ds_read_b64_tr_b16 v[190:191], v253 offset:13312
    s_waitcnt vmcnt(8) lgkmcnt(4)
    v_mfma_f32_32x32x16_bf16 v[128:143], v[176:179], v[84:87], v[128:143]
    ds_read_b64_tr_b16 v[192:193], v252 offset:14336
    ds_read_b64_tr_b16 v[194:195], v252 offset:15360
    buffer_load_dwordx4 v[0:3], v244, s[28:31], s59 offen offset:2048 sc1
    v_mfma_f32_32x32x16_bf16 v[144:159], v[180:183], v[84:87], v[144:159]
    ds_read_b64_tr_b16 v[196:197], v253 offset:14336
    ds_read_b64_tr_b16 v[198:199], v253 offset:15360
    s_waitcnt vmcnt(8) lgkmcnt(4)
    v_mfma_f32_32x32x16_bf16 v[128:143], v[184:187], v[88:91], v[128:143]
    ds_read_b64_tr_b16 v[176:177], v252 offset:16384
    ds_read_b64_tr_b16 v[178:179], v252 offset:17408
    buffer_load_dwordx4 v[4:7], v244, s[28:31], s59 offen offset:3072 sc1
    v_mfma_f32_32x32x16_bf16 v[144:159], v[188:191], v[88:91], v[144:159]
    ds_read_b64_tr_b16 v[180:181], v253 offset:16384
    ds_read_b64_tr_b16 v[182:183], v253 offset:17408
    s_waitcnt vmcnt(8) lgkmcnt(4)
    v_mfma_f32_32x32x16_bf16 v[128:143], v[192:195], v[92:95], v[128:143]
    ds_read_b64_tr_b16 v[184:185], v252 offset:18432
    ds_read_b64_tr_b16 v[186:187], v252 offset:19456
    v_cmp_gt_i32 vcc, 6, v210
    s_nop 3
    s_cbranch_vccnz Llre_109
Llgo_108:
    s_add_u32 s59, s47, 32768
    buffer_load_dwordx4 v[8:11], v244, s[28:31], s59 offen offset:0 sc1
    v_mfma_f32_32x32x16_bf16 v[144:159], v[196:199], v[92:95], v[144:159]
    ds_read_b64_tr_b16 v[188:189], v253 offset:18432
    ds_read_b64_tr_b16 v[190:191], v253 offset:19456
    s_waitcnt vmcnt(8) lgkmcnt(4)
    v_mfma_f32_32x32x16_bf16 v[128:143], v[176:179], v[96:99], v[128:143]
    ds_read_b64_tr_b16 v[192:193], v252 offset:20480
    ds_read_b64_tr_b16 v[194:195], v252 offset:21504
    buffer_load_dwordx4 v[12:15], v244, s[28:31], s59 offen offset:1024 sc1
    v_mfma_f32_32x32x16_bf16 v[144:159], v[180:183], v[96:99], v[144:159]
    ds_read_b64_tr_b16 v[196:197], v253 offset:20480
    ds_read_b64_tr_b16 v[198:199], v253 offset:21504
    s_waitcnt vmcnt(8) lgkmcnt(4)
    v_mfma_f32_32x32x16_bf16 v[128:143], v[184:187], v[100:103], v[128:143]
    ds_read_b64_tr_b16 v[176:177], v252 offset:22528
    ds_read_b64_tr_b16 v[178:179], v252 offset:23552
    buffer_load_dwordx4 v[16:19], v244, s[28:31], s59 offen offset:2048 sc1
    v_mfma_f32_32x32x16_bf16 v[144:159], v[188:191], v[100:103], v[144:159]
    ds_read_b64_tr_b16 v[180:181], v253 offset:22528
    ds_read_b64_tr_b16 v[182:183], v253 offset:23552
    s_waitcnt vmcnt(8) lgkmcnt(4)
    v_mfma_f32_32x32x16_bf16 v[128:143], v[192:195], v[104:107], v[128:143]
    ds_read_b64_tr_b16 v[184:185], v252 offset:24576
    ds_read_b64_tr_b16 v[186:187], v252 offset:25600
    buffer_load_dwordx4 v[20:23], v244, s[28:31], s59 offen offset:3072 sc1
    v_mfma_f32_32x32x16_bf16 v[144:159], v[196:199], v[104:107], v[144:159]
    ds_read_b64_tr_b16 v[188:189], v253 offset:24576
    ds_read_b64_tr_b16 v[190:191], v253 offset:25600
    s_waitcnt vmcnt(8) lgkmcnt(4)
    v_mfma_f32_32x32x16_bf16 v[128:143], v[176:179], v[108:111], v[128:143]
    ds_read_b64_tr_b16 v[192:193], v252 offset:26624
    ds_read_b64_tr_b16 v[194:195], v252 offset:27648
    s_add_u32 s59, s47, 36864
    buffer_load_dwordx4 v[24:27], v244, s[28:31], s59 offen offset:0 sc1
    v_mfma_f32_32x32x16_bf16 v[144:159], v[180:183], v[108:111], v[144:159]
    ds_read_b64_tr_b16 v[196:197], v253 offset:26624
    ds_read_b64_tr_b16 v[198:199], v253 offset:27648
    s_waitcnt vmcnt(8) lgkmcnt(4)
    v_mfma_f32_32x32x16_bf16 v[128:143], v[184:187], v[112:115], v[128:143]
    ds_read_b64_tr_b16 v[176:177], v252 offset:28672
    ds_read_b64_tr_b16 v[178:179], v252 offset:29696
    buffer_load_dwordx4 v[28:31], v244, s[28:31], s59 offen offset:1024 sc1
    v_mfma_f32_32x32x16_bf16 v[144:159], v[188:191], v[112:115], v[144:159]
    ds_read_b64_tr_b16 v[180:181], v253 offset:28672
    ds_read_b64_tr_b16 v[182:183], v253 offset:29696
    s_waitcnt vmcnt(8) lgkmcnt(4)
    v_mfma_f32_32x32x16_bf16 v[128:143], v[192:195], v[116:119], v[128:143]
    ds_read_b64_tr_b16 v[184:185], v252 offset:30720
    ds_read_b64_tr_b16 v[186:187], v252 offset:31744
    buffer_load_dwordx4 v[32:35], v244, s[28:31], s59 offen offset:2048 sc1
    v_mfma_f32_32x32x16_bf16 v[144:159], v[196:199], v[116:119], v[144:159]
    ds_read_b64_tr_b16 v[188:189], v253 offset:30720
    ds_read_b64_tr_b16 v[190:191], v253 offset:31744
    s_waitcnt vmcnt(8) lgkmcnt(4)
    v_mfma_f32_32x32x16_bf16 v[128:143], v[176:179], v[0:3], v[128:143]
    ds_read_b64_tr_b16 v[192:193], v252 offset:32768
    ds_read_b64_tr_b16 v[194:195], v252 offset:33792
    buffer_load_dwordx4 v[36:39], v244, s[28:31], s59 offen offset:3072 sc1
    v_mfma_f32_32x32x16_bf16 v[144:159], v[180:183], v[0:3], v[144:159]
    ds_read_b64_tr_b16 v[196:197], v253 offset:32768
    ds_read_b64_tr_b16 v[198:199], v253 offset:33792
    s_waitcnt vmcnt(8) lgkmcnt(4)
    v_mfma_f32_32x32x16_bf16 v[128:143], v[184:187], v[4:7], v[128:143]
    ds_read_b64_tr_b16 v[176:177], v252 offset:34816
    ds_read_b64_tr_b16 v[178:179], v252 offset:35840
    s_add_u32 s59, s47, 40960
    buffer_load_dwordx4 v[40:43], v244, s[28:31], s59 offen offset:0 sc1
    v_mfma_f32_32x32x16_bf16 v[144:159], v[188:191], v[4:7], v[144:159]
    ds_read_b64_tr_b16 v[180:181], v253 offset:34816
    ds_read_b64_tr_b16 v[182:183], v253 offset:35840
    s_waitcnt vmcnt(8) lgkmcnt(4)
    v_mfma_f32_32x32x16_bf16 v[128:143], v[192:195], v[8:11], v[128:143]
    ds_read_b64_tr_b16 v[184:185], v252 offset:36864
    ds_read_b64_tr_b16 v[186:187], v252 offset:37888
    buffer_load_dwordx4 v[44:47], v244, s[28:31], s59 offen offset:1024 sc1
    v_mfma_f32_32x32x16_bf16 v[144:159], v[196:199], v[8:11], v[144:159]
    ds_read_b64_tr_b16 v[188:189], v253 offset:36864
    ds_read_b64_tr_b16 v[190:191], v253 offset:37888
    s_waitcnt vmcnt(8) lgkmcnt(4)
    v_mfma_f32_32x32x16_bf16 v[128:143], v[176:179], v[12:15], v[128:143]
    ds_read_b64_tr_b16 v[192:193], v252 offset:38912
    ds_read_b64_tr_b16 v[194:195], v252 offset:39936
    buffer_load_dwordx4 v[48:51], v244, s[28:31], s59 offen offset:2048 sc1
    v_mfma_f32_32x32x16_bf16 v[144:159], v[180:183], v[12:15], v[144:159]
    ds_read_b64_tr_b16 v[196:197], v253 offset:38912
    ds_read_b64_tr_b16 v[198:199], v253 offset:39936
    s_waitcnt vmcnt(8) lgkmcnt(4)
    v_mfma_f32_32x32x16_bf16 v[128:143], v[184:187], v[16:19], v[128:143]
    ds_read_b64_tr_b16 v[176:177], v252 offset:40960
    ds_read_b64_tr_b16 v[178:179], v252 offset:41984
    v_mfma_f32_32x32x16_bf16 v[144:159], v[188:191], v[16:19], v[144:159]
    ds_read_b64_tr_b16 v[180:181], v253 offset:40960
    ds_read_b64_tr_b16 v[182:183], v253 offset:41984
    s_waitcnt vmcnt(7) lgkmcnt(4)
    v_mfma_f32_32x32x16_bf16 v[128:143], v[192:195], v[20:23], v[128:143]
    ds_read_b64_tr_b16 v[184:185], v252 offset:43008
    ds_read_b64_tr_b16 v[186:187], v252 offset:44032
    v_mfma_f32_32x32x16_bf16 v[144:159], v[196:199], v[20:23], v[144:159]
    ds_read_b64_tr_b16 v[188:189], v253 offset:43008
    ds_read_b64_tr_b16 v[190:191], v253 offset:44032
    s_waitcnt vmcnt(6) lgkmcnt(4)
    v_mfma_f32_32x32x16_bf16 v[128:143], v[176:179], v[24:27], v[128:143]
    ds_read_b64_tr_b16 v[192:193], v252 offset:45056
    ds_read_b64_tr_b16 v[194:195], v252 offset:46080
    v_mfma_f32_32x32x16_bf16 v[144:159], v[180:183], v[24:27], v[144:159]
    ds_read_b64_tr_b16 v[196:197], v253 offset:45056
    ds_read_b64_tr_b16 v[198:199], v253 offset:46080
    s_waitcnt vmcnt(5) lgkmcnt(4)
    v_mfma_f32_32x32x16_bf16 v[128:143], v[184:187], v[28:31], v[128:143]
    ds_read_b64_tr_b16 v[176:177], v252 offset:47104
    ds_read_b64_tr_b16 v[178:179], v252 offset:48128
    v_mfma_f32_32x32x16_bf16 v[144:159], v[188:191], v[28:31], v[144:159]
    ds_read_b64_tr_b16 v[180:181], v253 offset:47104
    ds_read_b64_tr_b16 v[182:183], v253 offset:48128
    s_waitcnt vmcnt(4) lgkmcnt(4)
    v_mfma_f32_32x32x16_bf16 v[128:143], v[192:195], v[32:35], v[128:143]
    s_barrier
    ds_read_b64_tr_b16 v[184:185], v248 offset:0
    ds_read_b64_tr_b16 v[186:187], v248 offset:1024
    v_mfma_f32_32x32x16_bf16 v[144:159], v[196:199], v[32:35], v[144:159]
    ds_read_b64_tr_b16 v[188:189], v249 offset:0
    ds_read_b64_tr_b16 v[190:191], v249 offset:1024
    s_waitcnt vmcnt(3) lgkmcnt(4)
    v_mfma_f32_32x32x16_bf16 v[128:143], v[176:179], v[36:39], v[128:143]
    ds_read_b64_tr_b16 v[192:193], v248 offset:2048
    ds_read_b64_tr_b16 v[194:195], v248 offset:3072
    v_mfma_f32_32x32x16_bf16 v[144:159], v[180:183], v[36:39], v[144:159]
    ds_read_b64_tr_b16 v[196:197], v249 offset:2048
    ds_read_b64_tr_b16 v[198:199], v249 offset:3072
    s_waitcnt vmcnt(2) lgkmcnt(4)
    v_mfma_f32_32x32x16_bf16 v[128:143], v[184:187], v[40:43], v[128:143]
    ds_read_b64_tr_b16 v[176:177], v248 offset:4096
    ds_read_b64_tr_b16 v[178:179], v248 offset:5120
    v_mfma_f32_32x32x16_bf16 v[144:159], v[188:191], v[40:43], v[144:159]
    ds_read_b64_tr_b16 v[180:181], v249 offset:4096
    ds_read_b64_tr_b16 v[182:183], v249 offset:5120
    s_waitcnt vmcnt(1) lgkmcnt(4)
    v_mfma_f32_32x32x16_bf16 v[128:143], v[192:195], v[44:47], v[128:143]
    v_mfma_f32_32x32x16_bf16 v[144:159], v[196:199], v[44:47], v[144:159]
    s_waitcnt vmcnt(0) lgkmcnt(0)
    v_mfma_f32_32x32x16_bf16 v[128:143], v[176:179], v[48:51], v[128:143]
    v_mfma_f32_32x32x16_bf16 v[144:159], v[180:183], v[48:51], v[144:159]
    s_lshl_b32 s59, s36, 12
    s_add_u32 s59, s59, 106496
    v_add_u32 v252, s59, v244
    s_xor_b32 s59, s36, 2
    s_lshl_b32 s59, s59, 12
    s_add_u32 s59, s59, 106496
    v_add_u32 v253, s59, v244
    s_nop 4
    ds_write_b128 v252, v[144:147] offset:0
    ds_write_b128 v252, v[148:151] offset:1024
    ds_write_b128 v252, v[152:155] offset:2048
    ds_write_b128 v252, v[156:159] offset:3072
    v_lshlrev_b32 v160, 16, v120
    v_and_b32 v161, 0xffff0000, v120
    v_lshlrev_b32 v162, 16, v121
    v_and_b32 v163, 0xffff0000, v121
    v_lshlrev_b32 v164, 16, v122
    v_and_b32 v165, 0xffff0000, v122
    v_lshlrev_b32 v166, 16, v123
    v_and_b32 v167, 0xffff0000, v123
    v_lshlrev_b32 v168, 16, v124
    v_and_b32 v169, 0xffff0000, v124
    v_lshlrev_b32 v170, 16, v125
    v_and_b32 v171, 0xffff0000, v125
    v_lshlrev_b32 v172, 16, v126
    v_and_b32 v173, 0xffff0000, v126
    v_lshlrev_b32 v174, 16, v127
    v_and_b32 v175, 0xffff0000, v127
    v_pk_add_f32 v[128:129], v[128:129], v[160:161]
    v_pk_add_f32 v[130:131], v[130:131], v[162:163]
    v_pk_add_f32 v[132:133], v[132:133], v[164:165]
    v_pk_add_f32 v[134:135], v[134:135], v[166:167]
    v_pk_add_f32 v[136:137], v[136:137], v[168:169]
    v_pk_add_f32 v[138:139], v[138:139], v[170:171]
    v_pk_add_f32 v[140:141], v[140:141], v[172:173]
    v_pk_add_f32 v[142:143], v[142:143], v[174:175]
    s_waitcnt lgkmcnt(0)
    s_barrier
    ds_read_b128 v[144:147], v253 offset:0
    ds_read_b128 v[148:151], v253 offset:1024
    ds_read_b128 v[152:155], v253 offset:2048
    ds_read_b128 v[156:159], v253 offset:3072
    s_waitcnt lgkmcnt(3)
    v_pk_add_f32 v[128:129], v[128:129], v[144:145]
    v_cvt_pk_bf16_f32 v176, v128, v129
    v_pk_add_f32 v[130:131], v[130:131], v[146:147]
    v_cvt_pk_bf16_f32 v177, v130, v131
    s_waitcnt lgkmcnt(2)
    v_pk_add_f32 v[132:133], v[132:133], v[148:149]
    v_cvt_pk_bf16_f32 v178, v132, v133
    v_pk_add_f32 v[134:135], v[134:135], v[150:151]
    v_cvt_pk_bf16_f32 v179, v134, v135
    v_permlane32_swap_b32 v176, v178
    s_nop 0
    v_permlane32_swap_b32 v177, v179
    s_cmp_eq_u32 s40, 1
    s_cbranch_scc0 Lf_112
    buffer_store_dwordx4 v[176:179], v254, s[24:27], s65 offen offset:0
Le_113:
    s_waitcnt lgkmcnt(1)
    v_pk_add_f32 v[136:137], v[136:137], v[152:153]
    v_cvt_pk_bf16_f32 v180, v136, v137
    v_pk_add_f32 v[138:139], v[138:139], v[154:155]
    v_cvt_pk_bf16_f32 v181, v138, v139
    s_waitcnt lgkmcnt(0)
    v_pk_add_f32 v[140:141], v[140:141], v[156:157]
    v_cvt_pk_bf16_f32 v182, v140, v141
    v_pk_add_f32 v[142:143], v[142:143], v[158:159]
    v_cvt_pk_bf16_f32 v183, v142, v143
    v_permlane32_swap_b32 v180, v182
    s_nop 0
    v_permlane32_swap_b32 v181, v183
    s_cmp_eq_u32 s40, 1
    s_cbranch_scc0 Lf_114
    buffer_store_dwordx4 v[180:183], v254, s[24:27], s65 offen offset:32
Le_115:
L_end:
    s_endpgm
Lagain_5:
    buffer_load_dwordx2 v[40:41], v19, s[32:35], 0 offen sc1
    s_waitcnt vmcnt(0)
    s_add_u32 s61, s61, 1
    s_cmp_lt_u32 s61, 262144
    s_cbranch_scc0 L_end
    s_branch Lreg_3
Lf_16:
    s_nop 4
    buffer_store_dwordx4 v[192:195], v244, s[28:31], s44 offen offset:0 sc1
    s_nop 1
    s_branch Le_17
Lf_18:
    s_nop 4
    buffer_store_dwordx4 v[196:199], v244, s[28:31], s44 offen offset:1024 sc1
    s_nop 1
    s_branch Le_19
Lf_20:
    s_nop 4
    buffer_store_dword v252, off, s[28:31], s50 sc1
    s_nop 1
    s_branch Le_21
Lf_24:
    s_nop 4
    buffer_store_dwordx4 v[176:179], v244, s[24:27], s48 offen offset:0 sc1
    s_nop 1
    s_branch Le_25
Lf_26:
    s_nop 4
    buffer_store_dwordx4 v[180:183], v244, s[24:27], s48 offen offset:1024 sc1
    s_nop 1
    s_branch Le_27
Lf_28:
    s_nop 4
    buffer_store_dword v184, v250, s[28:31], s55 offen sc1
    s_nop 1
    s_branch Le_29
Lf_30:
    s_nop 4
    buffer_store_dword v252, off, s[28:31], s52 sc1
    s_nop 1
    s_branch Le_31
Lf_35:
    s_nop 4
    buffer_store_dwordx4 v[176:179], v244, s[28:31], s45 offen offset:0 sc1
    s_nop 1
    s_branch Le_36
Lf_37:
    s_nop 4
    buffer_store_dwordx4 v[180:183], v244, s[28:31], s45 offen offset:1024 sc1
    s_nop 1
    s_branch Le_38
Lf_39:
    s_nop 4
    buffer_store_dwordx4 v[184:187], v244, s[28:31], s45 offen offset:2048 sc1
    s_nop 1
    s_branch Le_40
Lf_41:
    s_nop 4
    buffer_store_dwordx4 v[188:191], v244, s[28:31], s45 offen offset:3072 sc1
    s_nop 1
    s_branch Le_42
Lf_43:
    s_nop 4
    buffer_store_dwordx4 v[192:195], v244, s[28:31], s49 offen offset:0 sc1
    s_nop 1
    s_branch Le_44
Lf_45:
    s_nop 4
    buffer_store_dword v200, off, s[28:31], s50 sc1
    s_nop 1
    s_branch Le_46
Lf_47:
    s_nop 4
    buffer_store_dwordx4 v[196:199], v244, s[28:31], s54 offen offset:0 sc1
    s_nop 1
    s_branch Le_48
Lf_49:
    s_nop 4
    buffer_store_dword v253, off, s[28:31], s50 sc1
    s_nop 1
    s_branch Le_50
Lere_52:
    s_mov_b32 s61, 0
Lpoll_53:
    buffer_load_dword v253, v252, s[28:31], s51 offen sc1
    s_add_u32 s61, s61, 1
    s_cmp_gt_u32 s61, 262144
    s_cbranch_scc1 L_end
    s_waitcnt vmcnt(0)
    v_cmp_gt_i32 vcc, 2, v253
    s_nop 3
    s_cbranch_vccnz Lpoll_53
    s_branch Lego_51
Llre_56:
    s_mov_b32 s61, 0
Lpoll_57:
    buffer_load_dword v210, v211, s[28:31], s51 offen sc1
    s_add_u32 s61, s61, 1
    s_cmp_gt_u32 s61, 262144
    s_cbranch_scc1 L_end
    s_waitcnt vmcnt(0)
    v_cmp_gt_i32 vcc, 3, v210
    s_nop 3
    s_cbranch_vccnz Lpoll_57
    s_branch Llgo_55
Lf_59:
    s_nop 4
    buffer_store_dwordx4 v[176:179], v244, s[24:27], s48 offen offset:0 sc1
    s_nop 1
    s_branch Le_60
Lf_61:
    s_nop 4
    buffer_store_dwordx4 v[180:183], v244, s[24:27], s48 offen offset:1024 sc1
    s_nop 1
    s_branch Le_62
Lf_63:
    s_nop 4
    buffer_store_dword v184, v250, s[28:31], s55 offen sc1
    s_nop 1
    s_branch Le_64
Lf_65:
    s_nop 4
    buffer_store_dword v252, off, s[28:31], s52 sc1
    s_nop 1
    s_branch Le_66
Lf_69:
    s_nop 4
    buffer_store_dwordx4 v[192:195], v244, s[28:31], s44 offen offset:0 sc1
    s_nop 1
    s_branch Le_70
Lf_71:
    s_nop 4
    buffer_store_dwordx4 v[196:199], v244, s[28:31], s44 offen offset:1024 sc1
    s_nop 1
    s_branch Le_72
Lf_73:
    s_nop 4
    buffer_store_dword v252, off, s[28:31], s50 sc1
    s_nop 1
    s_branch Le_74
Lf_77:
    s_nop 4
    buffer_store_dwordx4 v[176:179], v244, s[24:27], s48 offen offset:0 sc1
    s_nop 1
    s_branch Le_78
Lf_79:
    s_nop 4
    buffer_store_dwordx4 v[180:183], v244, s[24:27], s48 offen offset:1024 sc1
    s_nop 1
    s_branch Le_80
Lf_81:
    s_nop 4
    buffer_store_dword v184, v250, s[28:31], s55 offen sc1
    s_nop 1
    s_branch Le_82
Lf_83:
    s_nop 4
    buffer_store_dword v252, off, s[28:31], s52 sc1
    s_nop 1
    s_branch Le_84
Lf_88:
    s_nop 4
    buffer_store_dwordx4 v[176:179], v244, s[28:31], s45 offen offset:0 sc1
    s_nop 1
    s_branch Le_89
Lf_90:
    s_nop 4
    buffer_store_dwordx4 v[180:183], v244, s[28:31], s45 offen offset:1024 sc1
    s_nop 1
    s_branch Le_91
Lf_92:
    s_nop 4
    buffer_store_dwordx4 v[184:187], v244, s[28:31], s45 offen offset:2048 sc1
    s_nop 1
    s_branch Le_93
Lf_94:
    s_nop 4
    buffer_store_dwordx4 v[188:191], v244, s[28:31], s45 offen offset:3072 sc1
    s_nop 1
    s_branch Le_95
Lf_96:
    s_nop 4
    buffer_store_dwordx4 v[192:195], v244, s[28:31], s49 offen offset:0 sc1
    s_nop 1
    s_branch Le_97
Lf_98:
    s_nop 4
    buffer_store_dword v200, off, s[28:31], s50 sc1
    s_nop 1
    s_branch Le_99
Lf_100:
    s_nop 4
    buffer_store_dwordx4 v[196:199], v244, s[28:31], s54 offen offset:0 sc1
    s_nop 1
    s_branch Le_101
Lf_102:
    s_nop 4
    buffer_store_dword v253, off, s[28:31], s50 sc1
    s_nop 1
    s_branch Le_103
Lere_105:
    s_mov_b32 s61, 0
Lpoll_106:
    buffer_load_dword v253, v252, s[28:31], s51 offen sc1
    s_add_u32 s61, s61, 1
    s_cmp_gt_u32 s61, 262144
    s_cbranch_scc1 L_end
    s_waitcnt vmcnt(0)
    v_cmp_gt_i32 vcc, 5, v253
    s_nop 3
    s_cbranch_vccnz Lpoll_106
    s_branch Lego_104
Llre_109:
    s_mov_b32 s61, 0
Lpoll_110:
    buffer_load_dword v210, v211, s[28:31], s51 offen sc1
    s_add_u32 s61, s61, 1
    s_cmp_gt_u32 s61, 262144
    s_cbranch_scc1 L_end
    s_waitcnt vmcnt(0)
    v_cmp_gt_i32 vcc, 6, v210
    s_nop 3
    s_cbranch_vccnz Lpoll_110
    s_branch Llgo_108
Lf_112:
    s_nop 4
    buffer_store_dwordx4 v[176:179], v254, s[24:27], s65 offen offset:0 sc1
    s_nop 1
    s_branch Le_113
Lf_114:
    s_nop 4
    buffer_store_dwordx4 v[180:183], v254, s[24:27], s65 offen offset:32 sc1
    s_nop 1
    s_branch Le_115
L_codeend:
.section .rodata,"a"
.p2align 6
.amdhsa_kernel interleave_layers__linear_attn_block__dense_activation_silu__prompt_kernel
  .amdhsa_next_free_vgpr 256
  .amdhsa_next_free_sgpr 102
  .amdhsa_accum_offset 256
  .amdhsa_group_segment_fixed_size 0
  .amdhsa_kernarg_size 72
  .amdhsa_user_sgpr_count 2
  .amdhsa_user_sgpr_kernarg_segment_ptr 1
  .amdhsa_system_sgpr_workgroup_id_x 1
.end_amdhsa_kernel
```
